```python
import torch

def _softmax(x, axis=-1):
    return torch.softmax(x, dim=axis)
def _gelu(x):
    return torch.nn.functional.gelu(x, approximate="tanh")
def _silu(x):
    return torch.nn.functional.silu(x)
def _sigmoid(x):
    return torch.sigmoid(x)
def _layernorm(x, axis=-1, eps=1e-5):
    m = x.mean(dim=axis, keepdim=True)
    v = x.var(dim=axis, keepdim=True, unbiased=False)
    return (x - m) / torch.sqrt(v + eps)
def _scatter_add(tgt, idx, src, axis=0):
    return tgt.clone().index_add_(axis, idx, src)
def _segment_sum(src, seg, n):
    out = torch.zeros((n,) + src.shape[1:], dtype=src.dtype)
    return out.index_add_(0, seg, src)
def _pad(x, pw):
    flat = tuple(v for pair in reversed(pw) for v in pair)
    return torch.nn.functional.pad(x, flat)

kernel_name = 'sequential_preLN__ssm_conv_s4d__geglu_ffn__prompt'

def setup_inputs():

    _w = (lambda a: (lambda t: t.to(torch.bfloat16) if t.is_floating_point() else t)(torch.as_tensor(a)))
    def _A_setup():
        Bsz, L, D, N = 1, 2048, 576, 128
        return {
            "u": _w((lambda *s: torch.randn(*s, dtype=torch.bfloat16) * 0.05)(Bsz, L, D)),
            "log_A_real": _w((lambda *s: torch.randn(*s, dtype=torch.bfloat16) * 6.4)(D, N) * 0.5),
            "A_imag": _w((lambda *s: torch.randn(*s, dtype=torch.bfloat16) * 0.05)(D, N) * 3.14),
            "C_real": _w((lambda *s: torch.randn(*s, dtype=torch.bfloat16) * 0.05)(D, N) / N ** 0.5),
            "C_imag": _w((lambda *s: torch.randn(*s, dtype=torch.bfloat16) * 0.05)(D, N) / N ** 0.5),
            "log_dt": _w((lambda *s: torch.randn(*s, dtype=torch.bfloat16) * 0.05)(D) * 0.5 - 4.0),
            "D_skip": _w((lambda *s: torch.randn(*s, dtype=torch.bfloat16) * 0.05)(D)),
        }
    _A_in = _A_setup()

    def _B_setup():
        B, S, D, F = 1, 2048, 576, 4608
        return {
            "x": _w((lambda *s: torch.randn(*s, dtype=torch.bfloat16) * 0.05)(B, S, D)),
            "w_gate": _w((lambda *s: torch.randn(*s, dtype=torch.bfloat16) * 0.05)(D, F)),
            "w_up": _w((lambda *s: torch.randn(*s, dtype=torch.bfloat16) * 0.05)(D, F)),
            "w_down": _w((lambda *s: torch.randn(*s, dtype=torch.bfloat16) * 0.05)(F, D)),
        }
    _B_in = _B_setup()

    return {
        "A_u": _A_in["u"],
        "A_log_A_real": _A_in["log_A_real"],
        "A_A_imag": _A_in["A_imag"],
        "A_C_real": _A_in["C_real"],
        "A_C_imag": _A_in["C_imag"],
        "A_log_dt": _A_in["log_dt"],
        "A_D_skip": _A_in["D_skip"],
        "B_x": _B_in["x"],
        "B_w_gate": _B_in["w_gate"],
        "B_w_up": _B_in["w_up"],
        "B_w_down": _B_in["w_down"],
    }

def reference(A_u, A_log_A_real, A_A_imag, A_C_real, A_C_imag, A_log_dt, A_D_skip, B_x, B_w_gate, B_w_up, B_w_down):
    def _A_ref(u, log_A_real, A_imag, C_real, C_imag, log_dt, D_skip):
        L = u.shape[1]
        dt = torch.exp(log_dt)
        A = -torch.exp(log_A_real) + 1j * A_imag
        C = (C_real + 1j * C_imag) * dt[:, None]
        pos = (lambda x, dt: x.to(dt))(torch.arange(L), log_dt.dtype)
        P = torch.exp((A * dt[:, None])[:, :, None] * pos[None, None, :])
        K = 2.0 * torch.einsum("dn,dnl->dl", C, P).real
        L2 = 2 * L
        u_t = (lambda x, *d: x.permute(*d))(u, 0, 2, 1)
        Kf = (lambda x, *a, **k: torch.fft.rfft(x.float(), *a, **k))(K, L2)
        Uf = (lambda x, *a, **k: torch.fft.rfft(x.float(), *a, **k))(u_t, L2)
        y = (lambda x, *a, **k: torch.fft.irfft(x, *a, **k).to(torch.bfloat16))(Uf * Kf[None, :, :], L2)[:, :, :L]
        y = (lambda x, *d: x.permute(*d))(y, 0, 2, 1)
        return y + u * D_skip[None, None, :]

    def _B_ref(x, w_gate, w_up, w_down):
        return (_gelu(x @ w_gate) * (x @ w_up)) @ w_down

    x = A_u
    h = x + _A_ref(_layernorm(x, axis=-1), A_log_A_real, A_A_imag, A_C_real, A_C_imag, A_log_dt, A_D_skip)
    h2 = h + _B_ref(_layernorm(h, axis=-1), B_w_gate, B_w_up, B_w_down)
    return h2
```

```asm
; @launch kernel=k1_kernel grid=(976,1,1) block=(256,1,1) lds=40960
; @launch kernel=k4_kernel grid=(256,1,1) block=(512,1,1) lds=142144
; @launch kernel=k5_kernel grid=(256,1,1) block=(512,1,1) lds=147456
.amdgcn_target "amdgcn-amd-amdhsa--gfx950"
.text
.globl k1_kernel
.p2align 8
.type k1_kernel,@function
k1_kernel:
    s_load_dwordx16 s[16:31], s[0:1], 0
    s_load_dwordx8 s[32:39], s[0:1], 64
    s_load_dwordx4 s[40:43], s[0:1], 96
    s_cmp_ge_u32 s2, 256
    s_cbranch_scc1 L_k1_other
    s_setprio 3
L_ln1:
    s_sub_u32 s3, s2, 0
    s_and_b32 s12, s2, 7
    s_lshl_b32 s12, s12, 5
    s_lshr_b32 s13, s3, 3
    s_add_u32 s12, s12, s13
    s_mul_i32 s13, s12, 9216
    v_and_b32 v1, 31, v0
    v_lshrrev_b32 v2, 5, v0
    v_mul_u32_u24 v3, 1152, v2
    v_lshl_add_u32 v3, v1, 2, v3
    v_mul_u32_u24 v4, 1216, v2
    v_lshl_add_u32 v4, v1, 2, v4
    v_lshrrev_b32 v5, 6, v0
    s_nop 0
    v_readfirstlane_b32 s14, v5
    s_waitcnt lgkmcnt(0)
    s_mov_b32 s8, s16
    s_and_b32 s9, s17, 0xffff
    s_mov_b32 s10, 2359296
    s_mov_b32 s11, 0x20000
    buffer_load_dword v10, v3, s[8:11], s13 offen offset:0
    buffer_load_dword v11, v3, s[8:11], s13 offen offset:128
    buffer_load_dword v12, v3, s[8:11], s13 offen offset:256
    buffer_load_dword v13, v3, s[8:11], s13 offen offset:384
    buffer_load_dword v14, v3, s[8:11], s13 offen offset:512
    buffer_load_dword v15, v3, s[8:11], s13 offen offset:640
    buffer_load_dword v16, v3, s[8:11], s13 offen offset:768
    buffer_load_dword v17, v3, s[8:11], s13 offen offset:896
    buffer_load_dword v18, v3, s[8:11], s13 offen offset:1024
    s_getpc_b64 s[4:5]
L_pf_k1a:
    s_sub_u32 s4, s4, L_pf_k1a-k1_kernel
    s_subb_u32 s5, s5, 0
    v_lshlrev_b32 v126, 4, v0
    s_mov_b32 s6, 0
    s_mov_b32 s7, L_k1_end-k1_kernel-4
L_pf_k1a_l:
    v_min_u32 v125, s7, v126
    global_load_dword v127, v125, s[4:5]
    v_add_u32 v126, 4096, v126
    s_add_u32 s6, s6, 4096
    s_cmp_lt_u32 s6, s7
    s_cbranch_scc1 L_pf_k1a_l
    s_mov_b32 s4, s42
    s_and_b32 s5, s43, 0xffff
    s_mov_b32 s6, 4718592
    s_mov_b32 s7, 0x20000
    v_and_b32 v6, 63, v0
    v_bfe_u32 v7, v6, 2, 2
    v_mul_u32_u24 v7, 1216, v7
    v_lshrrev_b32 v8, 4, v6
    v_lshl_add_u32 v7, v8, 5, v7
    v_and_b32 v8, 3, v6
    v_lshl_add_u32 v7, v8, 3, v7
    v_lshlrev_b32 v9, 4, v6
    s_mul_i32 s15, s12, 9216
    s_add_u32 s50, s14, 0
    s_cmp_ge_u32 s50, 9
    s_cselect_b32 s51, 1, 0
    s_mul_i32 s52, s51, 9
    s_sub_u32 s52, s50, s52
    s_mul_i32 s53, s51, 9728
    s_lshl_b32 s54, s52, 7
    s_add_u32 s53, s53, s54
    s_mul_i32 s54, s51, 2359296
    s_lshl_b32 s55, s52, 10
    s_add_u32 s54, s54, s55
    s_add_u32 s58, s54, s15
    v_add_u32 v60, s53, v7
    s_add_u32 s50, s14, 4
    s_cmp_ge_u32 s50, 9
    s_cselect_b32 s51, 1, 0
    s_mul_i32 s52, s51, 9
    s_sub_u32 s52, s50, s52
    s_mul_i32 s53, s51, 9728
    s_lshl_b32 s54, s52, 7
    s_add_u32 s53, s53, s54
    s_mul_i32 s54, s51, 2359296
    s_lshl_b32 s55, s52, 10
    s_add_u32 s54, s54, s55
    s_add_u32 s59, s54, s15
    v_add_u32 v61, s53, v7
    s_add_u32 s50, s14, 8
    s_cmp_ge_u32 s50, 9
    s_cselect_b32 s51, 1, 0
    s_mul_i32 s52, s51, 9
    s_sub_u32 s52, s50, s52
    s_mul_i32 s53, s51, 9728
    s_lshl_b32 s54, s52, 7
    s_add_u32 s53, s53, s54
    s_mul_i32 s54, s51, 2359296
    s_lshl_b32 s55, s52, 10
    s_add_u32 s54, s54, s55
    s_add_u32 s60, s54, s15
    v_add_u32 v62, s53, v7
    s_add_u32 s50, s14, 12
    s_cmp_ge_u32 s50, 9
    s_cselect_b32 s51, 1, 0
    s_mul_i32 s52, s51, 9
    s_sub_u32 s52, s50, s52
    s_mul_i32 s53, s51, 9728
    s_lshl_b32 s54, s52, 7
    s_add_u32 s53, s53, s54
    s_mul_i32 s54, s51, 2359296
    s_lshl_b32 s55, s52, 10
    s_add_u32 s54, s54, s55
    s_add_u32 s61, s54, s15
    v_add_u32 v63, s53, v7
    s_add_u32 s50, s14, 16
    s_cmp_ge_u32 s50, 9
    s_cselect_b32 s51, 1, 0
    s_mul_i32 s52, s51, 9
    s_sub_u32 s52, s50, s52
    s_mul_i32 s53, s51, 9728
    s_lshl_b32 s54, s52, 7
    s_add_u32 s53, s53, s54
    s_mul_i32 s54, s51, 2359296
    s_lshl_b32 s55, s52, 10
    s_add_u32 s54, s54, s55
    s_add_u32 s62, s54, s15
    v_add_u32 v64, s53, v7
    v_and_b32 v65, 7, v0
    v_bfe_u32 v66, v0, 3, 1
    v_mul_u32_u24 v66, 8192, v66
    v_lshl_add_u32 v65, v65, 2, v66
    s_lshl_b32 s44, s12, 5
    s_add_u32 s44, s44, 11888640
    s_add_u32 s44, s42, s44
    s_addc_u32 s45, s43, 0
    v_mov_b32 v66, 0
    v_cmp_gt_u32 vcc, 16, v0
    s_nop 3
    s_and_saveexec_b64 s[46:47], vcc
    s_cbranch_execz L_ln1_z
    global_store_dword v65, v66, s[44:45]
    v_and_b32 v65, 3, v0
    v_lshlrev_b32 v65, 2, v65
    s_lshl_b32 s48, s12, 4
    s_add_u32 s48, s48, 65581056
    s_add_u32 s48, s42, s48
    s_addc_u32 s49, s43, 0
    global_store_dword v65, v66, s[48:49]
L_ln1_z:
    s_mov_b64 exec, s[46:47]
    s_waitcnt vmcnt(0)
    ds_write_b32 v4, v10 offset:9728
    ds_write_b32 v4, v11 offset:9856
    ds_write_b32 v4, v12 offset:9984
    ds_write_b32 v4, v13 offset:10112
    ds_write_b32 v4, v14 offset:10240
    ds_write_b32 v4, v15 offset:10368
    ds_write_b32 v4, v16 offset:10496
    ds_write_b32 v4, v17 offset:10624
    ds_write_b32 v4, v18 offset:10752
    v_lshlrev_b32 v20, 16, v10
    v_and_b32 v21, 0xffff0000, v10
    v_lshlrev_b32 v22, 16, v11
    v_and_b32 v23, 0xffff0000, v11
    v_lshlrev_b32 v24, 16, v12
    v_and_b32 v25, 0xffff0000, v12
    v_lshlrev_b32 v26, 16, v13
    v_and_b32 v27, 0xffff0000, v13
    v_lshlrev_b32 v28, 16, v14
    v_and_b32 v29, 0xffff0000, v14
    v_lshlrev_b32 v30, 16, v15
    v_and_b32 v31, 0xffff0000, v15
    v_lshlrev_b32 v32, 16, v16
    v_and_b32 v33, 0xffff0000, v16
    v_lshlrev_b32 v34, 16, v17
    v_and_b32 v35, 0xffff0000, v17
    v_lshlrev_b32 v36, 16, v18
    v_and_b32 v37, 0xffff0000, v18
    v_pk_add_f32 v[50:51], v[20:21], v[22:23]
    v_pk_add_f32 v[52:53], v[24:25], v[26:27]
    v_pk_add_f32 v[50:51], v[50:51], v[28:29]
    v_pk_add_f32 v[52:53], v[52:53], v[30:31]
    v_pk_add_f32 v[50:51], v[50:51], v[32:33]
    v_pk_add_f32 v[52:53], v[52:53], v[34:35]
    v_pk_add_f32 v[50:51], v[50:51], v[36:37]
    v_pk_add_f32 v[50:51], v[50:51], v[52:53]
    v_add_f32 v50, v50, v51
    s_nop 1
    v_add_f32_dpp v52, v50, v50 quad_perm:[1,0,3,2] row_mask:0xf bank_mask:0xf
    s_nop 1
    v_add_f32_dpp v50, v52, v52 quad_perm:[2,3,0,1] row_mask:0xf bank_mask:0xf
    s_nop 1
    v_add_f32_dpp v52, v50, v50 row_half_mirror row_mask:0xf bank_mask:0xf
    s_nop 1
    v_add_f32_dpp v50, v52, v52 row_mirror row_mask:0xf bank_mask:0xf
    v_mov_b32 v52, v50
    s_nop 1
    v_permlane16_swap_b32 v50, v52
    v_add_f32 v50, v50, v52
    v_mul_f32 v54, 0xbae38e39, v50
    v_mov_b32 v55, v54
    v_pk_add_f32 v[52:53], v[20:21], v[54:55]
    v_pk_mul_f32 v[50:51], v[52:53], v[52:53]
    v_pk_add_f32 v[56:57], v[22:23], v[54:55]
    v_pk_fma_f32 v[50:51], v[56:57], v[56:57], v[50:51]
    v_pk_add_f32 v[52:53], v[24:25], v[54:55]
    v_pk_fma_f32 v[50:51], v[52:53], v[52:53], v[50:51]
    v_pk_add_f32 v[56:57], v[26:27], v[54:55]
    v_pk_fma_f32 v[50:51], v[56:57], v[56:57], v[50:51]
    v_pk_add_f32 v[52:53], v[28:29], v[54:55]
    v_pk_fma_f32 v[50:51], v[52:53], v[52:53], v[50:51]
    v_pk_add_f32 v[56:57], v[30:31], v[54:55]
    v_pk_fma_f32 v[50:51], v[56:57], v[56:57], v[50:51]
    v_pk_add_f32 v[52:53], v[32:33], v[54:55]
    v_pk_fma_f32 v[50:51], v[52:53], v[52:53], v[50:51]
    v_pk_add_f32 v[56:57], v[34:35], v[54:55]
    v_pk_fma_f32 v[50:51], v[56:57], v[56:57], v[50:51]
    v_pk_add_f32 v[52:53], v[36:37], v[54:55]
    v_pk_fma_f32 v[50:51], v[52:53], v[52:53], v[50:51]
    v_add_f32 v50, v50, v51
    s_nop 1
    v_add_f32_dpp v52, v50, v50 quad_perm:[1,0,3,2] row_mask:0xf bank_mask:0xf
    s_nop 1
    v_add_f32_dpp v50, v52, v52 quad_perm:[2,3,0,1] row_mask:0xf bank_mask:0xf
    s_nop 1
    v_add_f32_dpp v52, v50, v50 row_half_mirror row_mask:0xf bank_mask:0xf
    s_nop 1
    v_add_f32_dpp v50, v52, v52 row_mirror row_mask:0xf bank_mask:0xf
    v_mov_b32 v52, v50
    s_nop 1
    v_permlane16_swap_b32 v50, v52
    v_add_f32 v50, v50, v52
    v_mul_f32 v50, 0x3ae38e39, v50
    v_cvt_pk_bf16_f32 v52, v54, v50
    v_lshlrev_b32 v54, 16, v52
    v_and_b32 v50, 0xffff0000, v52
    v_mov_b32 v55, v54
    v_add_f32 v50, 0x3727c5ac, v50
    v_cvt_pk_bf16_f32 v52, v50, v50
    v_lshlrev_b32 v50, 16, v52
    v_sqrt_f32 v50, v50
    s_nop 0
    v_cvt_pk_bf16_f32 v52, v50, v50
    v_lshlrev_b32 v50, 16, v52
    v_rcp_f32 v56, v50
    s_nop 0
    v_mov_b32 v57, v56
    v_pk_add_f32 v[20:21], v[20:21], v[54:55]
    v_pk_add_f32 v[22:23], v[22:23], v[54:55]
    v_pk_add_f32 v[24:25], v[24:25], v[54:55]
    v_pk_add_f32 v[26:27], v[26:27], v[54:55]
    v_pk_add_f32 v[28:29], v[28:29], v[54:55]
    v_pk_add_f32 v[30:31], v[30:31], v[54:55]
    v_pk_add_f32 v[32:33], v[32:33], v[54:55]
    v_pk_add_f32 v[34:35], v[34:35], v[54:55]
    v_pk_add_f32 v[36:37], v[36:37], v[54:55]
    v_cvt_pk_bf16_f32 v21, v20, v21
    v_cvt_pk_bf16_f32 v23, v22, v23
    v_cvt_pk_bf16_f32 v25, v24, v25
    v_cvt_pk_bf16_f32 v27, v26, v27
    v_cvt_pk_bf16_f32 v29, v28, v29
    v_cvt_pk_bf16_f32 v31, v30, v31
    v_cvt_pk_bf16_f32 v33, v32, v33
    v_cvt_pk_bf16_f32 v35, v34, v35
    v_cvt_pk_bf16_f32 v37, v36, v37
    v_lshlrev_b32 v20, 16, v21
    v_and_b32 v21, 0xffff0000, v21
    v_lshlrev_b32 v22, 16, v23
    v_and_b32 v23, 0xffff0000, v23
    v_lshlrev_b32 v24, 16, v25
    v_and_b32 v25, 0xffff0000, v25
    v_lshlrev_b32 v26, 16, v27
    v_and_b32 v27, 0xffff0000, v27
    v_lshlrev_b32 v28, 16, v29
    v_and_b32 v29, 0xffff0000, v29
    v_lshlrev_b32 v30, 16, v31
    v_and_b32 v31, 0xffff0000, v31
    v_lshlrev_b32 v32, 16, v33
    v_and_b32 v33, 0xffff0000, v33
    v_lshlrev_b32 v34, 16, v35
    v_and_b32 v35, 0xffff0000, v35
    v_lshlrev_b32 v36, 16, v37
    v_and_b32 v37, 0xffff0000, v37
    v_pk_mul_f32 v[20:21], v[20:21], v[56:57]
    v_pk_mul_f32 v[22:23], v[22:23], v[56:57]
    v_pk_mul_f32 v[24:25], v[24:25], v[56:57]
    v_pk_mul_f32 v[26:27], v[26:27], v[56:57]
    v_pk_mul_f32 v[28:29], v[28:29], v[56:57]
    v_pk_mul_f32 v[30:31], v[30:31], v[56:57]
    v_pk_mul_f32 v[32:33], v[32:33], v[56:57]
    v_pk_mul_f32 v[34:35], v[34:35], v[56:57]
    v_pk_mul_f32 v[36:37], v[36:37], v[56:57]
    v_cvt_pk_bf16_f32 v40, v20, v21
    v_cvt_pk_bf16_f32 v41, v22, v23
    v_cvt_pk_bf16_f32 v42, v24, v25
    v_cvt_pk_bf16_f32 v43, v26, v27
    v_cvt_pk_bf16_f32 v44, v28, v29
    v_cvt_pk_bf16_f32 v45, v30, v31
    v_cvt_pk_bf16_f32 v46, v32, v33
    v_cvt_pk_bf16_f32 v47, v34, v35
    v_cvt_pk_bf16_f32 v48, v36, v37
    ds_write_b32 v4, v40 offset:0
    ds_write_b32 v4, v41 offset:128
    ds_write_b32 v4, v42 offset:256
    ds_write_b32 v4, v43 offset:384
    ds_write_b32 v4, v44 offset:512
    ds_write_b32 v4, v45 offset:640
    ds_write_b32 v4, v46 offset:768
    ds_write_b32 v4, v47 offset:896
    ds_write_b32 v4, v48 offset:1024
    s_waitcnt lgkmcnt(0)
    s_barrier
    ds_read_b64_tr_b16 v[20:21], v60
    ds_read_b64_tr_b16 v[22:23], v60 offset:4864
    ds_read_b64_tr_b16 v[24:25], v61
    ds_read_b64_tr_b16 v[26:27], v61 offset:4864
    ds_read_b64_tr_b16 v[28:29], v62
    ds_read_b64_tr_b16 v[30:31], v62 offset:4864
    ds_read_b64_tr_b16 v[32:33], v63
    ds_read_b64_tr_b16 v[34:35], v63 offset:4864
    s_cmp_ge_u32 s14, 2
    s_cbranch_scc1 L_ln1_four
    ds_read_b64_tr_b16 v[36:37], v64
    ds_read_b64_tr_b16 v[38:39], v64 offset:4864
    s_waitcnt lgkmcnt(0)
    buffer_store_dwordx4 v[36:39], v9, s[4:7], s62 offen sc1
L_ln1_four:
    s_waitcnt lgkmcnt(0)
    buffer_store_dwordx4 v[20:23], v9, s[4:7], s58 offen sc1
    buffer_store_dwordx4 v[24:27], v9, s[4:7], s59 offen sc1
    buffer_store_dwordx4 v[28:31], v9, s[4:7], s60 offen sc1
    buffer_store_dwordx4 v[32:35], v9, s[4:7], s61 offen sc1
    s_waitcnt vmcnt(0)
    s_barrier
    s_cmp_eq_u32 s14, 0
    s_cbranch_scc0 L_ln1_nosig
    s_and_b32 s44, s12, 3
    s_lshl_b32 s44, s44, 6
    s_add_u32 s44, s44, 64
    s_and_b32 s44, s44, 255
    s_add_u32 s44, s44, 4
    v_mov_b32 v20, s44
    v_mov_b32 v21, 1
    s_mov_b64 exec, 1
    global_atomic_add v22, v20, v21, s[40:41] sc0
    s_waitcnt vmcnt(0)
    v_readfirstlane_b32 s45, v22
    s_nop 3
    s_cmp_eq_u32 s45, 63
    s_cbranch_scc0 L_ln1_notlast
    v_mov_b32 v20, 0
    global_atomic_add v22, v20, v21, s[40:41] sc0
    s_waitcnt vmcnt(0)
    v_readfirstlane_b32 s45, v22
    s_nop 3
    s_cmp_eq_u32 s45, 3
    s_cbranch_scc0 L_ln1_notlast
    s_mov_b64 exec, -1
    v_and_b32 v20, 63, v0
    v_lshlrev_b32 v20, 7, v20
    s_add_u32 s46, s42, 65585152
    s_addc_u32 s47, s43, 0
    global_load_dword v22, v20, s[46:47] sc1
    s_waitcnt vmcnt(0)
    v_add_u32 v22, 1, v22
    global_store_dword v20, v22, s[46:47] sc1
L_ln1_notlast:
    s_mov_b64 exec, -1
L_ln1_nosig:
    s_endpgm
L_k1_other:
    s_cmp_lt_u32 s2, 832
    s_cbranch_scc1 L_kgen
    s_cmp_lt_u32 s2, 976
    s_cbranch_scc1 L_colsumFull
    s_endpgm
L_kgen:
    s_sub_u32 s3, s2, 256
    s_and_b32 s12, s3, 7
    s_mul_i32 s12, s12, 72
    s_lshr_b32 s3, s3, 3
    s_add_u32 s12, s12, s3
    s_getpc_b64 s[10:11]
L_kgen_pc:
    s_add_u32 s10, s10, idx_table-L_kgen_pc
    s_addc_u32 s11, s11, 0
    v_and_b32 v1, 63, v0
    v_lshrrev_b32 v2, 6, v0
    v_and_b32 v3, 15, v1
    v_lshrrev_b32 v4, 4, v1
    v_lshlrev_b32 v5, 4, v0
    global_load_dwordx4 v[96:99], v5, s[10:11]
    global_load_dwordx2 v[100:101], v5, s[10:11] offset:16
    s_lshl_b32 s13, s12, 8
    v_lshlrev_b32 v6, 6, v2
    v_lshl_add_u32 v6, v4, 3, v6
    v_bfe_u32 v7, v3, 2, 1
    v_lshl_add_u32 v6, v7, 5, v6
    v_and_b32 v7, 3, v3
    v_lshl_add_u32 v6, v7, 1, v6
    v_add_u32 v6, s13, v6
    s_lshl_b32 s14, s12, 1
    v_mov_b32 v7, s14
    v_cvt_f32_u32 v29, v3
    v_lshlrev_b32 v28, 4, v3
    v_cmp_eq_u32 s[44:45], 0, v3
    v_mov_b32 v30, 0x100
    s_nop 0
    v_cndmask_b32 v28, v28, v30, s[44:45]
    v_cvt_f32_u32 v28, v28
    v_readfirstlane_b32 s46, v2
    s_waitcnt lgkmcnt(0)
    global_load_ushort v31, v7, s[26:27]
    global_load_ushort v102, v7, s[28:29]
    s_and_b32 s56, s3, 63
    s_lshl_b32 s56, s56, 7
    s_add_u32 s56, s56, 65585152
    s_add_u32 s56, s42, s56
    s_addc_u32 s57, s43, 0
    v_mov_b32 v103, 0
    global_load_dword v104, v103, s[56:57] sc1
    s_waitcnt vmcnt(0)
    global_load_dword v105, v103, s[40:41] sc1
    global_load_ushort v12, v6, s[18:19]
    global_load_ushort v13, v6, s[20:21]
    global_load_ushort v14, v6, s[22:23]
    global_load_ushort v15, v6, s[24:25]
    s_setprio 1
    s_waitcnt vmcnt(0)
    v_lshlrev_b32 v31, 16, v31
    v_lshlrev_b32 v12, 16, v12
    v_mul_f32 v31, 0x3fb8aa3b, v31
    v_mul_f32 v12, 0x3fb8aa3b, v12
    v_exp_f32 v31, v31
    v_exp_f32 v12, v12
    v_lshlrev_b32 v13, 16, v13
    v_cvt_pk_bf16_f32 v31, v31, v12
    v_lshlrev_b32 v14, 16, v14
    v_and_b32 v12, 0xffff0000, v31
    v_lshlrev_b32 v31, 16, v31
    v_lshlrev_b32 v15, 16, v15
    v_mul_f32 v12, v12, v31
    v_mul_f32 v13, v13, v31
    v_mul_f32 v14, v14, v31
    v_mul_f32 v15, v15, v31
    v_mul_f32 v12, 0xbfb8aa3b, v12
    v_mul_f32 v13, 0x3e22f983, v13
    s_nop 1
    v_mul_f32_dpp v87, v13, v28 row_newbcast:0 row_mask:0xf bank_mask:0xf
    v_mul_f32_dpp v91, v13, v29 row_newbcast:0 row_mask:0xf bank_mask:0xf
    v_mul_f32_dpp v86, v12, v28 row_newbcast:0 row_mask:0xf bank_mask:0xf
    v_mul_f32_dpp v90, v12, v29 row_newbcast:0 row_mask:0xf bank_mask:0xf
    v_fract_f32 v87, v87
    v_fract_f32 v91, v91
    v_exp_f32 v86, v86
    v_exp_f32 v90, v90
    v_cos_f32 v88, v87
    v_sin_f32 v89, v87
    v_cos_f32 v92, v91
    v_sin_f32 v93, v91
    v_mov_b32_dpp v80, v14 row_newbcast:0 row_mask:0xf bank_mask:0xf
    v_mov_b32_dpp v81, v15 row_newbcast:0 row_mask:0xf bank_mask:0xf
    v_pk_mul_f32 v[82:83], v[88:89], v[86:87] op_sel:[0,0] op_sel_hi:[1,0]
    v_pk_mul_f32 v[84:85], v[92:93], v[90:91] op_sel:[0,0] op_sel_hi:[1,0]
    v_cndmask_b32 v86, v82, 1.0, s[44:45]
    v_cndmask_b32 v87, v83, 0, s[44:45]
    v_cvt_pk_bf16_f32 v48, v84, v85
    v_pk_mul_f32 v[88:89], v[86:87], v[80:81] op_sel:[0,0] op_sel_hi:[1,0] neg_hi:[1,0]
    v_pk_fma_f32 v[90:91], v[86:87], v[80:81], v[88:89] op_sel:[1,1,0] op_sel_hi:[0,1,1] neg_lo:[1,0,0] neg_hi:[1,0,0]
    v_cvt_pk_bf16_f32 v32, v90, v91
    v_pk_mul_f32 v[88:89], v[82:83], v[82:83] op_sel:[0,0] op_sel_hi:[1,0]
    v_pk_mul_f32 v[92:93], v[84:85], v[84:85] op_sel:[0,0] op_sel_hi:[1,0]
    v_pk_fma_f32 v[82:83], v[82:83], v[82:83], v[88:89] op_sel:[1,1,0] op_sel_hi:[0,1,1] neg_lo:[1,0,0]
    v_pk_fma_f32 v[84:85], v[84:85], v[84:85], v[92:93] op_sel:[1,1,0] op_sel_hi:[0,1,1] neg_lo:[1,0,0]
    v_cvt_pk_bf16_f32 v52, v84, v85
    v_pk_mul_f32 v[88:89], v[82:83], v[80:81] op_sel:[0,0] op_sel_hi:[1,0] neg_hi:[1,0]
    v_pk_fma_f32 v[90:91], v[82:83], v[80:81], v[88:89] op_sel:[1,1,0] op_sel_hi:[0,1,1] neg_lo:[1,0,0] neg_hi:[1,0,0]
    v_cvt_pk_bf16_f32 v36, v90, v91
    v_pk_mul_f32 v[88:89], v[82:83], v[82:83] op_sel:[0,0] op_sel_hi:[1,0]
    v_pk_mul_f32 v[92:93], v[84:85], v[84:85] op_sel:[0,0] op_sel_hi:[1,0]
    v_pk_fma_f32 v[82:83], v[82:83], v[82:83], v[88:89] op_sel:[1,1,0] op_sel_hi:[0,1,1] neg_lo:[1,0,0]
    v_pk_fma_f32 v[84:85], v[84:85], v[84:85], v[92:93] op_sel:[1,1,0] op_sel_hi:[0,1,1] neg_lo:[1,0,0]
    v_cvt_pk_bf16_f32 v56, v84, v85
    v_pk_mul_f32 v[88:89], v[82:83], v[80:81] op_sel:[0,0] op_sel_hi:[1,0] neg_hi:[1,0]
    v_pk_fma_f32 v[90:91], v[82:83], v[80:81], v[88:89] op_sel:[1,1,0] op_sel_hi:[0,1,1] neg_lo:[1,0,0] neg_hi:[1,0,0]
    v_cvt_pk_bf16_f32 v40, v90, v91
    v_pk_mul_f32 v[88:89], v[82:83], v[82:83] op_sel:[0,0] op_sel_hi:[1,0]
    v_pk_mul_f32 v[92:93], v[84:85], v[84:85] op_sel:[0,0] op_sel_hi:[1,0]
    v_pk_fma_f32 v[82:83], v[82:83], v[82:83], v[88:89] op_sel:[1,1,0] op_sel_hi:[0,1,1] neg_lo:[1,0,0]
    v_pk_fma_f32 v[84:85], v[84:85], v[84:85], v[92:93] op_sel:[1,1,0] op_sel_hi:[0,1,1] neg_lo:[1,0,0]
    v_cvt_pk_bf16_f32 v60, v84, v85
    v_pk_mul_f32 v[88:89], v[82:83], v[80:81] op_sel:[0,0] op_sel_hi:[1,0] neg_hi:[1,0]
    v_pk_fma_f32 v[90:91], v[82:83], v[80:81], v[88:89] op_sel:[1,1,0] op_sel_hi:[0,1,1] neg_lo:[1,0,0] neg_hi:[1,0,0]
    v_cvt_pk_bf16_f32 v44, v90, v91
    v_mul_f32_dpp v87, v13, v28 row_newbcast:1 row_mask:0xf bank_mask:0xf
    v_mul_f32_dpp v91, v13, v29 row_newbcast:1 row_mask:0xf bank_mask:0xf
    v_mul_f32_dpp v86, v12, v28 row_newbcast:1 row_mask:0xf bank_mask:0xf
    v_mul_f32_dpp v90, v12, v29 row_newbcast:1 row_mask:0xf bank_mask:0xf
    v_fract_f32 v87, v87
    v_fract_f32 v91, v91
    v_exp_f32 v86, v86
    v_exp_f32 v90, v90
    v_cos_f32 v88, v87
    v_sin_f32 v89, v87
    v_cos_f32 v92, v91
    v_sin_f32 v93, v91
    v_mov_b32_dpp v80, v14 row_newbcast:1 row_mask:0xf bank_mask:0xf
    v_mov_b32_dpp v81, v15 row_newbcast:1 row_mask:0xf bank_mask:0xf
    v_pk_mul_f32 v[82:83], v[88:89], v[86:87] op_sel:[0,0] op_sel_hi:[1,0]
    v_pk_mul_f32 v[84:85], v[92:93], v[90:91] op_sel:[0,0] op_sel_hi:[1,0]
    v_cndmask_b32 v86, v82, 1.0, s[44:45]
    v_cndmask_b32 v87, v83, 0, s[44:45]
    v_cvt_pk_bf16_f32 v49, v84, v85
    v_pk_mul_f32 v[88:89], v[86:87], v[80:81] op_sel:[0,0] op_sel_hi:[1,0] neg_hi:[1,0]
    v_pk_fma_f32 v[90:91], v[86:87], v[80:81], v[88:89] op_sel:[1,1,0] op_sel_hi:[0,1,1] neg_lo:[1,0,0] neg_hi:[1,0,0]
    v_cvt_pk_bf16_f32 v33, v90, v91
    v_pk_mul_f32 v[88:89], v[82:83], v[82:83] op_sel:[0,0] op_sel_hi:[1,0]
    v_pk_mul_f32 v[92:93], v[84:85], v[84:85] op_sel:[0,0] op_sel_hi:[1,0]
    v_pk_fma_f32 v[82:83], v[82:83], v[82:83], v[88:89] op_sel:[1,1,0] op_sel_hi:[0,1,1] neg_lo:[1,0,0]
    v_pk_fma_f32 v[84:85], v[84:85], v[84:85], v[92:93] op_sel:[1,1,0] op_sel_hi:[0,1,1] neg_lo:[1,0,0]
    v_cvt_pk_bf16_f32 v53, v84, v85
    v_pk_mul_f32 v[88:89], v[82:83], v[80:81] op_sel:[0,0] op_sel_hi:[1,0] neg_hi:[1,0]
    v_pk_fma_f32 v[90:91], v[82:83], v[80:81], v[88:89] op_sel:[1,1,0] op_sel_hi:[0,1,1] neg_lo:[1,0,0] neg_hi:[1,0,0]
    v_cvt_pk_bf16_f32 v37, v90, v91
    v_pk_mul_f32 v[88:89], v[82:83], v[82:83] op_sel:[0,0] op_sel_hi:[1,0]
    v_pk_mul_f32 v[92:93], v[84:85], v[84:85] op_sel:[0,0] op_sel_hi:[1,0]
    v_pk_fma_f32 v[82:83], v[82:83], v[82:83], v[88:89] op_sel:[1,1,0] op_sel_hi:[0,1,1] neg_lo:[1,0,0]
    v_pk_fma_f32 v[84:85], v[84:85], v[84:85], v[92:93] op_sel:[1,1,0] op_sel_hi:[0,1,1] neg_lo:[1,0,0]
    v_cvt_pk_bf16_f32 v57, v84, v85
    v_pk_mul_f32 v[88:89], v[82:83], v[80:81] op_sel:[0,0] op_sel_hi:[1,0] neg_hi:[1,0]
    v_pk_fma_f32 v[90:91], v[82:83], v[80:81], v[88:89] op_sel:[1,1,0] op_sel_hi:[0,1,1] neg_lo:[1,0,0] neg_hi:[1,0,0]
    v_cvt_pk_bf16_f32 v41, v90, v91
    v_pk_mul_f32 v[88:89], v[82:83], v[82:83] op_sel:[0,0] op_sel_hi:[1,0]
    v_pk_mul_f32 v[92:93], v[84:85], v[84:85] op_sel:[0,0] op_sel_hi:[1,0]
    v_pk_fma_f32 v[82:83], v[82:83], v[82:83], v[88:89] op_sel:[1,1,0] op_sel_hi:[0,1,1] neg_lo:[1,0,0]
    v_pk_fma_f32 v[84:85], v[84:85], v[84:85], v[92:93] op_sel:[1,1,0] op_sel_hi:[0,1,1] neg_lo:[1,0,0]
    v_cvt_pk_bf16_f32 v61, v84, v85
    v_pk_mul_f32 v[88:89], v[82:83], v[80:81] op_sel:[0,0] op_sel_hi:[1,0] neg_hi:[1,0]
    v_pk_fma_f32 v[90:91], v[82:83], v[80:81], v[88:89] op_sel:[1,1,0] op_sel_hi:[0,1,1] neg_lo:[1,0,0] neg_hi:[1,0,0]
    v_cvt_pk_bf16_f32 v45, v90, v91
    v_mul_f32_dpp v87, v13, v28 row_newbcast:2 row_mask:0xf bank_mask:0xf
    v_mul_f32_dpp v91, v13, v29 row_newbcast:2 row_mask:0xf bank_mask:0xf
    v_mul_f32_dpp v86, v12, v28 row_newbcast:2 row_mask:0xf bank_mask:0xf
    v_mul_f32_dpp v90, v12, v29 row_newbcast:2 row_mask:0xf bank_mask:0xf
    v_fract_f32 v87, v87
    v_fract_f32 v91, v91
    v_exp_f32 v86, v86
    v_exp_f32 v90, v90
    v_cos_f32 v88, v87
    v_sin_f32 v89, v87
    v_cos_f32 v92, v91
    v_sin_f32 v93, v91
    v_mov_b32_dpp v80, v14 row_newbcast:2 row_mask:0xf bank_mask:0xf
    v_mov_b32_dpp v81, v15 row_newbcast:2 row_mask:0xf bank_mask:0xf
    v_pk_mul_f32 v[82:83], v[88:89], v[86:87] op_sel:[0,0] op_sel_hi:[1,0]
    v_pk_mul_f32 v[84:85], v[92:93], v[90:91] op_sel:[0,0] op_sel_hi:[1,0]
    v_cndmask_b32 v86, v82, 1.0, s[44:45]
    v_cndmask_b32 v87, v83, 0, s[44:45]
    v_cvt_pk_bf16_f32 v50, v84, v85
    v_pk_mul_f32 v[88:89], v[86:87], v[80:81] op_sel:[0,0] op_sel_hi:[1,0] neg_hi:[1,0]
    v_pk_fma_f32 v[90:91], v[86:87], v[80:81], v[88:89] op_sel:[1,1,0] op_sel_hi:[0,1,1] neg_lo:[1,0,0] neg_hi:[1,0,0]
    v_cvt_pk_bf16_f32 v34, v90, v91
    v_pk_mul_f32 v[88:89], v[82:83], v[82:83] op_sel:[0,0] op_sel_hi:[1,0]
    v_pk_mul_f32 v[92:93], v[84:85], v[84:85] op_sel:[0,0] op_sel_hi:[1,0]
    v_pk_fma_f32 v[82:83], v[82:83], v[82:83], v[88:89] op_sel:[1,1,0] op_sel_hi:[0,1,1] neg_lo:[1,0,0]
    v_pk_fma_f32 v[84:85], v[84:85], v[84:85], v[92:93] op_sel:[1,1,0] op_sel_hi:[0,1,1] neg_lo:[1,0,0]
    v_cvt_pk_bf16_f32 v54, v84, v85
    v_pk_mul_f32 v[88:89], v[82:83], v[80:81] op_sel:[0,0] op_sel_hi:[1,0] neg_hi:[1,0]
    v_pk_fma_f32 v[90:91], v[82:83], v[80:81], v[88:89] op_sel:[1,1,0] op_sel_hi:[0,1,1] neg_lo:[1,0,0] neg_hi:[1,0,0]
    v_cvt_pk_bf16_f32 v38, v90, v91
    v_pk_mul_f32 v[88:89], v[82:83], v[82:83] op_sel:[0,0] op_sel_hi:[1,0]
    v_pk_mul_f32 v[92:93], v[84:85], v[84:85] op_sel:[0,0] op_sel_hi:[1,0]
    v_pk_fma_f32 v[82:83], v[82:83], v[82:83], v[88:89] op_sel:[1,1,0] op_sel_hi:[0,1,1] neg_lo:[1,0,0]
    v_pk_fma_f32 v[84:85], v[84:85], v[84:85], v[92:93] op_sel:[1,1,0] op_sel_hi:[0,1,1] neg_lo:[1,0,0]
    v_cvt_pk_bf16_f32 v58, v84, v85
    v_pk_mul_f32 v[88:89], v[82:83], v[80:81] op_sel:[0,0] op_sel_hi:[1,0] neg_hi:[1,0]
    v_pk_fma_f32 v[90:91], v[82:83], v[80:81], v[88:89] op_sel:[1,1,0] op_sel_hi:[0,1,1] neg_lo:[1,0,0] neg_hi:[1,0,0]
    v_cvt_pk_bf16_f32 v42, v90, v91
    v_pk_mul_f32 v[88:89], v[82:83], v[82:83] op_sel:[0,0] op_sel_hi:[1,0]
    v_pk_mul_f32 v[92:93], v[84:85], v[84:85] op_sel:[0,0] op_sel_hi:[1,0]
    v_pk_fma_f32 v[82:83], v[82:83], v[82:83], v[88:89] op_sel:[1,1,0] op_sel_hi:[0,1,1] neg_lo:[1,0,0]
    v_pk_fma_f32 v[84:85], v[84:85], v[84:85], v[92:93] op_sel:[1,1,0] op_sel_hi:[0,1,1] neg_lo:[1,0,0]
    v_cvt_pk_bf16_f32 v62, v84, v85
    v_pk_mul_f32 v[88:89], v[82:83], v[80:81] op_sel:[0,0] op_sel_hi:[1,0] neg_hi:[1,0]
    v_pk_fma_f32 v[90:91], v[82:83], v[80:81], v[88:89] op_sel:[1,1,0] op_sel_hi:[0,1,1] neg_lo:[1,0,0] neg_hi:[1,0,0]
    v_cvt_pk_bf16_f32 v46, v90, v91
    v_mul_f32_dpp v87, v13, v28 row_newbcast:3 row_mask:0xf bank_mask:0xf
    v_mul_f32_dpp v91, v13, v29 row_newbcast:3 row_mask:0xf bank_mask:0xf
    v_mul_f32_dpp v86, v12, v28 row_newbcast:3 row_mask:0xf bank_mask:0xf
    v_mul_f32_dpp v90, v12, v29 row_newbcast:3 row_mask:0xf bank_mask:0xf
    v_fract_f32 v87, v87
    v_fract_f32 v91, v91
    v_exp_f32 v86, v86
    v_exp_f32 v90, v90
    v_cos_f32 v88, v87
    v_sin_f32 v89, v87
    v_cos_f32 v92, v91
    v_sin_f32 v93, v91
    v_mov_b32_dpp v80, v14 row_newbcast:3 row_mask:0xf bank_mask:0xf
    v_mov_b32_dpp v81, v15 row_newbcast:3 row_mask:0xf bank_mask:0xf
    v_pk_mul_f32 v[82:83], v[88:89], v[86:87] op_sel:[0,0] op_sel_hi:[1,0]
    v_pk_mul_f32 v[84:85], v[92:93], v[90:91] op_sel:[0,0] op_sel_hi:[1,0]
    v_cndmask_b32 v86, v82, 1.0, s[44:45]
    v_cndmask_b32 v87, v83, 0, s[44:45]
    v_cvt_pk_bf16_f32 v51, v84, v85
    v_pk_mul_f32 v[88:89], v[86:87], v[80:81] op_sel:[0,0] op_sel_hi:[1,0] neg_hi:[1,0]
    v_pk_fma_f32 v[90:91], v[86:87], v[80:81], v[88:89] op_sel:[1,1,0] op_sel_hi:[0,1,1] neg_lo:[1,0,0] neg_hi:[1,0,0]
    v_cvt_pk_bf16_f32 v35, v90, v91
    v_pk_mul_f32 v[88:89], v[82:83], v[82:83] op_sel:[0,0] op_sel_hi:[1,0]
    v_pk_mul_f32 v[92:93], v[84:85], v[84:85] op_sel:[0,0] op_sel_hi:[1,0]
    v_pk_fma_f32 v[82:83], v[82:83], v[82:83], v[88:89] op_sel:[1,1,0] op_sel_hi:[0,1,1] neg_lo:[1,0,0]
    v_pk_fma_f32 v[84:85], v[84:85], v[84:85], v[92:93] op_sel:[1,1,0] op_sel_hi:[0,1,1] neg_lo:[1,0,0]
    v_cvt_pk_bf16_f32 v55, v84, v85
    v_pk_mul_f32 v[88:89], v[82:83], v[80:81] op_sel:[0,0] op_sel_hi:[1,0] neg_hi:[1,0]
    v_pk_fma_f32 v[90:91], v[82:83], v[80:81], v[88:89] op_sel:[1,1,0] op_sel_hi:[0,1,1] neg_lo:[1,0,0] neg_hi:[1,0,0]
    v_cvt_pk_bf16_f32 v39, v90, v91
    v_pk_mul_f32 v[88:89], v[82:83], v[82:83] op_sel:[0,0] op_sel_hi:[1,0]
    v_pk_mul_f32 v[92:93], v[84:85], v[84:85] op_sel:[0,0] op_sel_hi:[1,0]
    v_pk_fma_f32 v[82:83], v[82:83], v[82:83], v[88:89] op_sel:[1,1,0] op_sel_hi:[0,1,1] neg_lo:[1,0,0]
    v_pk_fma_f32 v[84:85], v[84:85], v[84:85], v[92:93] op_sel:[1,1,0] op_sel_hi:[0,1,1] neg_lo:[1,0,0]
    v_cvt_pk_bf16_f32 v59, v84, v85
    v_pk_mul_f32 v[88:89], v[82:83], v[80:81] op_sel:[0,0] op_sel_hi:[1,0] neg_hi:[1,0]
    v_pk_fma_f32 v[90:91], v[82:83], v[80:81], v[88:89] op_sel:[1,1,0] op_sel_hi:[0,1,1] neg_lo:[1,0,0] neg_hi:[1,0,0]
    v_cvt_pk_bf16_f32 v43, v90, v91
    v_pk_mul_f32 v[88:89], v[82:83], v[82:83] op_sel:[0,0] op_sel_hi:[1,0]
    v_pk_mul_f32 v[92:93], v[84:85], v[84:85] op_sel:[0,0] op_sel_hi:[1,0]
    v_pk_fma_f32 v[82:83], v[82:83], v[82:83], v[88:89] op_sel:[1,1,0] op_sel_hi:[0,1,1] neg_lo:[1,0,0]
    v_pk_fma_f32 v[84:85], v[84:85], v[84:85], v[92:93] op_sel:[1,1,0] op_sel_hi:[0,1,1] neg_lo:[1,0,0]
    v_cvt_pk_bf16_f32 v63, v84, v85
    v_pk_mul_f32 v[88:89], v[82:83], v[80:81] op_sel:[0,0] op_sel_hi:[1,0] neg_hi:[1,0]
    v_pk_fma_f32 v[90:91], v[82:83], v[80:81], v[88:89] op_sel:[1,1,0] op_sel_hi:[0,1,1] neg_lo:[1,0,0] neg_hi:[1,0,0]
    v_cvt_pk_bf16_f32 v47, v90, v91
    v_mfma_f32_16x16x32_bf16 v[64:67], v[32:35], v[48:51], 0
    v_mfma_f32_16x16x32_bf16 v[68:71], v[36:39], v[52:55], 0
    v_mfma_f32_16x16x32_bf16 v[72:75], v[40:43], v[56:59], 0
    v_mfma_f32_16x16x32_bf16 v[76:79], v[44:47], v[60:63], 0
    v_mul_f32_dpp v87, v13, v28 row_newbcast:4 row_mask:0xf bank_mask:0xf
    v_mul_f32_dpp v91, v13, v29 row_newbcast:4 row_mask:0xf bank_mask:0xf
    v_mul_f32_dpp v86, v12, v28 row_newbcast:4 row_mask:0xf bank_mask:0xf
    v_mul_f32_dpp v90, v12, v29 row_newbcast:4 row_mask:0xf bank_mask:0xf
    v_fract_f32 v87, v87
    v_fract_f32 v91, v91
    v_exp_f32 v86, v86
    v_exp_f32 v90, v90
    v_cos_f32 v88, v87
    v_sin_f32 v89, v87
    v_cos_f32 v92, v91
    v_sin_f32 v93, v91
    v_mov_b32_dpp v80, v14 row_newbcast:4 row_mask:0xf bank_mask:0xf
    v_mov_b32_dpp v81, v15 row_newbcast:4 row_mask:0xf bank_mask:0xf
    v_pk_mul_f32 v[82:83], v[88:89], v[86:87] op_sel:[0,0] op_sel_hi:[1,0]
    v_pk_mul_f32 v[84:85], v[92:93], v[90:91] op_sel:[0,0] op_sel_hi:[1,0]
    v_cndmask_b32 v86, v82, 1.0, s[44:45]
    v_cndmask_b32 v87, v83, 0, s[44:45]
    v_cvt_pk_bf16_f32 v48, v84, v85
    v_pk_mul_f32 v[88:89], v[86:87], v[80:81] op_sel:[0,0] op_sel_hi:[1,0] neg_hi:[1,0]
    v_pk_fma_f32 v[90:91], v[86:87], v[80:81], v[88:89] op_sel:[1,1,0] op_sel_hi:[0,1,1] neg_lo:[1,0,0] neg_hi:[1,0,0]
    v_cvt_pk_bf16_f32 v32, v90, v91
    v_pk_mul_f32 v[88:89], v[82:83], v[82:83] op_sel:[0,0] op_sel_hi:[1,0]
    v_pk_mul_f32 v[92:93], v[84:85], v[84:85] op_sel:[0,0] op_sel_hi:[1,0]
    v_pk_fma_f32 v[82:83], v[82:83], v[82:83], v[88:89] op_sel:[1,1,0] op_sel_hi:[0,1,1] neg_lo:[1,0,0]
    v_pk_fma_f32 v[84:85], v[84:85], v[84:85], v[92:93] op_sel:[1,1,0] op_sel_hi:[0,1,1] neg_lo:[1,0,0]
    v_cvt_pk_bf16_f32 v52, v84, v85
    v_pk_mul_f32 v[88:89], v[82:83], v[80:81] op_sel:[0,0] op_sel_hi:[1,0] neg_hi:[1,0]
    v_pk_fma_f32 v[90:91], v[82:83], v[80:81], v[88:89] op_sel:[1,1,0] op_sel_hi:[0,1,1] neg_lo:[1,0,0] neg_hi:[1,0,0]
    v_cvt_pk_bf16_f32 v36, v90, v91
    v_pk_mul_f32 v[88:89], v[82:83], v[82:83] op_sel:[0,0] op_sel_hi:[1,0]
    v_pk_mul_f32 v[92:93], v[84:85], v[84:85] op_sel:[0,0] op_sel_hi:[1,0]
    v_pk_fma_f32 v[82:83], v[82:83], v[82:83], v[88:89] op_sel:[1,1,0] op_sel_hi:[0,1,1] neg_lo:[1,0,0]
    v_pk_fma_f32 v[84:85], v[84:85], v[84:85], v[92:93] op_sel:[1,1,0] op_sel_hi:[0,1,1] neg_lo:[1,0,0]
    v_cvt_pk_bf16_f32 v56, v84, v85
    v_pk_mul_f32 v[88:89], v[82:83], v[80:81] op_sel:[0,0] op_sel_hi:[1,0] neg_hi:[1,0]
    v_pk_fma_f32 v[90:91], v[82:83], v[80:81], v[88:89] op_sel:[1,1,0] op_sel_hi:[0,1,1] neg_lo:[1,0,0] neg_hi:[1,0,0]
    v_cvt_pk_bf16_f32 v40, v90, v91
    v_pk_mul_f32 v[88:89], v[82:83], v[82:83] op_sel:[0,0] op_sel_hi:[1,0]
    v_pk_mul_f32 v[92:93], v[84:85], v[84:85] op_sel:[0,0] op_sel_hi:[1,0]
    v_pk_fma_f32 v[82:83], v[82:83], v[82:83], v[88:89] op_sel:[1,1,0] op_sel_hi:[0,1,1] neg_lo:[1,0,0]
    v_pk_fma_f32 v[84:85], v[84:85], v[84:85], v[92:93] op_sel:[1,1,0] op_sel_hi:[0,1,1] neg_lo:[1,0,0]
    v_cvt_pk_bf16_f32 v60, v84, v85
    v_pk_mul_f32 v[88:89], v[82:83], v[80:81] op_sel:[0,0] op_sel_hi:[1,0] neg_hi:[1,0]
    v_pk_fma_f32 v[90:91], v[82:83], v[80:81], v[88:89] op_sel:[1,1,0] op_sel_hi:[0,1,1] neg_lo:[1,0,0] neg_hi:[1,0,0]
    v_cvt_pk_bf16_f32 v44, v90, v91
    v_mul_f32_dpp v87, v13, v28 row_newbcast:5 row_mask:0xf bank_mask:0xf
    v_mul_f32_dpp v91, v13, v29 row_newbcast:5 row_mask:0xf bank_mask:0xf
    v_mul_f32_dpp v86, v12, v28 row_newbcast:5 row_mask:0xf bank_mask:0xf
    v_mul_f32_dpp v90, v12, v29 row_newbcast:5 row_mask:0xf bank_mask:0xf
    v_fract_f32 v87, v87
    v_fract_f32 v91, v91
    v_exp_f32 v86, v86
    v_exp_f32 v90, v90
    v_cos_f32 v88, v87
    v_sin_f32 v89, v87
    v_cos_f32 v92, v91
    v_sin_f32 v93, v91
    v_mov_b32_dpp v80, v14 row_newbcast:5 row_mask:0xf bank_mask:0xf
    v_mov_b32_dpp v81, v15 row_newbcast:5 row_mask:0xf bank_mask:0xf
    v_pk_mul_f32 v[82:83], v[88:89], v[86:87] op_sel:[0,0] op_sel_hi:[1,0]
    v_pk_mul_f32 v[84:85], v[92:93], v[90:91] op_sel:[0,0] op_sel_hi:[1,0]
    v_cndmask_b32 v86, v82, 1.0, s[44:45]
    v_cndmask_b32 v87, v83, 0, s[44:45]
    v_cvt_pk_bf16_f32 v49, v84, v85
    v_pk_mul_f32 v[88:89], v[86:87], v[80:81] op_sel:[0,0] op_sel_hi:[1,0] neg_hi:[1,0]
    v_pk_fma_f32 v[90:91], v[86:87], v[80:81], v[88:89] op_sel:[1,1,0] op_sel_hi:[0,1,1] neg_lo:[1,0,0] neg_hi:[1,0,0]
    v_cvt_pk_bf16_f32 v33, v90, v91
    v_pk_mul_f32 v[88:89], v[82:83], v[82:83] op_sel:[0,0] op_sel_hi:[1,0]
    v_pk_mul_f32 v[92:93], v[84:85], v[84:85] op_sel:[0,0] op_sel_hi:[1,0]
    v_pk_fma_f32 v[82:83], v[82:83], v[82:83], v[88:89] op_sel:[1,1,0] op_sel_hi:[0,1,1] neg_lo:[1,0,0]
    v_pk_fma_f32 v[84:85], v[84:85], v[84:85], v[92:93] op_sel:[1,1,0] op_sel_hi:[0,1,1] neg_lo:[1,0,0]
    v_cvt_pk_bf16_f32 v53, v84, v85
    v_pk_mul_f32 v[88:89], v[82:83], v[80:81] op_sel:[0,0] op_sel_hi:[1,0] neg_hi:[1,0]
    v_pk_fma_f32 v[90:91], v[82:83], v[80:81], v[88:89] op_sel:[1,1,0] op_sel_hi:[0,1,1] neg_lo:[1,0,0] neg_hi:[1,0,0]
    v_cvt_pk_bf16_f32 v37, v90, v91
    v_pk_mul_f32 v[88:89], v[82:83], v[82:83] op_sel:[0,0] op_sel_hi:[1,0]
    v_pk_mul_f32 v[92:93], v[84:85], v[84:85] op_sel:[0,0] op_sel_hi:[1,0]
    v_pk_fma_f32 v[82:83], v[82:83], v[82:83], v[88:89] op_sel:[1,1,0] op_sel_hi:[0,1,1] neg_lo:[1,0,0]
    v_pk_fma_f32 v[84:85], v[84:85], v[84:85], v[92:93] op_sel:[1,1,0] op_sel_hi:[0,1,1] neg_lo:[1,0,0]
    v_cvt_pk_bf16_f32 v57, v84, v85
    v_pk_mul_f32 v[88:89], v[82:83], v[80:81] op_sel:[0,0] op_sel_hi:[1,0] neg_hi:[1,0]
    v_pk_fma_f32 v[90:91], v[82:83], v[80:81], v[88:89] op_sel:[1,1,0] op_sel_hi:[0,1,1] neg_lo:[1,0,0] neg_hi:[1,0,0]
    v_cvt_pk_bf16_f32 v41, v90, v91
    v_pk_mul_f32 v[88:89], v[82:83], v[82:83] op_sel:[0,0] op_sel_hi:[1,0]
    v_pk_mul_f32 v[92:93], v[84:85], v[84:85] op_sel:[0,0] op_sel_hi:[1,0]
    v_pk_fma_f32 v[82:83], v[82:83], v[82:83], v[88:89] op_sel:[1,1,0] op_sel_hi:[0,1,1] neg_lo:[1,0,0]
    v_pk_fma_f32 v[84:85], v[84:85], v[84:85], v[92:93] op_sel:[1,1,0] op_sel_hi:[0,1,1] neg_lo:[1,0,0]
    v_cvt_pk_bf16_f32 v61, v84, v85
    v_pk_mul_f32 v[88:89], v[82:83], v[80:81] op_sel:[0,0] op_sel_hi:[1,0] neg_hi:[1,0]
    v_pk_fma_f32 v[90:91], v[82:83], v[80:81], v[88:89] op_sel:[1,1,0] op_sel_hi:[0,1,1] neg_lo:[1,0,0] neg_hi:[1,0,0]
    v_cvt_pk_bf16_f32 v45, v90, v91
    v_mul_f32_dpp v87, v13, v28 row_newbcast:6 row_mask:0xf bank_mask:0xf
    v_mul_f32_dpp v91, v13, v29 row_newbcast:6 row_mask:0xf bank_mask:0xf
    v_mul_f32_dpp v86, v12, v28 row_newbcast:6 row_mask:0xf bank_mask:0xf
    v_mul_f32_dpp v90, v12, v29 row_newbcast:6 row_mask:0xf bank_mask:0xf
    v_fract_f32 v87, v87
    v_fract_f32 v91, v91
    v_exp_f32 v86, v86
    v_exp_f32 v90, v90
    v_cos_f32 v88, v87
    v_sin_f32 v89, v87
    v_cos_f32 v92, v91
    v_sin_f32 v93, v91
    v_mov_b32_dpp v80, v14 row_newbcast:6 row_mask:0xf bank_mask:0xf
    v_mov_b32_dpp v81, v15 row_newbcast:6 row_mask:0xf bank_mask:0xf
    v_pk_mul_f32 v[82:83], v[88:89], v[86:87] op_sel:[0,0] op_sel_hi:[1,0]
    v_pk_mul_f32 v[84:85], v[92:93], v[90:91] op_sel:[0,0] op_sel_hi:[1,0]
    v_cndmask_b32 v86, v82, 1.0, s[44:45]
    v_cndmask_b32 v87, v83, 0, s[44:45]
    v_cvt_pk_bf16_f32 v50, v84, v85
    v_pk_mul_f32 v[88:89], v[86:87], v[80:81] op_sel:[0,0] op_sel_hi:[1,0] neg_hi:[1,0]
    v_pk_fma_f32 v[90:91], v[86:87], v[80:81], v[88:89] op_sel:[1,1,0] op_sel_hi:[0,1,1] neg_lo:[1,0,0] neg_hi:[1,0,0]
    v_cvt_pk_bf16_f32 v34, v90, v91
    v_pk_mul_f32 v[88:89], v[82:83], v[82:83] op_sel:[0,0] op_sel_hi:[1,0]
    v_pk_mul_f32 v[92:93], v[84:85], v[84:85] op_sel:[0,0] op_sel_hi:[1,0]
    v_pk_fma_f32 v[82:83], v[82:83], v[82:83], v[88:89] op_sel:[1,1,0] op_sel_hi:[0,1,1] neg_lo:[1,0,0]
    v_pk_fma_f32 v[84:85], v[84:85], v[84:85], v[92:93] op_sel:[1,1,0] op_sel_hi:[0,1,1] neg_lo:[1,0,0]
    v_cvt_pk_bf16_f32 v54, v84, v85
    v_pk_mul_f32 v[88:89], v[82:83], v[80:81] op_sel:[0,0] op_sel_hi:[1,0] neg_hi:[1,0]
    v_pk_fma_f32 v[90:91], v[82:83], v[80:81], v[88:89] op_sel:[1,1,0] op_sel_hi:[0,1,1] neg_lo:[1,0,0] neg_hi:[1,0,0]
    v_cvt_pk_bf16_f32 v38, v90, v91
    v_pk_mul_f32 v[88:89], v[82:83], v[82:83] op_sel:[0,0] op_sel_hi:[1,0]
    v_pk_mul_f32 v[92:93], v[84:85], v[84:85] op_sel:[0,0] op_sel_hi:[1,0]
    v_pk_fma_f32 v[82:83], v[82:83], v[82:83], v[88:89] op_sel:[1,1,0] op_sel_hi:[0,1,1] neg_lo:[1,0,0]
    v_pk_fma_f32 v[84:85], v[84:85], v[84:85], v[92:93] op_sel:[1,1,0] op_sel_hi:[0,1,1] neg_lo:[1,0,0]
    v_cvt_pk_bf16_f32 v58, v84, v85
    v_pk_mul_f32 v[88:89], v[82:83], v[80:81] op_sel:[0,0] op_sel_hi:[1,0] neg_hi:[1,0]
    v_pk_fma_f32 v[90:91], v[82:83], v[80:81], v[88:89] op_sel:[1,1,0] op_sel_hi:[0,1,1] neg_lo:[1,0,0] neg_hi:[1,0,0]
    v_cvt_pk_bf16_f32 v42, v90, v91
    v_pk_mul_f32 v[88:89], v[82:83], v[82:83] op_sel:[0,0] op_sel_hi:[1,0]
    v_pk_mul_f32 v[92:93], v[84:85], v[84:85] op_sel:[0,0] op_sel_hi:[1,0]
    v_pk_fma_f32 v[82:83], v[82:83], v[82:83], v[88:89] op_sel:[1,1,0] op_sel_hi:[0,1,1] neg_lo:[1,0,0]
    v_pk_fma_f32 v[84:85], v[84:85], v[84:85], v[92:93] op_sel:[1,1,0] op_sel_hi:[0,1,1] neg_lo:[1,0,0]
    v_cvt_pk_bf16_f32 v62, v84, v85
    v_pk_mul_f32 v[88:89], v[82:83], v[80:81] op_sel:[0,0] op_sel_hi:[1,0] neg_hi:[1,0]
    v_pk_fma_f32 v[90:91], v[82:83], v[80:81], v[88:89] op_sel:[1,1,0] op_sel_hi:[0,1,1] neg_lo:[1,0,0] neg_hi:[1,0,0]
    v_cvt_pk_bf16_f32 v46, v90, v91
    v_mul_f32_dpp v87, v13, v28 row_newbcast:7 row_mask:0xf bank_mask:0xf
    v_mul_f32_dpp v91, v13, v29 row_newbcast:7 row_mask:0xf bank_mask:0xf
    v_mul_f32_dpp v86, v12, v28 row_newbcast:7 row_mask:0xf bank_mask:0xf
    v_mul_f32_dpp v90, v12, v29 row_newbcast:7 row_mask:0xf bank_mask:0xf
    v_fract_f32 v87, v87
    v_fract_f32 v91, v91
    v_exp_f32 v86, v86
    v_exp_f32 v90, v90
    v_cos_f32 v88, v87
    v_sin_f32 v89, v87
    v_cos_f32 v92, v91
    v_sin_f32 v93, v91
    v_mov_b32_dpp v80, v14 row_newbcast:7 row_mask:0xf bank_mask:0xf
    v_mov_b32_dpp v81, v15 row_newbcast:7 row_mask:0xf bank_mask:0xf
    v_pk_mul_f32 v[82:83], v[88:89], v[86:87] op_sel:[0,0] op_sel_hi:[1,0]
    v_pk_mul_f32 v[84:85], v[92:93], v[90:91] op_sel:[0,0] op_sel_hi:[1,0]
    v_cndmask_b32 v86, v82, 1.0, s[44:45]
    v_cndmask_b32 v87, v83, 0, s[44:45]
    v_cvt_pk_bf16_f32 v51, v84, v85
    v_pk_mul_f32 v[88:89], v[86:87], v[80:81] op_sel:[0,0] op_sel_hi:[1,0] neg_hi:[1,0]
    v_pk_fma_f32 v[90:91], v[86:87], v[80:81], v[88:89] op_sel:[1,1,0] op_sel_hi:[0,1,1] neg_lo:[1,0,0] neg_hi:[1,0,0]
    v_cvt_pk_bf16_f32 v35, v90, v91
    v_pk_mul_f32 v[88:89], v[82:83], v[82:83] op_sel:[0,0] op_sel_hi:[1,0]
    v_pk_mul_f32 v[92:93], v[84:85], v[84:85] op_sel:[0,0] op_sel_hi:[1,0]
    v_pk_fma_f32 v[82:83], v[82:83], v[82:83], v[88:89] op_sel:[1,1,0] op_sel_hi:[0,1,1] neg_lo:[1,0,0]
    v_pk_fma_f32 v[84:85], v[84:85], v[84:85], v[92:93] op_sel:[1,1,0] op_sel_hi:[0,1,1] neg_lo:[1,0,0]
    v_cvt_pk_bf16_f32 v55, v84, v85
    v_pk_mul_f32 v[88:89], v[82:83], v[80:81] op_sel:[0,0] op_sel_hi:[1,0] neg_hi:[1,0]
    v_pk_fma_f32 v[90:91], v[82:83], v[80:81], v[88:89] op_sel:[1,1,0] op_sel_hi:[0,1,1] neg_lo:[1,0,0] neg_hi:[1,0,0]
    v_cvt_pk_bf16_f32 v39, v90, v91
    v_pk_mul_f32 v[88:89], v[82:83], v[82:83] op_sel:[0,0] op_sel_hi:[1,0]
    v_pk_mul_f32 v[92:93], v[84:85], v[84:85] op_sel:[0,0] op_sel_hi:[1,0]
    v_pk_fma_f32 v[82:83], v[82:83], v[82:83], v[88:89] op_sel:[1,1,0] op_sel_hi:[0,1,1] neg_lo:[1,0,0]
    v_pk_fma_f32 v[84:85], v[84:85], v[84:85], v[92:93] op_sel:[1,1,0] op_sel_hi:[0,1,1] neg_lo:[1,0,0]
    v_cvt_pk_bf16_f32 v59, v84, v85
    v_pk_mul_f32 v[88:89], v[82:83], v[80:81] op_sel:[0,0] op_sel_hi:[1,0] neg_hi:[1,0]
    v_pk_fma_f32 v[90:91], v[82:83], v[80:81], v[88:89] op_sel:[1,1,0] op_sel_hi:[0,1,1] neg_lo:[1,0,0] neg_hi:[1,0,0]
    v_cvt_pk_bf16_f32 v43, v90, v91
    v_pk_mul_f32 v[88:89], v[82:83], v[82:83] op_sel:[0,0] op_sel_hi:[1,0]
    v_pk_mul_f32 v[92:93], v[84:85], v[84:85] op_sel:[0,0] op_sel_hi:[1,0]
    v_pk_fma_f32 v[82:83], v[82:83], v[82:83], v[88:89] op_sel:[1,1,0] op_sel_hi:[0,1,1] neg_lo:[1,0,0]
    v_pk_fma_f32 v[84:85], v[84:85], v[84:85], v[92:93] op_sel:[1,1,0] op_sel_hi:[0,1,1] neg_lo:[1,0,0]
    v_cvt_pk_bf16_f32 v63, v84, v85
    v_pk_mul_f32 v[88:89], v[82:83], v[80:81] op_sel:[0,0] op_sel_hi:[1,0] neg_hi:[1,0]
    v_pk_fma_f32 v[90:91], v[82:83], v[80:81], v[88:89] op_sel:[1,1,0] op_sel_hi:[0,1,1] neg_lo:[1,0,0] neg_hi:[1,0,0]
    v_cvt_pk_bf16_f32 v47, v90, v91
    v_mfma_f32_16x16x32_bf16 v[64:67], v[32:35], v[48:51], v[64:67]
    v_mfma_f32_16x16x32_bf16 v[68:71], v[36:39], v[52:55], v[68:71]
    v_mfma_f32_16x16x32_bf16 v[72:75], v[40:43], v[56:59], v[72:75]
    v_mfma_f32_16x16x32_bf16 v[76:79], v[44:47], v[60:63], v[76:79]
    v_lshlrev_b32 v6, 12, v2
    v_lshl_add_u32 v6, v1, 4, v6
    s_nop 2
    ds_write_b128 v6, v[64:67] offset:0
    ds_write_b128 v6, v[68:71] offset:1024
    ds_write_b128 v6, v[72:75] offset:2048
    ds_write_b128 v6, v[76:79] offset:3072
    s_waitcnt lgkmcnt(0)
    s_barrier
    ds_read_b128 v[48:51], v5 offset:0
    ds_read_b128 v[52:55], v5 offset:4096
    ds_read_b128 v[56:59], v5 offset:8192
    ds_read_b128 v[60:63], v5 offset:12288
    s_waitcnt lgkmcnt(0)
    v_add_f32 v48, v48, v52
    v_add_f32 v56, v56, v60
    v_add_f32 v49, v49, v53
    v_add_f32 v57, v57, v61
    v_add_f32 v50, v50, v54
    v_add_f32 v58, v58, v62
    v_add_f32 v51, v51, v55
    v_add_f32 v59, v59, v63
    v_add_f32 v48, v48, v56
    v_add_f32 v49, v49, v57
    v_add_f32 v50, v50, v58
    v_add_f32 v51, v51, v59
    v_add_f32 v48, v48, v48
    v_add_f32 v49, v49, v49
    v_add_f32 v50, v50, v50
    v_add_f32 v51, v51, v51
    v_cvt_pk_bf16_f32 v36, v48, v49
    v_cvt_pk_bf16_f32 v37, v50, v51
    v_lshlrev_b32 v6, 3, v0
    ds_write_b64 v6, v[36:37] offset:36864
    v_mov_b32 v38, 0
    v_mov_b32 v39, 38912
    ds_write_b32 v39, v38
    s_waitcnt lgkmcnt(0)
    s_barrier
    v_and_b32 v40, 0xffff, v96
    v_lshrrev_b32 v41, 16, v96
    v_and_b32 v42, 0xffff, v97
    v_lshrrev_b32 v43, 16, v97
    v_and_b32 v44, 0xffff, v98
    v_lshrrev_b32 v45, 16, v98
    v_and_b32 v46, 0xffff, v99
    v_lshrrev_b32 v47, 16, v99
    v_and_b32 v48, 0xffff, v100
    v_lshrrev_b32 v49, 16, v100
    v_and_b32 v50, 0xffff, v101
    v_lshrrev_b32 v51, 16, v101
    ds_read_u16 v52, v40 offset:36864
    ds_read_u16 v53, v41 offset:36864
    ds_read_u16 v54, v42 offset:36864
    ds_read_u16 v55, v43 offset:36864
    ds_read_u16 v56, v44 offset:36864
    ds_read_u16 v57, v45 offset:36864
    ds_read_u16 v58, v46 offset:36864
    ds_read_u16 v59, v47 offset:36864
    ds_read_u16 v60, v48 offset:36864
    ds_read_u16 v61, v49 offset:36864
    ds_read_u16 v62, v50 offset:36864
    ds_read_u16 v63, v51 offset:36864
    v_mov_b32 v24, 0
    v_mov_b32 v25, 0
    v_mov_b32 v26, 0
    v_mov_b32 v27, 0
    s_waitcnt lgkmcnt(0)
    v_lshl_or_b32 v8, v53, 16, v52
    v_lshl_or_b32 v9, v55, 16, v54
    v_lshl_or_b32 v10, v57, 16, v56
    v_lshl_or_b32 v11, v59, 16, v58
    v_lshl_or_b32 v12, v61, 16, v60
    v_lshl_or_b32 v13, v63, 16, v62
    s_barrier
    v_alignbit_b32 v30, v9, v8, 16
    v_alignbit_b32 v31, v10, v9, 16
    v_alignbit_b32 v32, v11, v10, 16
    v_alignbit_b32 v33, v12, v11, 16
    v_mov_b32 v34, v31
    v_mov_b32 v35, v32
    v_mov_b32 v36, v33
    v_alignbit_b32 v37, v13, v12, 16
    v_mov_b32 v40, v9
    v_mov_b32 v41, v10
    v_mov_b32 v42, v11
    v_mov_b32 v43, v12
    ds_write_b128 v5, v[10:13] offset:32
    ds_write_b128 v5, v[34:37] offset:4192
    ds_write_b128 v5, v[40:43] offset:8352
    ds_write_b128 v5, v[30:33] offset:12512
    v_lshrrev_b32 v28, 1, v0
    v_mul_u32_u24 v28, 4160, v28
    v_and_b32 v29, 1, v0
    v_lshl_add_u32 v28, v29, 4, v28
    v_subrev_u32 v29, 8, v0
    v_lshlrev_b32 v29, 4, v29
    v_add_u32 v29, 32256, v29
    v_cmp_gt_u32 vcc, 8, v0
    s_nop 1
    v_cndmask_b32 v28, v29, v28, vcc
    v_cmp_gt_u32 vcc, 40, v0
    s_nop 3
    s_and_saveexec_b64 s[46:47], vcc
    s_cbranch_execz L_kc_z
    ds_write_b128 v28, v[24:27]
L_kc_z:
    s_mov_b64 exec, s[46:47]
    v_bfe_u32 v14, v1, 2, 2
    v_mul_u32_u24 v14, 4160, v14
    v_and_b32 v15, 3, v1
    v_lshl_add_u32 v14, v15, 3, v14
    v_lshlrev_b32 v15, 4, v4
    v_sub_u32 v14, v14, v15
    v_add_u32 v14, 56, v14
    v_lshl_add_u32 v14, v2, 7, v14
    v_lshlrev_b32 v15, 5, v3
    v_lshl_add_u32 v15, v4, 4, v15
    v_add_u32 v15, 32672, v15
    v_lshlrev_b32 v28, 7, v2
    v_sub_u32 v15, v15, v28
    v_lshlrev_b32 v6, 5, v3
    v_lshl_add_u32 v6, v4, 3, v6
    v_lshl_add_u32 v6, v2, 10, v6
    v_mul_u32_u24 v7, 576, v0
    v_add_u32 v7, s12, v7
    v_lshlrev_b32 v7, 4, v7
    s_cmp_eq_u32 s46, s46
    v_readfirstlane_b32 s48, v2
    s_nop 3
    s_cmp_eq_u32 s48, 0
    s_cbranch_scc0 L_kc_nopoll
    v_readfirstlane_b32 s52, v105
    s_nop 3
    s_cmp_ge_u32 s52, 4
    s_cbranch_scc1 L_kc_nopoll
    v_readfirstlane_b32 s53, v104
    s_mov_b32 s49, 0
    s_mov_b64 s[50:51], exec
    s_mov_b64 exec, 1
L_kc_poll:
    global_load_dword v17, v103, s[56:57] sc1
    s_waitcnt vmcnt(0)
    v_readfirstlane_b32 s52, v17
    s_nop 3
    s_cmp_lg_u32 s52, s53
    s_cbranch_scc1 L_kc_pollok
    s_add_u32 s49, s49, 1
    s_cmp_ge_u32 s49, 400000
    s_cbranch_scc1 L_kc_pollok
    s_sleep 4
    s_branch L_kc_poll
L_kc_pollok:
    s_mov_b64 exec, s[50:51]
L_kc_nopoll:
    s_waitcnt lgkmcnt(0)
    s_barrier
    s_add_u32 s16, s42, 2359296
    s_addc_u32 s17, s43, 0
    global_load_dwordx4 v[16:19], v7, s[42:43] sc1
    global_load_dwordx4 v[20:23], v7, s[16:17] sc1
    v_lshlrev_b32 v102, 16, v102
    s_nop 0
    v_readfirstlane_b32 s15, v102
    s_waitcnt vmcnt(0)
    ds_write_b128 v5, v[16:19] offset:32768
    ds_write_b128 v5, v[20:23] offset:36864
    s_waitcnt lgkmcnt(0)
    s_barrier
    ds_read_b64_tr_b16 v[16:17], v14 offset:8
    ds_read_b64_tr_b16 v[18:19], v14 offset:0
    ds_read_b128 v[48:51], v15 offset:64
    ds_read_b64_tr_b16 v[20:21], v14 offset:520
    ds_read_b64_tr_b16 v[22:23], v14 offset:512
    ds_read_b128 v[52:55], v15 offset:576
    ds_read_b64_tr_b16 v[24:25], v14 offset:1032
    ds_read_b64_tr_b16 v[26:27], v14 offset:1024
    ds_read_b128 v[56:59], v15 offset:1088
    ds_read_b64_tr_b16 v[28:29], v14 offset:1544
    ds_read_b64_tr_b16 v[30:31], v14 offset:1536
    ds_read_b128 v[60:63], v15 offset:1600
    ds_read_b64_tr_b16 v[32:33], v14 offset:2056
    ds_read_b64_tr_b16 v[34:35], v14 offset:2048
    ds_read_b128 v[64:67], v15 offset:2112
    ds_read_b64_tr_b16 v[36:37], v14 offset:2568
    ds_read_b64_tr_b16 v[38:39], v14 offset:2560
    ds_read_b128 v[68:71], v15 offset:2624
    ds_read_b64_tr_b16 v[40:41], v14 offset:3080
    ds_read_b64_tr_b16 v[42:43], v14 offset:3072
    ds_read_b128 v[72:75], v15 offset:3136
    ds_read_b64_tr_b16 v[44:45], v14 offset:3592
    ds_read_b64_tr_b16 v[46:47], v14 offset:3584
    ds_read_b128 v[76:79], v15 offset:3648
    s_waitcnt lgkmcnt(0)
    v_mfma_f32_16x16x32_bf16 v[80:83], v[16:19], v[48:51], 0
    v_mfma_f32_16x16x32_bf16 v[84:87], v[20:23], v[48:51], 0
    v_mfma_f32_16x16x32_bf16 v[88:91], v[24:27], v[48:51], 0
    v_mfma_f32_16x16x32_bf16 v[92:95], v[28:31], v[48:51], 0
    v_mfma_f32_16x16x32_bf16 v[96:99], v[32:35], v[48:51], 0
    v_mfma_f32_16x16x32_bf16 v[100:103], v[36:39], v[48:51], 0
    v_mfma_f32_16x16x32_bf16 v[104:107], v[40:43], v[48:51], 0
    v_mfma_f32_16x16x32_bf16 v[108:111], v[44:47], v[48:51], 0
    v_mfma_f32_16x16x32_bf16 v[84:87], v[16:19], v[52:55], v[84:87]
    v_mfma_f32_16x16x32_bf16 v[88:91], v[20:23], v[52:55], v[88:91]
    v_mfma_f32_16x16x32_bf16 v[92:95], v[24:27], v[52:55], v[92:95]
    v_mfma_f32_16x16x32_bf16 v[96:99], v[28:31], v[52:55], v[96:99]
    v_mfma_f32_16x16x32_bf16 v[100:103], v[32:35], v[52:55], v[100:103]
    v_mfma_f32_16x16x32_bf16 v[104:107], v[36:39], v[52:55], v[104:107]
    v_mfma_f32_16x16x32_bf16 v[108:111], v[40:43], v[52:55], v[108:111]
    v_mfma_f32_16x16x32_bf16 v[88:91], v[16:19], v[56:59], v[88:91]
    v_mfma_f32_16x16x32_bf16 v[92:95], v[20:23], v[56:59], v[92:95]
    v_mfma_f32_16x16x32_bf16 v[96:99], v[24:27], v[56:59], v[96:99]
    v_mfma_f32_16x16x32_bf16 v[100:103], v[28:31], v[56:59], v[100:103]
    v_mfma_f32_16x16x32_bf16 v[104:107], v[32:35], v[56:59], v[104:107]
    v_mfma_f32_16x16x32_bf16 v[108:111], v[36:39], v[56:59], v[108:111]
    v_mfma_f32_16x16x32_bf16 v[92:95], v[16:19], v[60:63], v[92:95]
    v_mfma_f32_16x16x32_bf16 v[96:99], v[20:23], v[60:63], v[96:99]
    v_mfma_f32_16x16x32_bf16 v[100:103], v[24:27], v[60:63], v[100:103]
    v_mfma_f32_16x16x32_bf16 v[104:107], v[28:31], v[60:63], v[104:107]
    v_mfma_f32_16x16x32_bf16 v[108:111], v[32:35], v[60:63], v[108:111]
    v_mfma_f32_16x16x32_bf16 v[96:99], v[16:19], v[64:67], v[96:99]
    v_mfma_f32_16x16x32_bf16 v[100:103], v[20:23], v[64:67], v[100:103]
    v_mfma_f32_16x16x32_bf16 v[104:107], v[24:27], v[64:67], v[104:107]
    v_mfma_f32_16x16x32_bf16 v[108:111], v[28:31], v[64:67], v[108:111]
    v_mfma_f32_16x16x32_bf16 v[100:103], v[16:19], v[68:71], v[100:103]
    v_mfma_f32_16x16x32_bf16 v[104:107], v[20:23], v[68:71], v[104:107]
    v_mfma_f32_16x16x32_bf16 v[108:111], v[24:27], v[68:71], v[108:111]
    v_mfma_f32_16x16x32_bf16 v[104:107], v[16:19], v[72:75], v[104:107]
    v_mfma_f32_16x16x32_bf16 v[108:111], v[20:23], v[72:75], v[108:111]
    v_mfma_f32_16x16x32_bf16 v[108:111], v[16:19], v[76:79], v[108:111]
    ds_read_b64_tr_b16 v[16:17], v14 offset:72
    ds_read_b64_tr_b16 v[18:19], v14 offset:64
    ds_read_b128 v[48:51], v15 offset:0
    ds_read_b64_tr_b16 v[20:21], v14 offset:584
    ds_read_b64_tr_b16 v[22:23], v14 offset:576
    ds_read_b128 v[52:55], v15 offset:512
    ds_read_b64_tr_b16 v[24:25], v14 offset:1096
    ds_read_b64_tr_b16 v[26:27], v14 offset:1088
    ds_read_b128 v[56:59], v15 offset:1024
    ds_read_b64_tr_b16 v[28:29], v14 offset:1608
    ds_read_b64_tr_b16 v[30:31], v14 offset:1600
    ds_read_b128 v[60:63], v15 offset:1536
    ds_read_b64_tr_b16 v[32:33], v14 offset:2120
    ds_read_b64_tr_b16 v[34:35], v14 offset:2112
    ds_read_b128 v[64:67], v15 offset:2048
    ds_read_b64_tr_b16 v[36:37], v14 offset:2632
    ds_read_b64_tr_b16 v[38:39], v14 offset:2624
    ds_read_b128 v[68:71], v15 offset:2560
    ds_read_b64_tr_b16 v[40:41], v14 offset:3144
    ds_read_b64_tr_b16 v[42:43], v14 offset:3136
    ds_read_b128 v[72:75], v15 offset:3072
    ds_read_b64_tr_b16 v[44:45], v14 offset:3656
    ds_read_b64_tr_b16 v[46:47], v14 offset:3648
    ds_read_b128 v[76:79], v15 offset:3584
    s_waitcnt lgkmcnt(0)
    v_mfma_f32_16x16x32_bf16 v[80:83], v[16:19], v[48:51], v[80:83]
    v_mfma_f32_16x16x32_bf16 v[84:87], v[20:23], v[48:51], v[84:87]
    v_mfma_f32_16x16x32_bf16 v[88:91], v[24:27], v[48:51], v[88:91]
    v_mfma_f32_16x16x32_bf16 v[92:95], v[28:31], v[48:51], v[92:95]
    v_mfma_f32_16x16x32_bf16 v[96:99], v[32:35], v[48:51], v[96:99]
    v_mfma_f32_16x16x32_bf16 v[100:103], v[36:39], v[48:51], v[100:103]
    v_mfma_f32_16x16x32_bf16 v[104:107], v[40:43], v[48:51], v[104:107]
    v_mfma_f32_16x16x32_bf16 v[108:111], v[44:47], v[48:51], v[108:111]
    v_mfma_f32_16x16x32_bf16 v[84:87], v[16:19], v[52:55], v[84:87]
    v_mfma_f32_16x16x32_bf16 v[88:91], v[20:23], v[52:55], v[88:91]
    v_mfma_f32_16x16x32_bf16 v[92:95], v[24:27], v[52:55], v[92:95]
    v_mfma_f32_16x16x32_bf16 v[96:99], v[28:31], v[52:55], v[96:99]
    v_mfma_f32_16x16x32_bf16 v[100:103], v[32:35], v[52:55], v[100:103]
    v_mfma_f32_16x16x32_bf16 v[104:107], v[36:39], v[52:55], v[104:107]
    v_mfma_f32_16x16x32_bf16 v[108:111], v[40:43], v[52:55], v[108:111]
    v_mfma_f32_16x16x32_bf16 v[88:91], v[16:19], v[56:59], v[88:91]
    v_mfma_f32_16x16x32_bf16 v[92:95], v[20:23], v[56:59], v[92:95]
    v_mfma_f32_16x16x32_bf16 v[96:99], v[24:27], v[56:59], v[96:99]
    v_mfma_f32_16x16x32_bf16 v[100:103], v[28:31], v[56:59], v[100:103]
    v_mfma_f32_16x16x32_bf16 v[104:107], v[32:35], v[56:59], v[104:107]
    v_mfma_f32_16x16x32_bf16 v[108:111], v[36:39], v[56:59], v[108:111]
    v_mfma_f32_16x16x32_bf16 v[92:95], v[16:19], v[60:63], v[92:95]
    v_mfma_f32_16x16x32_bf16 v[96:99], v[20:23], v[60:63], v[96:99]
    v_mfma_f32_16x16x32_bf16 v[100:103], v[24:27], v[60:63], v[100:103]
    v_mfma_f32_16x16x32_bf16 v[104:107], v[28:31], v[60:63], v[104:107]
    v_mfma_f32_16x16x32_bf16 v[108:111], v[32:35], v[60:63], v[108:111]
    v_mfma_f32_16x16x32_bf16 v[96:99], v[16:19], v[64:67], v[96:99]
    v_mfma_f32_16x16x32_bf16 v[100:103], v[20:23], v[64:67], v[100:103]
    v_mfma_f32_16x16x32_bf16 v[104:107], v[24:27], v[64:67], v[104:107]
    v_mfma_f32_16x16x32_bf16 v[108:111], v[28:31], v[64:67], v[108:111]
    v_mfma_f32_16x16x32_bf16 v[100:103], v[16:19], v[68:71], v[100:103]
    v_mfma_f32_16x16x32_bf16 v[104:107], v[20:23], v[68:71], v[104:107]
    v_mfma_f32_16x16x32_bf16 v[108:111], v[24:27], v[68:71], v[108:111]
    v_mfma_f32_16x16x32_bf16 v[104:107], v[16:19], v[72:75], v[104:107]
    v_mfma_f32_16x16x32_bf16 v[108:111], v[20:23], v[72:75], v[108:111]
    v_mfma_f32_16x16x32_bf16 v[108:111], v[16:19], v[76:79], v[108:111]
    s_barrier
    v_lshlrev_b32 v112, 4, v1
    v_lshl_add_u32 v112, v2, 13, v112
    ds_write_b128 v112, v[80:83] offset:0
    ds_write_b128 v112, v[84:87] offset:1024
    ds_write_b128 v112, v[88:91] offset:2048
    ds_write_b128 v112, v[92:95] offset:3072
    ds_write_b128 v112, v[96:99] offset:4096
    ds_write_b128 v112, v[100:103] offset:5120
    ds_write_b128 v112, v[104:107] offset:6144
    ds_write_b128 v112, v[108:111] offset:7168
    s_waitcnt lgkmcnt(0)
    s_barrier
    v_lshlrev_b32 v112, 4, v1
    v_lshl_add_u32 v112, v2, 11, v112
    ds_read_b128 v[16:19], v112 offset:0
    ds_read_b128 v[20:23], v112 offset:8192
    ds_read_b128 v[24:27], v112 offset:16384
    ds_read_b128 v[28:31], v112 offset:24576
    ds_read_b128 v[32:35], v112 offset:1024
    ds_read_b128 v[36:39], v112 offset:9216
    ds_read_b128 v[40:43], v112 offset:17408
    ds_read_b128 v[44:47], v112 offset:25600
    v_add_u32 v113, 32768, v6
    ds_read_b64 v[116:117], v113
    ds_read_b64 v[118:119], v113 offset:512
    ds_read_b64 v[120:121], v113 offset:4096
    ds_read_b64 v[122:123], v113 offset:4608
    s_lshl_b32 s13, s12, 12
    s_add_u32 s13, s13, 7096320
    s_add_u32 s18, s42, s13
    s_addc_u32 s19, s43, 0
    s_waitcnt lgkmcnt(0)
    v_add_f32 v16, v16, v20
    v_add_f32 v24, v24, v28
    v_add_f32 v17, v17, v21
    v_add_f32 v25, v25, v29
    v_add_f32 v18, v18, v22
    v_add_f32 v26, v26, v30
    v_add_f32 v19, v19, v23
    v_add_f32 v27, v27, v31
    v_add_f32 v16, v16, v24
    v_add_f32 v17, v17, v25
    v_add_f32 v18, v18, v26
    v_add_f32 v19, v19, v27
    v_cvt_pk_bf16_f32 v48, v16, v17
    v_cvt_pk_bf16_f32 v49, v18, v19
    v_lshlrev_b32 v52, 16, v116
    v_and_b32 v53, 0xffff0000, v116
    v_mul_f32 v52, s15, v52
    v_mul_f32 v53, s15, v53
    v_cvt_pk_bf16_f32 v54, v52, v53
    v_lshlrev_b32 v52, 16, v54
    v_and_b32 v53, 0xffff0000, v54
    v_lshlrev_b32 v54, 16, v48
    v_and_b32 v55, 0xffff0000, v48
    v_add_f32 v52, v52, v54
    v_add_f32 v53, v53, v55
    v_cvt_pk_bf16_f32 v54, v52, v53
    v_lshlrev_b32 v52, 16, v54
    v_and_b32 v53, 0xffff0000, v54
    v_lshlrev_b32 v54, 16, v120
    v_and_b32 v55, 0xffff0000, v120
    v_add_f32 v52, v52, v54
    v_add_f32 v53, v53, v55
    v_cvt_pk_bf16_f32 v64, v52, v53
    v_lshlrev_b32 v52, 16, v117
    v_and_b32 v53, 0xffff0000, v117
    v_mul_f32 v52, s15, v52
    v_mul_f32 v53, s15, v53
    v_cvt_pk_bf16_f32 v54, v52, v53
    v_lshlrev_b32 v52, 16, v54
    v_and_b32 v53, 0xffff0000, v54
    v_lshlrev_b32 v54, 16, v49
    v_and_b32 v55, 0xffff0000, v49
    v_add_f32 v52, v52, v54
    v_add_f32 v53, v53, v55
    v_cvt_pk_bf16_f32 v54, v52, v53
    v_lshlrev_b32 v52, 16, v54
    v_and_b32 v53, 0xffff0000, v54
    v_lshlrev_b32 v54, 16, v121
    v_and_b32 v55, 0xffff0000, v121
    v_add_f32 v52, v52, v54
    v_add_f32 v53, v53, v55
    v_cvt_pk_bf16_f32 v65, v52, v53
    global_store_dwordx2 v6, v[64:65], s[18:19] offset:0 sc1
    v_add_f32 v32, v32, v36
    v_add_f32 v40, v40, v44
    v_add_f32 v33, v33, v37
    v_add_f32 v41, v41, v45
    v_add_f32 v34, v34, v38
    v_add_f32 v42, v42, v46
    v_add_f32 v35, v35, v39
    v_add_f32 v43, v43, v47
    v_add_f32 v32, v32, v40
    v_add_f32 v33, v33, v41
    v_add_f32 v34, v34, v42
    v_add_f32 v35, v35, v43
    v_cvt_pk_bf16_f32 v48, v32, v33
    v_cvt_pk_bf16_f32 v49, v34, v35
    v_lshlrev_b32 v52, 16, v118
    v_and_b32 v53, 0xffff0000, v118
    v_mul_f32 v52, s15, v52
    v_mul_f32 v53, s15, v53
    v_cvt_pk_bf16_f32 v54, v52, v53
    v_lshlrev_b32 v52, 16, v54
    v_and_b32 v53, 0xffff0000, v54
    v_lshlrev_b32 v54, 16, v48
    v_and_b32 v55, 0xffff0000, v48
    v_add_f32 v52, v52, v54
    v_add_f32 v53, v53, v55
    v_cvt_pk_bf16_f32 v54, v52, v53
    v_lshlrev_b32 v52, 16, v54
    v_and_b32 v53, 0xffff0000, v54
    v_lshlrev_b32 v54, 16, v122
    v_and_b32 v55, 0xffff0000, v122
    v_add_f32 v52, v52, v54
    v_add_f32 v53, v53, v55
    v_cvt_pk_bf16_f32 v66, v52, v53
    v_lshlrev_b32 v52, 16, v119
    v_and_b32 v53, 0xffff0000, v119
    v_mul_f32 v52, s15, v52
    v_mul_f32 v53, s15, v53
    v_cvt_pk_bf16_f32 v54, v52, v53
    v_lshlrev_b32 v52, 16, v54
    v_and_b32 v53, 0xffff0000, v54
    v_lshlrev_b32 v54, 16, v49
    v_and_b32 v55, 0xffff0000, v49
    v_add_f32 v52, v52, v54
    v_add_f32 v53, v53, v55
    v_cvt_pk_bf16_f32 v54, v52, v53
    v_lshlrev_b32 v52, 16, v54
    v_and_b32 v53, 0xffff0000, v54
    v_lshlrev_b32 v54, 16, v123
    v_and_b32 v55, 0xffff0000, v123
    v_add_f32 v52, v52, v54
    v_add_f32 v53, v53, v55
    v_cvt_pk_bf16_f32 v67, v52, v53
    global_store_dwordx2 v6, v[66:67], s[18:19] offset:512 sc1
    s_endpgm
L_colsumFull:
    s_waitcnt lgkmcnt(0)
    s_sub_u32 s12, s2, 832
    s_getpc_b64 s[4:5]
L_pf_next:
    s_add_u32 s4, s4, k4_kernel-L_pf_next
    s_addc_u32 s5, s5, 0
    s_lshl_b32 s6, s12, 9
    v_and_b32 v125, 31, v0
    v_lshlrev_b32 v125, 4, v125
    v_add_u32 v125, s6, v125
    s_mov_b32 s7, L_k5_done-k4_kernel-4
    v_min_u32 v125, s7, v125
    global_load_dword v127, v125, s[4:5]
    s_lshr_b32 s6, s12, 3
    s_lshl_b32 s7, s6, 22
    v_and_b32 v124, 7, v0
    v_lshlrev_b32 v124, 19, v124
    v_add_u32 v124, s7, v124
    global_load_dword v127, v124, s[42:43]
    s_min_u32 s7, s6, 10
    s_lshl_b32 s7, s7, 19
    v_mov_b32 v123, s7
    global_load_dword v127, v123, s[36:37]
    s_min_u32 s7, s6, 4
    s_lshl_b32 s7, s7, 19
    v_mov_b32 v122, s7
    global_load_dword v127, v122, s[38:39]
    s_and_b32 s56, s2, 63
    s_lshl_b32 s56, s56, 7
    s_add_u32 s56, s56, 65585152
    s_waitcnt lgkmcnt(0)
    s_add_u32 s56, s42, s56
    s_addc_u32 s57, s43, 0
    v_lshrrev_b32 v60, 6, v0
    s_nop 0
    v_readfirstlane_b32 s58, v60
    s_nop 3
    s_cmp_eq_u32 s58, 0
    s_cbranch_scc0 L_wl_cs_end
    v_mov_b32 v60, 0
    s_mov_b64 s[54:55], exec
    s_mov_b64 exec, 1
    global_load_dword v61, v60, s[56:57] sc1
    s_waitcnt vmcnt(0)
    global_load_dword v62, v60, s[40:41] sc1
    s_waitcnt vmcnt(0)
    v_readfirstlane_b32 s52, v62
    v_readfirstlane_b32 s53, v61
    s_nop 2
    s_cmp_ge_u32 s52, 4
    s_cbranch_scc1 L_wl_cs_ok
    s_mov_b32 s59, 0
L_wl_cs_poll:
    s_sleep 8
    global_load_dword v62, v60, s[56:57] sc1
    s_waitcnt vmcnt(0)
    v_readfirstlane_b32 s52, v62
    s_nop 3
    s_cmp_lg_u32 s52, s53
    s_cbranch_scc1 L_wl_cs_ok
    s_add_u32 s59, s59, 1
    s_cmp_lt_u32 s59, 400000
    s_cbranch_scc1 L_wl_cs_poll
L_wl_cs_ok:
    s_mov_b64 exec, s[54:55]
L_wl_cs_end:
    s_barrier
    s_sub_u32 s12, s2, 832
    s_cmp_ge_u32 s12, 72
    s_cselect_b32 s13, 1, 0
    s_mul_i32 s14, s13, 72
    s_sub_u32 s14, s12, s14
    v_lshrrev_b32 v1, 3, v0
    v_and_b32 v2, 7, v0
    v_mul_u32_u24 v3, 9216, v1
    v_lshl_add_u32 v3, v2, 4, v3
    s_lshl_b32 s15, s14, 7
    s_waitcnt lgkmcnt(0)
    s_cmp_eq_u32 s13, 1
    s_cselect_b32 s4, s34, s32
    s_cselect_b32 s5, s35, s33
    s_mov_b32 s8, s4
    s_and_b32 s9, s5, 0xffff
    s_mov_b32 s10, 5308416
    s_mov_b32 s11, 0x20000
    s_add_u32 s44, s15, 0
    buffer_load_dwordx4 v[16:19], v3, s[8:11], s44 offen
    s_add_u32 s44, s15, 294912
    buffer_load_dwordx4 v[20:23], v3, s[8:11], s44 offen
    s_add_u32 s44, s15, 589824
    buffer_load_dwordx4 v[24:27], v3, s[8:11], s44 offen
    s_add_u32 s44, s15, 884736
    buffer_load_dwordx4 v[28:31], v3, s[8:11], s44 offen
    s_add_u32 s44, s15, 1179648
    buffer_load_dwordx4 v[32:35], v3, s[8:11], s44 offen
    s_add_u32 s44, s15, 1474560
    buffer_load_dwordx4 v[36:39], v3, s[8:11], s44 offen
    s_add_u32 s44, s15, 1769472
    buffer_load_dwordx4 v[40:43], v3, s[8:11], s44 offen
    s_add_u32 s44, s15, 2064384
    buffer_load_dwordx4 v[44:47], v3, s[8:11], s44 offen
    s_add_u32 s44, s15, 2359296
    buffer_load_dwordx4 v[48:51], v3, s[8:11], s44 offen
    s_add_u32 s44, s15, 2654208
    buffer_load_dwordx4 v[52:55], v3, s[8:11], s44 offen
    s_add_u32 s44, s15, 2949120
    buffer_load_dwordx4 v[56:59], v3, s[8:11], s44 offen
    s_add_u32 s44, s15, 3244032
    buffer_load_dwordx4 v[60:63], v3, s[8:11], s44 offen
    s_add_u32 s44, s15, 3538944
    buffer_load_dwordx4 v[64:67], v3, s[8:11], s44 offen
    s_add_u32 s44, s15, 3833856
    buffer_load_dwordx4 v[68:71], v3, s[8:11], s44 offen
    s_add_u32 s44, s15, 4128768
    buffer_load_dwordx4 v[72:75], v3, s[8:11], s44 offen
    s_add_u32 s44, s15, 4423680
    buffer_load_dwordx4 v[76:79], v3, s[8:11], s44 offen
    s_add_u32 s44, s15, 4718592
    buffer_load_dwordx4 v[80:83], v3, s[8:11], s44 offen
    s_add_u32 s44, s15, 5013504
    buffer_load_dwordx4 v[84:87], v3, s[8:11], s44 offen
    v_mov_b32 v8, 0
    v_mov_b32 v9, 0
    v_mov_b32 v10, 0
    v_mov_b32 v11, 0
    v_mov_b32 v12, 0
    v_mov_b32 v13, 0
    v_mov_b32 v14, 0
    v_mov_b32 v15, 0
    s_waitcnt vmcnt(17)
    v_lshlrev_b32 v4, 16, v16
    v_and_b32 v5, 0xffff0000, v16
    v_pk_add_f32 v[8:9], v[8:9], v[4:5]
    v_lshlrev_b32 v4, 16, v17
    v_and_b32 v5, 0xffff0000, v17
    v_pk_add_f32 v[10:11], v[10:11], v[4:5]
    v_lshlrev_b32 v4, 16, v18
    v_and_b32 v5, 0xffff0000, v18
    v_pk_add_f32 v[12:13], v[12:13], v[4:5]
    v_lshlrev_b32 v4, 16, v19
    v_and_b32 v5, 0xffff0000, v19
    v_pk_add_f32 v[14:15], v[14:15], v[4:5]
    s_waitcnt vmcnt(16)
    v_lshlrev_b32 v4, 16, v20
    v_and_b32 v5, 0xffff0000, v20
    v_pk_add_f32 v[8:9], v[8:9], v[4:5]
    v_lshlrev_b32 v4, 16, v21
    v_and_b32 v5, 0xffff0000, v21
    v_pk_add_f32 v[10:11], v[10:11], v[4:5]
    v_lshlrev_b32 v4, 16, v22
    v_and_b32 v5, 0xffff0000, v22
    v_pk_add_f32 v[12:13], v[12:13], v[4:5]
    v_lshlrev_b32 v4, 16, v23
    v_and_b32 v5, 0xffff0000, v23
    v_pk_add_f32 v[14:15], v[14:15], v[4:5]
    s_waitcnt vmcnt(15)
    v_lshlrev_b32 v4, 16, v24
    v_and_b32 v5, 0xffff0000, v24
    v_pk_add_f32 v[8:9], v[8:9], v[4:5]
    v_lshlrev_b32 v4, 16, v25
    v_and_b32 v5, 0xffff0000, v25
    v_pk_add_f32 v[10:11], v[10:11], v[4:5]
    v_lshlrev_b32 v4, 16, v26
    v_and_b32 v5, 0xffff0000, v26
    v_pk_add_f32 v[12:13], v[12:13], v[4:5]
    v_lshlrev_b32 v4, 16, v27
    v_and_b32 v5, 0xffff0000, v27
    v_pk_add_f32 v[14:15], v[14:15], v[4:5]
    s_waitcnt vmcnt(14)
    v_lshlrev_b32 v4, 16, v28
    v_and_b32 v5, 0xffff0000, v28
    v_pk_add_f32 v[8:9], v[8:9], v[4:5]
    v_lshlrev_b32 v4, 16, v29
    v_and_b32 v5, 0xffff0000, v29
    v_pk_add_f32 v[10:11], v[10:11], v[4:5]
    v_lshlrev_b32 v4, 16, v30
    v_and_b32 v5, 0xffff0000, v30
    v_pk_add_f32 v[12:13], v[12:13], v[4:5]
    v_lshlrev_b32 v4, 16, v31
    v_and_b32 v5, 0xffff0000, v31
    v_pk_add_f32 v[14:15], v[14:15], v[4:5]
    s_waitcnt vmcnt(13)
    v_lshlrev_b32 v4, 16, v32
    v_and_b32 v5, 0xffff0000, v32
    v_pk_add_f32 v[8:9], v[8:9], v[4:5]
    v_lshlrev_b32 v4, 16, v33
    v_and_b32 v5, 0xffff0000, v33
    v_pk_add_f32 v[10:11], v[10:11], v[4:5]
    v_lshlrev_b32 v4, 16, v34
    v_and_b32 v5, 0xffff0000, v34
    v_pk_add_f32 v[12:13], v[12:13], v[4:5]
    v_lshlrev_b32 v4, 16, v35
    v_and_b32 v5, 0xffff0000, v35
    v_pk_add_f32 v[14:15], v[14:15], v[4:5]
    s_waitcnt vmcnt(12)
    v_lshlrev_b32 v4, 16, v36
    v_and_b32 v5, 0xffff0000, v36
    v_pk_add_f32 v[8:9], v[8:9], v[4:5]
    v_lshlrev_b32 v4, 16, v37
    v_and_b32 v5, 0xffff0000, v37
    v_pk_add_f32 v[10:11], v[10:11], v[4:5]
    v_lshlrev_b32 v4, 16, v38
    v_and_b32 v5, 0xffff0000, v38
    v_pk_add_f32 v[12:13], v[12:13], v[4:5]
    v_lshlrev_b32 v4, 16, v39
    v_and_b32 v5, 0xffff0000, v39
    v_pk_add_f32 v[14:15], v[14:15], v[4:5]
    s_waitcnt vmcnt(11)
    v_lshlrev_b32 v4, 16, v40
    v_and_b32 v5, 0xffff0000, v40
    v_pk_add_f32 v[8:9], v[8:9], v[4:5]
    v_lshlrev_b32 v4, 16, v41
    v_and_b32 v5, 0xffff0000, v41
    v_pk_add_f32 v[10:11], v[10:11], v[4:5]
    v_lshlrev_b32 v4, 16, v42
    v_and_b32 v5, 0xffff0000, v42
    v_pk_add_f32 v[12:13], v[12:13], v[4:5]
    v_lshlrev_b32 v4, 16, v43
    v_and_b32 v5, 0xffff0000, v43
    v_pk_add_f32 v[14:15], v[14:15], v[4:5]
    s_waitcnt vmcnt(10)
    v_lshlrev_b32 v4, 16, v44
    v_and_b32 v5, 0xffff0000, v44
    v_pk_add_f32 v[8:9], v[8:9], v[4:5]
    v_lshlrev_b32 v4, 16, v45
    v_and_b32 v5, 0xffff0000, v45
    v_pk_add_f32 v[10:11], v[10:11], v[4:5]
    v_lshlrev_b32 v4, 16, v46
    v_and_b32 v5, 0xffff0000, v46
    v_pk_add_f32 v[12:13], v[12:13], v[4:5]
    v_lshlrev_b32 v4, 16, v47
    v_and_b32 v5, 0xffff0000, v47
    v_pk_add_f32 v[14:15], v[14:15], v[4:5]
    s_waitcnt vmcnt(9)
    v_lshlrev_b32 v4, 16, v48
    v_and_b32 v5, 0xffff0000, v48
    v_pk_add_f32 v[8:9], v[8:9], v[4:5]
    v_lshlrev_b32 v4, 16, v49
    v_and_b32 v5, 0xffff0000, v49
    v_pk_add_f32 v[10:11], v[10:11], v[4:5]
    v_lshlrev_b32 v4, 16, v50
    v_and_b32 v5, 0xffff0000, v50
    v_pk_add_f32 v[12:13], v[12:13], v[4:5]
    v_lshlrev_b32 v4, 16, v51
    v_and_b32 v5, 0xffff0000, v51
    v_pk_add_f32 v[14:15], v[14:15], v[4:5]
    s_waitcnt vmcnt(8)
    v_lshlrev_b32 v4, 16, v52
    v_and_b32 v5, 0xffff0000, v52
    v_pk_add_f32 v[8:9], v[8:9], v[4:5]
    v_lshlrev_b32 v4, 16, v53
    v_and_b32 v5, 0xffff0000, v53
    v_pk_add_f32 v[10:11], v[10:11], v[4:5]
    v_lshlrev_b32 v4, 16, v54
    v_and_b32 v5, 0xffff0000, v54
    v_pk_add_f32 v[12:13], v[12:13], v[4:5]
    v_lshlrev_b32 v4, 16, v55
    v_and_b32 v5, 0xffff0000, v55
    v_pk_add_f32 v[14:15], v[14:15], v[4:5]
    s_waitcnt vmcnt(7)
    v_lshlrev_b32 v4, 16, v56
    v_and_b32 v5, 0xffff0000, v56
    v_pk_add_f32 v[8:9], v[8:9], v[4:5]
    v_lshlrev_b32 v4, 16, v57
    v_and_b32 v5, 0xffff0000, v57
    v_pk_add_f32 v[10:11], v[10:11], v[4:5]
    v_lshlrev_b32 v4, 16, v58
    v_and_b32 v5, 0xffff0000, v58
    v_pk_add_f32 v[12:13], v[12:13], v[4:5]
    v_lshlrev_b32 v4, 16, v59
    v_and_b32 v5, 0xffff0000, v59
    v_pk_add_f32 v[14:15], v[14:15], v[4:5]
    s_waitcnt vmcnt(6)
    v_lshlrev_b32 v4, 16, v60
    v_and_b32 v5, 0xffff0000, v60
    v_pk_add_f32 v[8:9], v[8:9], v[4:5]
    v_lshlrev_b32 v4, 16, v61
    v_and_b32 v5, 0xffff0000, v61
    v_pk_add_f32 v[10:11], v[10:11], v[4:5]
    v_lshlrev_b32 v4, 16, v62
    v_and_b32 v5, 0xffff0000, v62
    v_pk_add_f32 v[12:13], v[12:13], v[4:5]
    v_lshlrev_b32 v4, 16, v63
    v_and_b32 v5, 0xffff0000, v63
    v_pk_add_f32 v[14:15], v[14:15], v[4:5]
    s_waitcnt vmcnt(5)
    v_lshlrev_b32 v4, 16, v64
    v_and_b32 v5, 0xffff0000, v64
    v_pk_add_f32 v[8:9], v[8:9], v[4:5]
    v_lshlrev_b32 v4, 16, v65
    v_and_b32 v5, 0xffff0000, v65
    v_pk_add_f32 v[10:11], v[10:11], v[4:5]
    v_lshlrev_b32 v4, 16, v66
    v_and_b32 v5, 0xffff0000, v66
    v_pk_add_f32 v[12:13], v[12:13], v[4:5]
    v_lshlrev_b32 v4, 16, v67
    v_and_b32 v5, 0xffff0000, v67
    v_pk_add_f32 v[14:15], v[14:15], v[4:5]
    s_waitcnt vmcnt(4)
    v_lshlrev_b32 v4, 16, v68
    v_and_b32 v5, 0xffff0000, v68
    v_pk_add_f32 v[8:9], v[8:9], v[4:5]
    v_lshlrev_b32 v4, 16, v69
    v_and_b32 v5, 0xffff0000, v69
    v_pk_add_f32 v[10:11], v[10:11], v[4:5]
    v_lshlrev_b32 v4, 16, v70
    v_and_b32 v5, 0xffff0000, v70
    v_pk_add_f32 v[12:13], v[12:13], v[4:5]
    v_lshlrev_b32 v4, 16, v71
    v_and_b32 v5, 0xffff0000, v71
    v_pk_add_f32 v[14:15], v[14:15], v[4:5]
    s_waitcnt vmcnt(3)
    v_lshlrev_b32 v4, 16, v72
    v_and_b32 v5, 0xffff0000, v72
    v_pk_add_f32 v[8:9], v[8:9], v[4:5]
    v_lshlrev_b32 v4, 16, v73
    v_and_b32 v5, 0xffff0000, v73
    v_pk_add_f32 v[10:11], v[10:11], v[4:5]
    v_lshlrev_b32 v4, 16, v74
    v_and_b32 v5, 0xffff0000, v74
    v_pk_add_f32 v[12:13], v[12:13], v[4:5]
    v_lshlrev_b32 v4, 16, v75
    v_and_b32 v5, 0xffff0000, v75
    v_pk_add_f32 v[14:15], v[14:15], v[4:5]
    s_waitcnt vmcnt(2)
    v_lshlrev_b32 v4, 16, v76
    v_and_b32 v5, 0xffff0000, v76
    v_pk_add_f32 v[8:9], v[8:9], v[4:5]
    v_lshlrev_b32 v4, 16, v77
    v_and_b32 v5, 0xffff0000, v77
    v_pk_add_f32 v[10:11], v[10:11], v[4:5]
    v_lshlrev_b32 v4, 16, v78
    v_and_b32 v5, 0xffff0000, v78
    v_pk_add_f32 v[12:13], v[12:13], v[4:5]
    v_lshlrev_b32 v4, 16, v79
    v_and_b32 v5, 0xffff0000, v79
    v_pk_add_f32 v[14:15], v[14:15], v[4:5]
    s_waitcnt vmcnt(1)
    v_lshlrev_b32 v4, 16, v80
    v_and_b32 v5, 0xffff0000, v80
    v_pk_add_f32 v[8:9], v[8:9], v[4:5]
    v_lshlrev_b32 v4, 16, v81
    v_and_b32 v5, 0xffff0000, v81
    v_pk_add_f32 v[10:11], v[10:11], v[4:5]
    v_lshlrev_b32 v4, 16, v82
    v_and_b32 v5, 0xffff0000, v82
    v_pk_add_f32 v[12:13], v[12:13], v[4:5]
    v_lshlrev_b32 v4, 16, v83
    v_and_b32 v5, 0xffff0000, v83
    v_pk_add_f32 v[14:15], v[14:15], v[4:5]
    s_waitcnt vmcnt(0)
    v_lshlrev_b32 v4, 16, v84
    v_and_b32 v5, 0xffff0000, v84
    v_pk_add_f32 v[8:9], v[8:9], v[4:5]
    v_lshlrev_b32 v4, 16, v85
    v_and_b32 v5, 0xffff0000, v85
    v_pk_add_f32 v[10:11], v[10:11], v[4:5]
    v_lshlrev_b32 v4, 16, v86
    v_and_b32 v5, 0xffff0000, v86
    v_pk_add_f32 v[12:13], v[12:13], v[4:5]
    v_lshlrev_b32 v4, 16, v87
    v_and_b32 v5, 0xffff0000, v87
    v_pk_add_f32 v[14:15], v[14:15], v[4:5]
    v_add_f32_dpp v8, v8, v8 row_ror:8 row_mask:0xf bank_mask:0xf
    v_add_f32_dpp v9, v9, v9 row_ror:8 row_mask:0xf bank_mask:0xf
    v_add_f32_dpp v10, v10, v10 row_ror:8 row_mask:0xf bank_mask:0xf
    v_add_f32_dpp v11, v11, v11 row_ror:8 row_mask:0xf bank_mask:0xf
    v_add_f32_dpp v12, v12, v12 row_ror:8 row_mask:0xf bank_mask:0xf
    v_add_f32_dpp v13, v13, v13 row_ror:8 row_mask:0xf bank_mask:0xf
    v_add_f32_dpp v14, v14, v14 row_ror:8 row_mask:0xf bank_mask:0xf
    v_add_f32_dpp v15, v15, v15 row_ror:8 row_mask:0xf bank_mask:0xf
    v_mov_b32 v16, v8
    v_mov_b32 v17, v9
    v_mov_b32 v18, v10
    v_mov_b32 v19, v11
    v_mov_b32 v20, v12
    v_mov_b32 v21, v13
    v_mov_b32 v22, v14
    v_mov_b32 v23, v15
    v_permlane16_swap_b32 v8, v16
    v_permlane16_swap_b32 v9, v17
    v_permlane16_swap_b32 v10, v18
    v_permlane16_swap_b32 v11, v19
    v_permlane16_swap_b32 v12, v20
    v_permlane16_swap_b32 v13, v21
    v_permlane16_swap_b32 v14, v22
    v_permlane16_swap_b32 v15, v23
    v_add_f32 v8, v8, v16
    v_add_f32 v9, v9, v17
    v_add_f32 v10, v10, v18
    v_add_f32 v11, v11, v19
    v_add_f32 v12, v12, v20
    v_add_f32 v13, v13, v21
    v_add_f32 v14, v14, v22
    v_add_f32 v15, v15, v23
    v_mov_b32 v16, v8
    v_mov_b32 v17, v9
    v_mov_b32 v18, v10
    v_mov_b32 v19, v11
    v_mov_b32 v20, v12
    v_mov_b32 v21, v13
    v_mov_b32 v22, v14
    v_mov_b32 v23, v15
    v_permlane32_swap_b32 v8, v16
    v_permlane32_swap_b32 v9, v17
    v_permlane32_swap_b32 v10, v18
    v_permlane32_swap_b32 v11, v19
    v_permlane32_swap_b32 v12, v20
    v_permlane32_swap_b32 v13, v21
    v_permlane32_swap_b32 v14, v22
    v_permlane32_swap_b32 v15, v23
    v_add_f32 v8, v8, v16
    v_add_f32 v9, v9, v17
    v_add_f32 v10, v10, v18
    v_add_f32 v11, v11, v19
    v_add_f32 v12, v12, v20
    v_add_f32 v13, v13, v21
    v_add_f32 v14, v14, v22
    v_add_f32 v15, v15, v23
    v_lshrrev_b32 v4, 6, v0
    v_lshlrev_b32 v4, 8, v4
    v_lshl_add_u32 v4, v2, 5, v4
    v_and_b32 v5, 63, v0
    v_cmp_gt_u32 vcc, 8, v5
    s_nop 3
    s_and_saveexec_b64 s[44:45], vcc
    ds_write_b128 v4, v[8:11]
    ds_write_b128 v4, v[12:15] offset:16
    s_mov_b64 exec, s[44:45]
    s_waitcnt lgkmcnt(0)
    s_barrier
    v_cmp_gt_u32 vcc, 64, v0
    s_nop 3
    s_and_saveexec_b64 s[44:45], vcc
    s_cbranch_execz L_colsumFull_done
    v_lshlrev_b32 v4, 2, v0
    ds_read_b32 v8, v4 offset:0
    ds_read_b32 v9, v4 offset:256
    ds_read_b32 v10, v4 offset:512
    ds_read_b32 v11, v4 offset:768
    s_mul_i32 s46, s13, 4608
    s_lshl_b32 s47, s14, 6
    s_add_u32 s46, s46, s47
    s_lshl_b32 s46, s46, 2
    s_add_u32 s46, s46, 11814912
    s_add_u32 s6, s42, s46
    s_addc_u32 s7, s43, 0
    s_add_u32 s48, s6, 36864
    s_addc_u32 s49, s7, 0
    s_waitcnt lgkmcnt(0)
    v_add_f32 v8, v8, v9
    v_add_f32 v10, v10, v11
    v_add_f32 v8, v8, v10
    v_mov_b32 v9, 0
    global_store_dword v4, v8, s[6:7]
    global_store_dword v4, v9, s[48:49]
L_colsumFull_done:
    s_mov_b64 exec, -1
    s_endpgm
L_k1_end:
.p2align 6
.type idx_table,@object
idx_table:
.short 2048,2048,2048,2048,0,8,16,24
.short 32,40,48,56,64,72,80,88
.short 96,104,112,120,2,10,18,26
.short 34,42,50,58,66,74,82,90
.short 98,106,114,122,4,12,20,28
.short 36,44,52,60,68,76,84,92
.short 100,108,116,124,6,14,22,30
.short 38,46,54,62,70,78,86,94
.short 102,110,118,126,128,136,144,152
.short 160,168,176,184,192,200,208,216
.short 224,232,240,248,130,138,146,154
.short 162,170,178,186,194,202,210,218
.short 226,234,242,250,132,140,148,156
.short 164,172,180,188,196,204,212,220
.short 228,236,244,252,134,142,150,158
.short 166,174,182,190,198,206,214,222
.short 230,238,246,254,256,264,272,280
.short 288,296,304,312,320,328,336,344
.short 352,360,368,376,258,266,274,282
.short 290,298,306,314,322,330,338,346
.short 354,362,370,378,260,268,276,284
.short 292,300,308,316,324,332,340,348
.short 356,364,372,380,262,270,278,286
.short 294,302,310,318,326,334,342,350
.short 358,366,374,382,384,392,400,408
.short 416,424,432,440,448,456,464,472
.short 480,488,496,504,386,394,402,410
.short 418,426,434,442,450,458,466,474
.short 482,490,498,506,388,396,404,412
.short 420,428,436,444,452,460,468,476
.short 484,492,500,508,390,398,406,414
.short 422,430,438,446,454,462,470,478
.short 486,494,502,510,768,768,776,784
.short 784,784,792,800,800,800,808,816
.short 816,816,824,832,832,832,840,848
.short 848,848,856,864,864,864,872,880
.short 880,880,888,770,770,770,778,786
.short 786,786,794,802,802,802,810,818
.short 818,818,826,834,834,834,842,850
.short 850,850,858,866,866,866,874,882
.short 882,882,890,772,772,772,780,788
.short 788,788,796,804,804,804,812,820
.short 820,820,828,836,836,836,844,852
.short 852,852,860,868,868,868,876,884
.short 884,884,892,774,774,774,782,790
.short 790,790,798,806,806,806,814,822
.short 822,822,830,838,838,838,846,854
.short 854,854,862,870,870,870,878,886
.short 886,886,894,896,896,896,904,912
.short 912,912,920,928,928,928,936,944
.short 944,944,952,960,960,960,968,976
.short 976,976,984,992,992,992,1000,1008
.short 1008,1008,1016,898,898,898,906,914
.short 914,914,922,930,930,930,938,946
.short 946,946,954,962,962,962,970,978
.short 978,978,986,994,994,994,1002,1010
.short 1010,1010,1018,900,900,900,908,916
.short 916,916,924,932,932,932,940,948
.short 948,948,956,964,964,964,972,980
.short 980,980,988,996,996,996,1004,1012
.short 1012,1012,1020,902,902,902,910,918
.short 918,918,926,934,934,934,942,950
.short 950,950,958,966,966,966,974,982
.short 982,982,990,998,998,998,1006,1014
.short 1014,1014,1022,1280,1280,1280,1280,1288
.short 1288,1288,1296,1296,1296,1296,1296,1304
.short 1304,1304,1312,1312,1312,1312,1312,1320
.short 1320,1320,1328,1328,1328,1328,1328,1336
.short 1336,1336,1344,1344,1344,1344,1344,1352
.short 1352,1352,1360,1360,1360,1360,1360,1368
.short 1368,1368,1376,1376,1376,1376,1376,1384
.short 1384,1384,1392,1392,1392,1392,1392,1400
.short 1400,1400,1282,1282,1282,1282,1282,1290
.short 1290,1290,1298,1298,1298,1298,1298,1306
.short 1306,1306,1314,1314,1314,1314,1314,1322
.short 1322,1322,1330,1330,1330,1330,1330,1338
.short 1338,1338,1346,1346,1346,1346,1346,1354
.short 1354,1354,1362,1362,1362,1362,1362,1370
.short 1370,1370,1378,1378,1378,1378,1378,1386
.short 1386,1386,1394,1394,1394,1394,1394,1402
.short 1402,1402,1284,1284,1284,1284,1284,1292
.short 1292,1292,1300,1300,1300,1300,1300,1308
.short 1308,1308,1316,1316,1316,1316,1316,1324
.short 1324,1324,1332,1332,1332,1332,1332,1340
.short 1340,1340,1348,1348,1348,1348,1348,1356
.short 1356,1356,1364,1364,1364,1364,1364,1372
.short 1372,1372,1380,1380,1380,1380,1380,1388
.short 1388,1388,1396,1396,1396,1396,1396,1404
.short 1404,1404,1286,1286,1286,1286,1286,1294
.short 1294,1294,1302,1302,1302,1302,1302,1310
.short 1310,1310,1318,1318,1318,1318,1318,1326
.short 1326,1326,1334,1334,1334,1334,1334,1342
.short 1342,1342,1350,1350,1350,1350,1350,1358
.short 1358,1358,1366,1366,1366,1366,1366,1374
.short 1374,1374,1382,1382,1382,1382,1382,1390
.short 1390,1390,1398,1398,1398,1398,1398,1406
.short 1406,1406,1408,1408,1408,1408,1408,1416
.short 1416,1416,1424,1424,1424,1424,1424,1432
.short 1432,1432,1440,1440,1440,1440,1440,1448
.short 1448,1448,1456,1456,1456,1456,1456,1464
.short 1464,1464,1472,1472,1472,1472,1472,1480
.short 1480,1480,1488,1488,1488,1488,1488,1496
.short 1496,1496,1504,1504,1504,1504,1504,1512
.short 1512,1512,1520,1520,1520,1520,1520,1528
.short 1528,1528,1410,1410,1410,1410,1410,1418
.short 1418,1418,1426,1426,1426,1426,1426,1434
.short 1434,1434,1442,1442,1442,1442,1442,1450
.short 1450,1450,1458,1458,1458,1458,1458,1466
.short 1466,1466,1474,1474,1474,1474,1474,1482
.short 1482,1482,1490,1490,1490,1490,1490,1498
.short 1498,1498,1506,1506,1506,1506,1506,1514
.short 1514,1514,1522,1522,1522,1522,1522,1530
.short 1530,1530,1412,1412,1412,1412,1412,1420
.short 1420,1420,1428,1428,1428,1428,1428,1436
.short 1436,1436,1444,1444,1444,1444,1444,1452
.short 1452,1452,1460,1460,1460,1460,1460,1468
.short 1468,1468,1476,1476,1476,1476,1476,1484
.short 1484,1484,1492,1492,1492,1492,1492,1500
.short 1500,1500,1508,1508,1508,1508,1508,1516
.short 1516,1516,1524,1524,1524,1524,1524,1532
.short 1532,1532,1414,1414,1414,1414,1414,1422
.short 1422,1422,1430,1430,1430,1430,1430,1438
.short 1438,1438,1446,1446,1446,1446,1446,1454
.short 1454,1454,1462,1462,1462,1462,1462,1470
.short 1470,1470,1478,1478,1478,1478,1478,1486
.short 1486,1486,1494,1494,1494,1494,1494,1502
.short 1502,1502,1510,1510,1510,1510,1510,1518
.short 1518,1518,1526,1526,1526,1526,1526,1534
.short 1534,1534,1792,1792,1792,1792,1792,1792
.short 1792,1800,1800,1800,1800,1800,1800,1800
.short 1808,1808,1808,1808,1808,1808,1808,1808
.short 1808,1816,1816,1816,1816,1816,1816,1816
.short 1824,1824,1824,1824,1824,1824,1824,1824
.short 1824,1832,1832,1832,1832,1832,1832,1832
.short 1840,1840,1840,1840,1840,1840,1840,1840
.short 1840,1848,1848,1848,1848,1848,1848,1848
.short 1856,1856,1856,1856,1856,1856,1856,1856
.short 1856,1864,1864,1864,1864,1864,1864,1864
.short 1872,1872,1872,1872,1872,1872,1872,1872
.short 1872,1880,1880,1880,1880,1880,1880,1880
.short 1888,1888,1888,1888,1888,1888,1888,1888
.short 1888,1896,1896,1896,1896,1896,1896,1896
.short 1904,1904,1904,1904,1904,1904,1904,1904
.short 1904,1912,1912,1912,1912,1912,1912,1912
.short 1794,1794,1794,1794,1794,1794,1794,1794
.short 1794,1802,1802,1802,1802,1802,1802,1802
.short 1810,1810,1810,1810,1810,1810,1810,1810
.short 1810,1818,1818,1818,1818,1818,1818,1818
.short 1826,1826,1826,1826,1826,1826,1826,1826
.short 1826,1834,1834,1834,1834,1834,1834,1834
.short 1842,1842,1842,1842,1842,1842,1842,1842
.short 1842,1850,1850,1850,1850,1850,1850,1850
.short 1858,1858,1858,1858,1858,1858,1858,1858
.short 1858,1866,1866,1866,1866,1866,1866,1866
.short 1874,1874,1874,1874,1874,1874,1874,1874
.short 1874,1882,1882,1882,1882,1882,1882,1882
.short 1890,1890,1890,1890,1890,1890,1890,1890
.short 1890,1898,1898,1898,1898,1898,1898,1898
.short 1906,1906,1906,1906,1906,1906,1906,1906
.short 1906,1914,1914,1914,1914,1914,1914,1914
.short 1796,1796,1796,1796,1796,1796,1796,1796
.short 1796,1804,1804,1804,1804,1804,1804,1804
.short 1812,1812,1812,1812,1812,1812,1812,1812
.short 1812,1820,1820,1820,1820,1820,1820,1820
.short 1828,1828,1828,1828,1828,1828,1828,1828
.short 1828,1836,1836,1836,1836,1836,1836,1836
.short 1844,1844,1844,1844,1844,1844,1844,1844
.short 1844,1852,1852,1852,1852,1852,1852,1852
.short 1860,1860,1860,1860,1860,1860,1860,1860
.short 1860,1868,1868,1868,1868,1868,1868,1868
.short 1876,1876,1876,1876,1876,1876,1876,1876
.short 1876,1884,1884,1884,1884,1884,1884,1884
.short 1892,1892,1892,1892,1892,1892,1892,1892
.short 1892,1900,1900,1900,1900,1900,1900,1900
.short 1908,1908,1908,1908,1908,1908,1908,1908
.short 1908,1916,1916,1916,1916,1916,1916,1916
.short 1798,1798,1798,1798,1798,1798,1798,1798
.short 1798,1806,1806,1806,1806,1806,1806,1806
.short 1814,1814,1814,1814,1814,1814,1814,1814
.short 1814,1822,1822,1822,1822,1822,1822,1822
.short 1830,1830,1830,1830,1830,1830,1830,1830
.short 1830,1838,1838,1838,1838,1838,1838,1838
.short 1846,1846,1846,1846,1846,1846,1846,1846
.short 1846,1854,1854,1854,1854,1854,1854,1854
.short 1862,1862,1862,1862,1862,1862,1862,1862
.short 1862,1870,1870,1870,1870,1870,1870,1870
.short 1878,1878,1878,1878,1878,1878,1878,1878
.short 1878,1886,1886,1886,1886,1886,1886,1886
.short 1894,1894,1894,1894,1894,1894,1894,1894
.short 1894,1902,1902,1902,1902,1902,1902,1902
.short 1910,1910,1910,1910,1910,1910,1910,1910
.short 1910,1918,1918,1918,1918,1918,1918,1918
.short 1920,1920,1920,1920,1920,1920,1920,1920
.short 1920,1928,1928,1928,1928,1928,1928,1928
.short 1936,1936,1936,1936,1936,1936,1936,1936
.short 1936,1944,1944,1944,1944,1944,1944,1944
.short 1952,1952,1952,1952,1952,1952,1952,1952
.short 1952,1960,1960,1960,1960,1960,1960,1960
.short 1968,1968,1968,1968,1968,1968,1968,1968
.short 1968,1976,1976,1976,1976,1976,1976,1976
.short 1984,1984,1984,1984,1984,1984,1984,1984
.short 1984,1992,1992,1992,1992,1992,1992,1992
.short 2000,2000,2000,2000,2000,2000,2000,2000
.short 2000,2008,2008,2008,2008,2008,2008,2008
.short 2016,2016,2016,2016,2016,2016,2016,2016
.short 2016,2024,2024,2024,2024,2024,2024,2024
.short 2032,2032,2032,2032,2032,2032,2032,2032
.short 2032,2040,2040,2040,2040,2040,2040,2040
.short 1922,1922,1922,1922,1922,1922,1922,1922
.short 1922,1930,1930,1930,1930,1930,1930,1930
.short 1938,1938,1938,1938,1938,1938,1938,1938
.short 1938,1946,1946,1946,1946,1946,1946,1946
.short 1954,1954,1954,1954,1954,1954,1954,1954
.short 1954,1962,1962,1962,1962,1962,1962,1962
.short 1970,1970,1970,1970,1970,1970,1970,1970
.short 1970,1978,1978,1978,1978,1978,1978,1978
.short 1986,1986,1986,1986,1986,1986,1986,1986
.short 1986,1994,1994,1994,1994,1994,1994,1994
.short 2002,2002,2002,2002,2002,2002,2002,2002
.short 2002,2010,2010,2010,2010,2010,2010,2010
.short 2018,2018,2018,2018,2018,2018,2018,2018
.short 2018,2026,2026,2026,2026,2026,2026,2026
.short 2034,2034,2034,2034,2034,2034,2034,2034
.short 2034,2042,2042,2042,2042,2042,2042,2042
.short 1924,1924,1924,1924,1924,1924,1924,1924
.short 1924,1932,1932,1932,1932,1932,1932,1932
.short 1940,1940,1940,1940,1940,1940,1940,1940
.short 1940,1948,1948,1948,1948,1948,1948,1948
.short 1956,1956,1956,1956,1956,1956,1956,1956
.short 1956,1964,1964,1964,1964,1964,1964,1964
.short 1972,1972,1972,1972,1972,1972,1972,1972
.short 1972,1980,1980,1980,1980,1980,1980,1980
.short 1988,1988,1988,1988,1988,1988,1988,1988
.short 1988,1996,1996,1996,1996,1996,1996,1996
.short 2004,2004,2004,2004,2004,2004,2004,2004
.short 2004,2012,2012,2012,2012,2012,2012,2012
.short 2020,2020,2020,2020,2020,2020,2020,2020
.short 2020,2028,2028,2028,2028,2028,2028,2028
.short 2036,2036,2036,2036,2036,2036,2036,2036
.short 2036,2044,2044,2044,2044,2044,2044,2044
.short 1926,1926,1926,1926,1926,1926,1926,1926
.short 1926,1934,1934,1934,1934,1934,1934,1934
.short 1942,1942,1942,1942,1942,1942,1942,1942
.short 1942,1950,1950,1950,1950,1950,1950,1950
.short 1958,1958,1958,1958,1958,1958,1958,1958
.short 1958,1966,1966,1966,1966,1966,1966,1966
.short 1974,1974,1974,1974,1974,1974,1974,1974
.short 1974,1982,1982,1982,1982,1982,1982,1982
.short 1990,1990,1990,1990,1990,1990,1990,1990
.short 1990,1998,1998,1998,1998,1998,1998,1998
.short 2006,2006,2006,2006,2006,2006,2006,2006
.short 2006,2014,2014,2014,2014,2014,2014,2014
.short 2022,2022,2022,2022,2022,2022,2022,2022
.short 2022,2030,2030,2030,2030,2030,2030,2030
.short 2038,2038,2038,2038,2038,2038,2038,2038
.short 2038,2046,2046,2046,2046,2046,2046,2046
.short 1536,1536,1536,1536,2048,2048,2048,2048
.size idx_table, 4112
.section .rodata,"a"
.p2align 6
.amdhsa_kernel k1_kernel
  .amdhsa_next_free_vgpr 128
  .amdhsa_next_free_sgpr 96
  .amdhsa_accum_offset 128
  .amdhsa_group_segment_fixed_size 0
  .amdhsa_kernarg_size 112
  .amdhsa_user_sgpr_count 2
  .amdhsa_user_sgpr_kernarg_segment_ptr 1
  .amdhsa_system_sgpr_workgroup_id_x 1
.end_amdhsa_kernel
.text
.globl k4_kernel
.p2align 8
.type k4_kernel,@function
k4_kernel:
    s_load_dwordx16 s[16:31], s[0:1], 0
    s_load_dwordx8 s[32:39], s[0:1], 64
    s_load_dwordx4 s[40:43], s[0:1], 96
    s_cmp_ge_u32 s2, 256
    s_cbranch_scc1 L_k4_done
    s_and_b32 s12, s2, 7
    s_lshr_b32 s13, s2, 3
    s_and_b32 s14, s13, 3
    s_lshl_b32 s12, s12, 2
    s_add_u32 s12, s12, s14
    s_lshr_b32 s13, s13, 2
    v_and_b32 v1, 63, v0
    v_lshrrev_b32 v2, 6, v0
    s_nop 0
    v_readfirstlane_b32 s15, v2
    v_lshrrev_b32 v3, 5, v1
    v_and_b32 v4, 31, v1
    v_lshlrev_b32 v5, 2, v3
    v_xor_b32 v5, v5, v4
    v_lshlrev_b32 v5, 4, v5
    v_lshl_add_u32 v8, v3, 12, v5
    v_add_u32 v5, 2, v3
    v_lshlrev_b32 v6, 2, v5
    v_xor_b32 v6, v6, v4
    v_lshlrev_b32 v6, 4, v6
    v_lshl_add_u32 v9, v5, 12, v6
    v_subrev_u32 v9, 1024, v9
    s_mov_b32 s46, s15
    s_lshl_b32 s44, s46, 6
    v_add_u32 v5, s44, v1
    v_mul_u32_u24 v6, 0xe38f, v5
    v_lshrrev_b32 v6, 20, v6
    v_mul_u32_u24 v7, 18, v6
    v_sub_u32 v7, v5, v7
    v_mul_u32_u24 v6, 9216, v6
    v_lshl_add_u32 v10, v7, 4, v6
    s_sub_u32 s47, s15, 1
    s_cmp_eq_u32 s15, 0
    s_cselect_b32 s47, 8, s47
    s_lshl_b32 s44, s47, 6
    v_add_u32 v5, s44, v1
    v_mul_u32_u24 v6, 0xe38f, v5
    v_lshrrev_b32 v6, 20, v6
    v_mul_u32_u24 v7, 18, v6
    v_sub_u32 v7, v5, v7
    v_mul_u32_u24 v6, 9216, v6
    v_lshl_add_u32 v11, v7, 4, v6
    s_and_b32 s48, s15, 1
    s_add_u32 s48, s48, 7
    s_lshl_b32 s44, s48, 6
    v_add_u32 v5, s44, v1
    v_mul_u32_u24 v6, 0xe38f, v5
    v_lshrrev_b32 v6, 20, v6
    v_mul_u32_u24 v7, 18, v6
    v_sub_u32 v7, v5, v7
    v_mul_u32_u24 v6, 9216, v6
    v_lshl_add_u32 v12, v7, 4, v6
    s_and_b32 s49, s15, 3
    s_lshl_b32 s50, s15, 11
    s_lshl_b32 s51, s15, 10
    s_add_u32 s51, s51, 16384
    s_lshl_b32 s52, s47, 10
    s_cmp_eq_u32 s15, 0
    s_mov_b32 s44, 25728
    s_cselect_b32 s44, 16384, s44
    s_add_u32 s52, s52, s44
    s_lshl_b32 s53, s48, 10
    s_add_u32 s53, s53, 25728
    s_lshl_b32 s54, s15, 14
    s_lshl_b32 s44, s13, 9
    s_add_u32 s54, s54, s44
    s_mul_i32 s55, s12, 288
    s_mov_b32 s56, 0
    s_and_b32 s57, s15, 6
    s_cmp_eq_u32 s57, 4
    s_cselect_b32 s57, 1, 0
    s_lshr_b32 s58, s15, 2
    s_mul_i32 s58, s58, 9
    s_mul_i32 s59, s12, 18
    s_add_u32 s58, s58, s59
    s_lshl_b32 s58, s58, 12
    s_lshl_b32 s59, s13, 8
    s_lshl_b32 s60, s49, 6
    s_add_u32 s59, s59, s60
    s_lshl_b32 s60, s59, 1
    s_add_u32 s58, s58, s60
    v_lshlrev_b32 v13, 1, v1
    v_mov_b32 v66, 0
    s_waitcnt lgkmcnt(0)
    s_add_u32 s16, s42, 7096320
    s_addc_u32 s17, s43, 0
    s_and_b32 s17, s17, 0xffff
    s_mov_b32 s18, 2359296
    s_mov_b32 s19, 0x20000
    s_mov_b32 s20, s32
    s_and_b32 s21, s33, 0xffff
    s_mov_b32 s22, 5308416
    s_mov_b32 s23, 0x20000
    s_mov_b32 s24, s34
    s_and_b32 s25, s35, 0xffff
    s_mov_b32 s26, 5308416
    s_mov_b32 s27, 0x20000
    s_cmp_eq_u32 s15, 0
    s_cselect_b32 s28, s20, s24
    s_cselect_b32 s29, s21, s25
    s_mov_b32 s30, 5308416
    s_mov_b32 s31, 0x20000
    s_add_u32 m0, s56, s50
    s_nop 0
    buffer_load_dwordx4 v8, s[16:19], s54 offen lds
    s_add_u32 m0, s56, s50
    s_nop 0
    buffer_load_dwordx4 v9, s[16:19], s54 offen offset:1024 lds
    s_add_u32 m0, s56, s51
    s_nop 0
    buffer_load_dwordx4 v10, s[20:23], s55 offen lds
    s_add_u32 m0, s56, s52
    s_nop 0
    buffer_load_dwordx4 v11, s[28:31], s55 offen lds
    s_cmp_eq_u32 s57, 0
    s_cbranch_scc1 L_noex_0
    s_add_u32 m0, s56, s53
    s_nop 0
    buffer_load_dwordx4 v12, s[24:27], s55 offen lds
L_noex_0:
    s_add_u32 s54, s54, 131072
    s_add_u32 s55, s55, 294912
    s_add_u32 s56, s56, 34944
    s_cmp_eq_u32 s56, 139776
    s_cselect_b32 s56, 0, s56
    s_add_u32 m0, s56, s50
    s_nop 0
    buffer_load_dwordx4 v8, s[16:19], s54 offen lds
    s_add_u32 m0, s56, s50
    s_nop 0
    buffer_load_dwordx4 v9, s[16:19], s54 offen offset:1024 lds
    s_add_u32 m0, s56, s51
    s_nop 0
    buffer_load_dwordx4 v10, s[20:23], s55 offen lds
    s_add_u32 m0, s56, s52
    s_nop 0
    buffer_load_dwordx4 v11, s[28:31], s55 offen lds
    s_cmp_eq_u32 s57, 0
    s_cbranch_scc1 L_noex_1
    s_add_u32 m0, s56, s53
    s_nop 0
    buffer_load_dwordx4 v12, s[24:27], s55 offen lds
L_noex_1:
    s_add_u32 s54, s54, 131072
    s_add_u32 s55, s55, 294912
    s_add_u32 s56, s56, 34944
    s_cmp_eq_u32 s56, 139776
    s_cselect_b32 s56, 0, s56
    s_add_u32 s44, s58, 0
    buffer_load_ushort v14, v13, s[16:19], s44 offen
    s_add_u32 s44, s58, 4096
    buffer_load_ushort v15, v13, s[16:19], s44 offen
    s_add_u32 s44, s58, 8192
    buffer_load_ushort v16, v13, s[16:19], s44 offen
    s_add_u32 s44, s58, 12288
    buffer_load_ushort v17, v13, s[16:19], s44 offen
    s_add_u32 s44, s58, 16384
    buffer_load_ushort v18, v13, s[16:19], s44 offen
    s_add_u32 s44, s58, 20480
    buffer_load_ushort v19, v13, s[16:19], s44 offen
    s_add_u32 s44, s58, 24576
    buffer_load_ushort v20, v13, s[16:19], s44 offen
    s_add_u32 s44, s58, 28672
    buffer_load_ushort v21, v13, s[16:19], s44 offen
    s_add_u32 s44, s58, 32768
    buffer_load_ushort v26, v13, s[16:19], s44 offen
    v_cmp_gt_u32 vcc, 288, v0
    v_mov_b32 v2, 0x40000000
    s_movk_i32 s46, 144
    v_cmp_le_u32 s[44:45], s46, v0
    s_nop 1
    v_cndmask_b32 v3, 0, 1, s[44:45]
    v_mul_u32_u24 v4, 144, v3
    v_sub_u32 v4, v0, v4
    s_mul_i32 s46, s12, 144
    v_add_u32 v5, s46, v4
    v_mul_u32_u24 v6, 4608, v3
    v_add_u32 v5, v5, v6
    v_lshlrev_b32 v5, 2, v5
    v_cndmask_b32 v5, v2, v5, vcc
    s_add_u32 s4, s42, 11814912
    s_addc_u32 s5, s43, 0
    s_and_b32 s5, s5, 0xffff
    s_mov_b32 s6, 73728
    s_mov_b32 s7, 0x20000
    buffer_load_dword v27, v5, s[4:7], 0 offen
    s_mov_b32 s44, 36864
    buffer_load_dword v67, v5, s[4:7], s44 offen
    v_mov_b32 v64, v3
    v_mov_b32 v65, v4
    s_add_u32 s32, s42, 27832320
    s_addc_u32 s33, s43, 0
    s_and_b32 s33, s33, 0xffff
    s_mov_b32 s34, 18874368
    s_mov_b32 s35, 0x20000
    v_lshrrev_b32 v3, 5, v1
    v_bfe_u32 v4, v1, 4, 1
    v_bfe_u32 v5, v1, 2, 2
    v_and_b32 v6, 3, v1
    v_lshl_add_u32 v7, v3, 3, v5
    s_lshl_b32 s44, s49, 3
    s_add_u32 s44, s44, 0
    v_lshlrev_b32 v30, 2, v5
    v_xor_b32 v30, s44, v30
    v_lshl_add_u32 v30, v4, 1, v30
    v_lshrrev_b32 v31, 1, v6
    v_add_u32 v30, v30, v31
    v_lshlrev_b32 v30, 4, v30
    v_and_b32 v31, 1, v6
    v_lshl_add_u32 v30, v31, 3, v30
    v_lshl_add_u32 v22, v7, 9, v30
    s_lshl_b32 s44, s49, 3
    s_add_u32 s44, s44, 4
    v_lshlrev_b32 v30, 2, v5
    v_xor_b32 v30, s44, v30
    v_lshl_add_u32 v30, v4, 1, v30
    v_lshrrev_b32 v31, 1, v6
    v_add_u32 v30, v30, v31
    v_lshlrev_b32 v30, 4, v30
    v_and_b32 v31, 1, v6
    v_lshl_add_u32 v30, v31, 3, v30
    v_lshl_add_u32 v23, v7, 9, v30
    v_mul_u32_u24 v30, 288, v7
    v_mul_u32_u24 v31, 9344, v4
    v_add_u32 v30, v30, v31
    v_and_b32 v31, 1, v6
    v_lshl_add_u32 v30, v31, 4, v30
    v_lshrrev_b32 v31, 1, v6
    v_lshl_add_u32 v30, v31, 3, v30
    v_add_u32 v24, 16384, v30
    v_bfe_u32 v25, v1, 4, 1
    v_lshlrev_b32 v25, 10, v25
    v_lshrrev_b32 v30, 5, v1
    v_lshl_add_u32 v25, v30, 8, v25
    v_and_b32 v30, 15, v1
    v_lshl_add_u32 v25, v30, 4, v25
    s_lshl_b32 s61, s13, 2
    s_add_u32 s61, s61, s49
    s_mul_i32 s61, s61, 589824
    s_mul_i32 s62, s12, 9
    s_add_u32 s64, s42, 11888640
    s_addc_u32 s65, s43, 0
    s_add_u32 s66, s42, 11896832
    s_addc_u32 s67, s43, 0
    s_waitcnt vmcnt(15)
    s_barrier
    s_cmp_ge_u32 s15, 4
    s_cbranch_scc1 L_k4_B
    v_add_u32 v68, 0, v22
    v_add_u32 v69, 0, v23
    v_add_u32 v70, 0, v24
    v_add_u32 v71, 34944, v22
    v_add_u32 v72, 34944, v23
    v_add_u32 v73, 34944, v24
    v_add_u32 v74, 69888, v22
    v_add_u32 v75, 69888, v23
    v_add_u32 v76, 69888, v24
    v_add_u32 v77, 104832, v22
    v_add_u32 v78, 104832, v23
    v_add_u32 v79, 104832, v24
    ds_read_b64_tr_b16 v[28:29], v68 offset:0
    ds_read_b64_tr_b16 v[30:31], v68 offset:2048
    ds_read_b64_tr_b16 v[32:33], v69 offset:0
    ds_read_b64_tr_b16 v[34:35], v69 offset:2048
    ds_read_b64_tr_b16 v[44:45], v70 offset:0
    ds_read_b64_tr_b16 v[46:47], v70 offset:1152
    ds_read_b64_tr_b16 v[48:49], v70 offset:32
    ds_read_b64_tr_b16 v[50:51], v70 offset:1184
    ds_read_b64_tr_b16 v[52:53], v70 offset:64
    ds_read_b64_tr_b16 v[54:55], v70 offset:1216
    ds_read_b64_tr_b16 v[56:57], v70 offset:96
    ds_read_b64_tr_b16 v[58:59], v70 offset:1248
    s_mov_b32 s70, 0
    s_mov_b32 s71, 0
    ds_read_b64_tr_b16 v[60:61], v70 offset:128
    ds_read_b64_tr_b16 v[62:63], v70 offset:1280
    s_waitcnt lgkmcnt(8)
    v_mfma_f32_32x32x16_bf16 v[96:111], v[44:47], v[28:31], 0
    v_mfma_f32_32x32x16_bf16 v[112:127], v[44:47], v[32:35], 0
    s_add_u32 m0, s56, s50
    s_nop 0
    buffer_load_dwordx4 v8, s[16:19], s54 offen lds
    s_add_u32 m0, s56, s50
    s_nop 0
    buffer_load_dwordx4 v9, s[16:19], s54 offen offset:1024 lds
    ds_read_b64_tr_b16 v[44:45], v70 offset:4608
    ds_read_b64_tr_b16 v[46:47], v70 offset:5760
    ds_read_b64_tr_b16 v[36:37], v68 offset:8192
    ds_read_b64_tr_b16 v[38:39], v68 offset:10240
    ds_read_b64_tr_b16 v[40:41], v69 offset:8192
    ds_read_b64_tr_b16 v[42:43], v69 offset:10240
    s_waitcnt lgkmcnt(12)
    v_mfma_f32_32x32x16_bf16 v[128:143], v[48:51], v[28:31], 0
    v_mfma_f32_32x32x16_bf16 v[144:159], v[48:51], v[32:35], 0
    s_add_u32 m0, s56, s51
    s_nop 0
    buffer_load_dwordx4 v10, s[20:23], s55 offen lds
    s_add_u32 m0, s56, s52
    s_nop 0
    buffer_load_dwordx4 v11, s[28:31], s55 offen lds
    s_add_u32 s54, s54, 131072
    s_add_u32 s55, s55, 294912
    s_add_u32 s56, s56, 34944
    s_cmp_eq_u32 s56, 139776
    s_cselect_b32 s56, 0, s56
    ds_read_b64_tr_b16 v[48:49], v70 offset:4640
    ds_read_b64_tr_b16 v[50:51], v70 offset:5792
    s_waitcnt lgkmcnt(12)
    v_mfma_f32_32x32x16_bf16 v[160:175], v[52:55], v[28:31], 0
    v_mfma_f32_32x32x16_bf16 v[176:191], v[52:55], v[32:35], 0
    ds_read_b64_tr_b16 v[52:53], v70 offset:4672
    ds_read_b64_tr_b16 v[54:55], v70 offset:5824
    s_waitcnt lgkmcnt(12)
    v_mfma_f32_32x32x16_bf16 v[192:207], v[56:59], v[28:31], 0
    v_mfma_f32_32x32x16_bf16 v[208:223], v[56:59], v[32:35], 0
    ds_read_b64_tr_b16 v[56:57], v70 offset:4704
    ds_read_b64_tr_b16 v[58:59], v70 offset:5856
    s_waitcnt lgkmcnt(12)
    v_mfma_f32_32x32x16_bf16 v[224:239], v[60:63], v[28:31], 0
    v_mfma_f32_32x32x16_bf16 v[240:255], v[60:63], v[32:35], 0
    s_waitcnt vmcnt(15)
    s_barrier
    ds_read_b64_tr_b16 v[60:61], v70 offset:4736
    ds_read_b64_tr_b16 v[62:63], v70 offset:5888
    s_waitcnt lgkmcnt(8)
    v_mfma_f32_32x32x16_bf16 v[96:111], v[44:47], v[36:39], v[96:111]
    v_mfma_f32_32x32x16_bf16 v[112:127], v[44:47], v[40:43], v[112:127]
    s_add_u32 m0, s56, s50
    s_nop 0
    buffer_load_dwordx4 v8, s[16:19], s54 offen lds
    s_add_u32 m0, s56, s50
    s_nop 0
    buffer_load_dwordx4 v9, s[16:19], s54 offen offset:1024 lds
    ds_read_b64_tr_b16 v[44:45], v73 offset:0
    ds_read_b64_tr_b16 v[46:47], v73 offset:1152
    ds_read_b64_tr_b16 v[28:29], v71 offset:0
    ds_read_b64_tr_b16 v[30:31], v71 offset:2048
    ds_read_b64_tr_b16 v[32:33], v72 offset:0
    ds_read_b64_tr_b16 v[34:35], v72 offset:2048
    s_waitcnt lgkmcnt(12)
    v_mfma_f32_32x32x16_bf16 v[128:143], v[48:51], v[36:39], v[128:143]
    v_mfma_f32_32x32x16_bf16 v[144:159], v[48:51], v[40:43], v[144:159]
    s_add_u32 m0, s56, s51
    s_nop 0
    buffer_load_dwordx4 v10, s[20:23], s55 offen lds
    s_add_u32 m0, s56, s52
    s_nop 0
    buffer_load_dwordx4 v11, s[28:31], s55 offen lds
    s_add_u32 s54, s54, 131072
    s_add_u32 s55, s55, 294912
    s_add_u32 s56, s56, 34944
    s_cmp_eq_u32 s56, 139776
    s_cselect_b32 s56, 0, s56
    ds_read_b64_tr_b16 v[48:49], v73 offset:32
    ds_read_b64_tr_b16 v[50:51], v73 offset:1184
    s_waitcnt lgkmcnt(12)
    v_mfma_f32_32x32x16_bf16 v[160:175], v[52:55], v[36:39], v[160:175]
    v_mfma_f32_32x32x16_bf16 v[176:191], v[52:55], v[40:43], v[176:191]
    ds_read_b64_tr_b16 v[52:53], v73 offset:64
    ds_read_b64_tr_b16 v[54:55], v73 offset:1216
    s_waitcnt lgkmcnt(12)
    v_mfma_f32_32x32x16_bf16 v[192:207], v[56:59], v[36:39], v[192:207]
    v_mfma_f32_32x32x16_bf16 v[208:223], v[56:59], v[40:43], v[208:223]
    ds_read_b64_tr_b16 v[56:57], v73 offset:96
    ds_read_b64_tr_b16 v[58:59], v73 offset:1248
    s_waitcnt lgkmcnt(12)
    v_mfma_f32_32x32x16_bf16 v[224:239], v[60:63], v[36:39], v[224:239]
    v_mfma_f32_32x32x16_bf16 v[240:255], v[60:63], v[40:43], v[240:255]
    s_add_u32 s70, s70, 1
    ds_read_b64_tr_b16 v[60:61], v73 offset:128
    ds_read_b64_tr_b16 v[62:63], v73 offset:1280
    s_waitcnt lgkmcnt(8)
    v_mfma_f32_32x32x16_bf16 v[96:111], v[44:47], v[28:31], v[96:111]
    v_mfma_f32_32x32x16_bf16 v[112:127], v[44:47], v[32:35], v[112:127]
    ds_read_b64_tr_b16 v[44:45], v73 offset:4608
    ds_read_b64_tr_b16 v[46:47], v73 offset:5760
    ds_read_b64_tr_b16 v[36:37], v71 offset:8192
    ds_read_b64_tr_b16 v[38:39], v71 offset:10240
    ds_read_b64_tr_b16 v[40:41], v72 offset:8192
    ds_read_b64_tr_b16 v[42:43], v72 offset:10240
    s_waitcnt lgkmcnt(12)
    v_mfma_f32_32x32x16_bf16 v[128:143], v[48:51], v[28:31], v[128:143]
    v_mfma_f32_32x32x16_bf16 v[144:159], v[48:51], v[32:35], v[144:159]
    ds_read_b64_tr_b16 v[48:49], v73 offset:4640
    ds_read_b64_tr_b16 v[50:51], v73 offset:5792
    s_waitcnt lgkmcnt(12)
    v_mfma_f32_32x32x16_bf16 v[160:175], v[52:55], v[28:31], v[160:175]
    v_mfma_f32_32x32x16_bf16 v[176:191], v[52:55], v[32:35], v[176:191]
    ds_read_b64_tr_b16 v[52:53], v73 offset:4672
    ds_read_b64_tr_b16 v[54:55], v73 offset:5824
    s_waitcnt lgkmcnt(12)
    v_mfma_f32_32x32x16_bf16 v[192:207], v[56:59], v[28:31], v[192:207]
    v_mfma_f32_32x32x16_bf16 v[208:223], v[56:59], v[32:35], v[208:223]
    ds_read_b64_tr_b16 v[56:57], v73 offset:4704
    ds_read_b64_tr_b16 v[58:59], v73 offset:5856
    s_waitcnt lgkmcnt(12)
    v_mfma_f32_32x32x16_bf16 v[224:239], v[60:63], v[28:31], v[224:239]
    v_mfma_f32_32x32x16_bf16 v[240:255], v[60:63], v[32:35], v[240:255]
    s_waitcnt vmcnt(4)
    s_barrier
    v_mov_b32 v86, 0
    v_mov_b32 v87, 0
    v_lshlrev_b32 v14, 16, v14
    v_add_f32 v86, v86, v14
    v_fmac_f32 v87, v14, v14
    v_lshlrev_b32 v15, 16, v15
    v_add_f32 v86, v86, v15
    v_fmac_f32 v87, v15, v15
    v_lshlrev_b32 v16, 16, v16
    v_add_f32 v86, v86, v16
    v_fmac_f32 v87, v16, v16
    v_lshlrev_b32 v17, 16, v17
    v_add_f32 v86, v86, v17
    v_fmac_f32 v87, v17, v17
    v_lshlrev_b32 v18, 16, v18
    v_add_f32 v86, v86, v18
    v_fmac_f32 v87, v18, v18
    v_lshlrev_b32 v19, 16, v19
    v_add_f32 v86, v86, v19
    v_fmac_f32 v87, v19, v19
    v_lshlrev_b32 v20, 16, v20
    v_add_f32 v86, v86, v20
    v_fmac_f32 v87, v20, v20
    v_lshlrev_b32 v21, 16, v21
    v_add_f32 v86, v86, v21
    v_fmac_f32 v87, v21, v21
    v_lshlrev_b32 v26, 16, v26
    v_add_f32 v86, v86, v26
    v_fmac_f32 v87, v26, v26
    v_lshlrev_b32 v14, 2, v1
    s_lshl_b32 s44, s59, 2
    v_add_u32 v14, s44, v14
    global_atomic_add_f32 v20, v14, v86, s[64:65] sc0
    global_atomic_add_f32 v21, v14, v87, s[66:67] sc0
    v_lshrrev_b32 v15, 4, v65
    v_bfe_u32 v16, v65, 3, 1
    v_bfe_u32 v17, v65, 2, 1
    v_and_b32 v18, 3, v65
    v_lshl_add_u32 v17, v64, 1, v17
    v_lshlrev_b32 v17, 3, v17
    v_lshl_add_u32 v17, v16, 2, v17
    v_add_u32 v17, v17, v18
    v_lshlrev_b32 v15, 8, v15
    v_lshl_add_u32 v15, v17, 2, v15
    v_add_u32 v15, 139776, v15
    v_lshrrev_b32 v16, 5, v0
    v_and_b32 v17, 31, v0
    v_lshlrev_b32 v16, 8, v16
    v_lshl_add_u32 v16, v17, 2, v16
    v_add_u32 v16, 139904, v16
    v_mov_b32 v17, 142080
    v_cmp_gt_u32 vcc, 288, v0
    s_nop 1
    v_cndmask_b32 v15, v17, v15, vcc
    v_cndmask_b32 v16, v17, v16, vcc
    v_add_f32 v27, v27, v67
    v_cvt_pk_bf16_f32 v18, v27, v27
    v_lshlrev_b32 v19, 16, v18
    v_sub_f32 v19, v27, v19
    v_cvt_pk_bf16_f32 v19, v19, v19
    v_and_b32 v18, 0xffff, v18
    v_lshl_or_b32 v18, v19, 16, v18
    v_mov_b32 v19, 0
    ds_write_b32 v15, v18
    ds_write_b32 v16, v19
    ds_read_b64_tr_b16 v[60:61], v73 offset:4736
    ds_read_b64_tr_b16 v[62:63], v73 offset:5888
    s_waitcnt lgkmcnt(10)
    v_mfma_f32_32x32x16_bf16 v[96:111], v[44:47], v[36:39], v[96:111]
    v_mfma_f32_32x32x16_bf16 v[112:127], v[44:47], v[40:43], v[112:127]
    s_add_u32 m0, s56, s50
    s_nop 0
    buffer_load_dwordx4 v8, s[16:19], s54 offen lds
    ds_read_b64_tr_b16 v[44:45], v76 offset:0
    ds_read_b64_tr_b16 v[46:47], v76 offset:1152
    ds_read_b64_tr_b16 v[28:29], v74 offset:0
    ds_read_b64_tr_b16 v[30:31], v74 offset:2048
    ds_read_b64_tr_b16 v[32:33], v75 offset:0
    ds_read_b64_tr_b16 v[34:35], v75 offset:2048
    s_waitcnt lgkmcnt(14)
    v_mfma_f32_32x32x16_bf16 v[128:143], v[48:51], v[36:39], v[128:143]
    v_mfma_f32_32x32x16_bf16 v[144:159], v[48:51], v[40:43], v[144:159]
    s_add_u32 m0, s56, s50
    s_nop 0
    buffer_load_dwordx4 v9, s[16:19], s54 offen offset:1024 lds
    ds_read_b64_tr_b16 v[48:49], v76 offset:32
    ds_read_b64_tr_b16 v[50:51], v76 offset:1184
    s_waitcnt lgkmcnt(14)
    v_mfma_f32_32x32x16_bf16 v[160:175], v[52:55], v[36:39], v[160:175]
    v_mfma_f32_32x32x16_bf16 v[176:191], v[52:55], v[40:43], v[176:191]
    ds_read_b64_tr_b16 v[52:53], v76 offset:64
    ds_read_b64_tr_b16 v[54:55], v76 offset:1216
    s_waitcnt lgkmcnt(14)
    v_mfma_f32_32x32x16_bf16 v[192:207], v[56:59], v[36:39], v[192:207]
    v_mfma_f32_32x32x16_bf16 v[208:223], v[56:59], v[40:43], v[208:223]
    ds_read_b64_tr_b16 v[56:57], v76 offset:96
    ds_read_b64_tr_b16 v[58:59], v76 offset:1248
    s_waitcnt lgkmcnt(12)
    v_mfma_f32_32x32x16_bf16 v[224:239], v[60:63], v[36:39], v[224:239]
    v_mfma_f32_32x32x16_bf16 v[240:255], v[60:63], v[40:43], v[240:255]
    s_add_u32 s70, s70, 1
    ds_read_b64_tr_b16 v[60:61], v76 offset:128
    ds_read_b64_tr_b16 v[62:63], v76 offset:1280
    s_waitcnt lgkmcnt(8)
    v_mfma_f32_32x32x16_bf16 v[96:111], v[44:47], v[28:31], v[96:111]
    v_mfma_f32_32x32x16_bf16 v[112:127], v[44:47], v[32:35], v[112:127]
    s_add_u32 m0, s56, s51
    s_nop 0
    buffer_load_dwordx4 v10, s[20:23], s55 offen lds
    ds_read_b64_tr_b16 v[44:45], v76 offset:4608
    ds_read_b64_tr_b16 v[46:47], v76 offset:5760
    ds_read_b64_tr_b16 v[36:37], v74 offset:8192
    ds_read_b64_tr_b16 v[38:39], v74 offset:10240
    ds_read_b64_tr_b16 v[40:41], v75 offset:8192
    ds_read_b64_tr_b16 v[42:43], v75 offset:10240
    s_waitcnt lgkmcnt(12)
    v_mfma_f32_32x32x16_bf16 v[128:143], v[48:51], v[28:31], v[128:143]
    v_mfma_f32_32x32x16_bf16 v[144:159], v[48:51], v[32:35], v[144:159]
    s_add_u32 m0, s56, s52
    s_nop 0
    buffer_load_dwordx4 v11, s[28:31], s55 offen lds
    s_add_u32 s54, s54, 131072
    s_add_u32 s55, s55, 294912
    s_add_u32 s56, s56, 34944
    s_cmp_eq_u32 s56, 139776
    s_cselect_b32 s56, 0, s56
    ds_read_b64_tr_b16 v[48:49], v76 offset:4640
    ds_read_b64_tr_b16 v[50:51], v76 offset:5792
    s_waitcnt lgkmcnt(12)
    v_mfma_f32_32x32x16_bf16 v[160:175], v[52:55], v[28:31], v[160:175]
    v_mfma_f32_32x32x16_bf16 v[176:191], v[52:55], v[32:35], v[176:191]
    ds_read_b64_tr_b16 v[52:53], v76 offset:4672
    ds_read_b64_tr_b16 v[54:55], v76 offset:5824
    s_waitcnt lgkmcnt(12)
    v_mfma_f32_32x32x16_bf16 v[192:207], v[56:59], v[28:31], v[192:207]
    v_mfma_f32_32x32x16_bf16 v[208:223], v[56:59], v[32:35], v[208:223]
    ds_read_b64_tr_b16 v[56:57], v76 offset:4704
    ds_read_b64_tr_b16 v[58:59], v76 offset:5856
    s_waitcnt lgkmcnt(12)
    v_mfma_f32_32x32x16_bf16 v[224:239], v[60:63], v[28:31], v[224:239]
    v_mfma_f32_32x32x16_bf16 v[240:255], v[60:63], v[32:35], v[240:255]
    s_waitcnt vmcnt(6)
    s_barrier
    ds_read_b64_tr_b16 v[60:61], v76 offset:4736
    ds_read_b64_tr_b16 v[62:63], v76 offset:5888
    s_waitcnt lgkmcnt(8)
    v_mfma_f32_32x32x16_bf16 v[96:111], v[44:47], v[36:39], v[96:111]
    v_mfma_f32_32x32x16_bf16 v[112:127], v[44:47], v[40:43], v[112:127]
    s_add_u32 m0, s56, s50
    s_nop 0
    buffer_load_dwordx4 v8, s[16:19], s54 offen lds
    ds_read_b64_tr_b16 v[44:45], v79 offset:0
    ds_read_b64_tr_b16 v[46:47], v79 offset:1152
    ds_read_b64_tr_b16 v[28:29], v77 offset:0
    ds_read_b64_tr_b16 v[30:31], v77 offset:2048
    ds_read_b64_tr_b16 v[32:33], v78 offset:0
    ds_read_b64_tr_b16 v[34:35], v78 offset:2048
    s_waitcnt lgkmcnt(12)
    v_mfma_f32_32x32x16_bf16 v[128:143], v[48:51], v[36:39], v[128:143]
    v_mfma_f32_32x32x16_bf16 v[144:159], v[48:51], v[40:43], v[144:159]
    s_add_u32 m0, s56, s50
    s_nop 0
    buffer_load_dwordx4 v9, s[16:19], s54 offen offset:1024 lds
    ds_read_b64_tr_b16 v[48:49], v79 offset:32
    ds_read_b64_tr_b16 v[50:51], v79 offset:1184
    s_waitcnt lgkmcnt(12)
    v_mfma_f32_32x32x16_bf16 v[160:175], v[52:55], v[36:39], v[160:175]
    v_mfma_f32_32x32x16_bf16 v[176:191], v[52:55], v[40:43], v[176:191]
    ds_read_b64_tr_b16 v[52:53], v79 offset:64
    ds_read_b64_tr_b16 v[54:55], v79 offset:1216
    s_waitcnt lgkmcnt(12)
    v_mfma_f32_32x32x16_bf16 v[192:207], v[56:59], v[36:39], v[192:207]
    v_mfma_f32_32x32x16_bf16 v[208:223], v[56:59], v[40:43], v[208:223]
    ds_read_b64_tr_b16 v[56:57], v79 offset:96
    ds_read_b64_tr_b16 v[58:59], v79 offset:1248
    s_waitcnt lgkmcnt(12)
    v_mfma_f32_32x32x16_bf16 v[224:239], v[60:63], v[36:39], v[224:239]
    v_mfma_f32_32x32x16_bf16 v[240:255], v[60:63], v[40:43], v[240:255]
    s_getpc_b64 s[4:5]
L_pf_k4A:
    s_sub_u32 s4, s4, L_pf_k4A-k4_kernel
    s_subb_u32 s5, s5, 0
    v_lshlrev_b32 v66, 4, v0
    s_mov_b32 s6, 0
    s_mov_b32 s7, L_k4_done-k4_kernel-4
L_pf_k4A_l:
    v_min_u32 v65, s7, v66
    global_load_dword v67, v65, s[4:5]
    v_add_u32 v66, 8192, v66
    s_add_u32 s6, s6, 8192
    s_cmp_lt_u32 s6, s7
    s_cbranch_scc1 L_pf_k4A_l
    s_add_u32 s70, s70, 1
L_k4_loopA:
    ds_read_b64_tr_b16 v[60:61], v79 offset:128
    ds_read_b64_tr_b16 v[62:63], v79 offset:1280
    s_waitcnt lgkmcnt(8)
    v_mfma_f32_32x32x16_bf16 v[96:111], v[44:47], v[28:31], v[96:111]
    v_mfma_f32_32x32x16_bf16 v[112:127], v[44:47], v[32:35], v[112:127]
    s_add_u32 m0, s56, s51
    s_nop 0
    buffer_load_dwordx4 v10, s[20:23], s55 offen lds
    ds_read_b64_tr_b16 v[44:45], v79 offset:4608
    ds_read_b64_tr_b16 v[46:47], v79 offset:5760
    ds_read_b64_tr_b16 v[36:37], v77 offset:8192
    ds_read_b64_tr_b16 v[38:39], v77 offset:10240
    ds_read_b64_tr_b16 v[40:41], v78 offset:8192
    ds_read_b64_tr_b16 v[42:43], v78 offset:10240
    s_waitcnt lgkmcnt(12)
    v_mfma_f32_32x32x16_bf16 v[128:143], v[48:51], v[28:31], v[128:143]
    v_mfma_f32_32x32x16_bf16 v[144:159], v[48:51], v[32:35], v[144:159]
    s_add_u32 m0, s56, s52
    s_nop 0
    buffer_load_dwordx4 v11, s[28:31], s55 offen lds
    s_add_u32 s54, s54, 131072
    s_add_u32 s55, s55, 294912
    s_add_u32 s56, s56, 34944
    s_cmp_eq_u32 s56, 139776
    s_cselect_b32 s56, 0, s56
    ds_read_b64_tr_b16 v[48:49], v79 offset:4640
    ds_read_b64_tr_b16 v[50:51], v79 offset:5792
    s_waitcnt lgkmcnt(12)
    v_mfma_f32_32x32x16_bf16 v[160:175], v[52:55], v[28:31], v[160:175]
    v_mfma_f32_32x32x16_bf16 v[176:191], v[52:55], v[32:35], v[176:191]
    ds_read_b64_tr_b16 v[52:53], v79 offset:4672
    ds_read_b64_tr_b16 v[54:55], v79 offset:5824
    s_waitcnt lgkmcnt(12)
    v_mfma_f32_32x32x16_bf16 v[192:207], v[56:59], v[28:31], v[192:207]
    v_mfma_f32_32x32x16_bf16 v[208:223], v[56:59], v[32:35], v[208:223]
    ds_read_b64_tr_b16 v[56:57], v79 offset:4704
    ds_read_b64_tr_b16 v[58:59], v79 offset:5856
    s_waitcnt lgkmcnt(12)
    v_mfma_f32_32x32x16_bf16 v[224:239], v[60:63], v[28:31], v[224:239]
    v_mfma_f32_32x32x16_bf16 v[240:255], v[60:63], v[32:35], v[240:255]
    s_waitcnt vmcnt(4)
    s_cmp_eq_u32 s70, 11
    s_cbranch_scc1 L_hkA_0
L_hrA_0:
    s_barrier
    s_cmp_eq_u32 s70, 3
    s_cbranch_scc1 L_hkA_1
L_hrA_1:
    s_cmp_eq_u32 s70, 11
    s_cbranch_scc1 L_hkA_2
L_hrA_2:
    ds_read_b64_tr_b16 v[60:61], v79 offset:4736
    ds_read_b64_tr_b16 v[62:63], v79 offset:5888
    s_waitcnt lgkmcnt(8)
    v_mfma_f32_32x32x16_bf16 v[96:111], v[44:47], v[36:39], v[96:111]
    v_mfma_f32_32x32x16_bf16 v[112:127], v[44:47], v[40:43], v[112:127]
    s_add_u32 m0, s56, s50
    s_nop 0
    buffer_load_dwordx4 v8, s[16:19], s54 offen lds
    ds_read_b64_tr_b16 v[44:45], v70 offset:0
    ds_read_b64_tr_b16 v[46:47], v70 offset:1152
    ds_read_b64_tr_b16 v[28:29], v68 offset:0
    ds_read_b64_tr_b16 v[30:31], v68 offset:2048
    ds_read_b64_tr_b16 v[32:33], v69 offset:0
    ds_read_b64_tr_b16 v[34:35], v69 offset:2048
    s_waitcnt lgkmcnt(12)
    v_mfma_f32_32x32x16_bf16 v[128:143], v[48:51], v[36:39], v[128:143]
    v_mfma_f32_32x32x16_bf16 v[144:159], v[48:51], v[40:43], v[144:159]
    s_add_u32 m0, s56, s50
    s_nop 0
    buffer_load_dwordx4 v9, s[16:19], s54 offen offset:1024 lds
    ds_read_b64_tr_b16 v[48:49], v70 offset:32
    ds_read_b64_tr_b16 v[50:51], v70 offset:1184
    s_waitcnt lgkmcnt(12)
    v_mfma_f32_32x32x16_bf16 v[160:175], v[52:55], v[36:39], v[160:175]
    v_mfma_f32_32x32x16_bf16 v[176:191], v[52:55], v[40:43], v[176:191]
    ds_read_b64_tr_b16 v[52:53], v70 offset:64
    ds_read_b64_tr_b16 v[54:55], v70 offset:1216
    s_waitcnt lgkmcnt(12)
    v_mfma_f32_32x32x16_bf16 v[192:207], v[56:59], v[36:39], v[192:207]
    v_mfma_f32_32x32x16_bf16 v[208:223], v[56:59], v[40:43], v[208:223]
    ds_read_b64_tr_b16 v[56:57], v70 offset:96
    ds_read_b64_tr_b16 v[58:59], v70 offset:1248
    s_waitcnt lgkmcnt(12)
    v_mfma_f32_32x32x16_bf16 v[224:239], v[60:63], v[36:39], v[224:239]
    v_mfma_f32_32x32x16_bf16 v[240:255], v[60:63], v[40:43], v[240:255]
    s_add_u32 s70, s70, 1
    ds_read_b64_tr_b16 v[60:61], v70 offset:128
    ds_read_b64_tr_b16 v[62:63], v70 offset:1280
    s_waitcnt lgkmcnt(8)
    v_mfma_f32_32x32x16_bf16 v[96:111], v[44:47], v[28:31], v[96:111]
    v_mfma_f32_32x32x16_bf16 v[112:127], v[44:47], v[32:35], v[112:127]
    s_add_u32 m0, s56, s51
    s_nop 0
    buffer_load_dwordx4 v10, s[20:23], s55 offen lds
    ds_read_b64_tr_b16 v[44:45], v70 offset:4608
    ds_read_b64_tr_b16 v[46:47], v70 offset:5760
    ds_read_b64_tr_b16 v[36:37], v68 offset:8192
    ds_read_b64_tr_b16 v[38:39], v68 offset:10240
    ds_read_b64_tr_b16 v[40:41], v69 offset:8192
    ds_read_b64_tr_b16 v[42:43], v69 offset:10240
    s_waitcnt lgkmcnt(12)
    v_mfma_f32_32x32x16_bf16 v[128:143], v[48:51], v[28:31], v[128:143]
    v_mfma_f32_32x32x16_bf16 v[144:159], v[48:51], v[32:35], v[144:159]
    s_add_u32 m0, s56, s52
    s_nop 0
    buffer_load_dwordx4 v11, s[28:31], s55 offen lds
    s_add_u32 s54, s54, 131072
    s_add_u32 s55, s55, 294912
    s_add_u32 s56, s56, 34944
    s_cmp_eq_u32 s56, 139776
    s_cselect_b32 s56, 0, s56
    ds_read_b64_tr_b16 v[48:49], v70 offset:4640
    ds_read_b64_tr_b16 v[50:51], v70 offset:5792
    s_waitcnt lgkmcnt(12)
    v_mfma_f32_32x32x16_bf16 v[160:175], v[52:55], v[28:31], v[160:175]
    v_mfma_f32_32x32x16_bf16 v[176:191], v[52:55], v[32:35], v[176:191]
    ds_read_b64_tr_b16 v[52:53], v70 offset:4672
    ds_read_b64_tr_b16 v[54:55], v70 offset:5824
    s_waitcnt lgkmcnt(12)
    v_mfma_f32_32x32x16_bf16 v[192:207], v[56:59], v[28:31], v[192:207]
    v_mfma_f32_32x32x16_bf16 v[208:223], v[56:59], v[32:35], v[208:223]
    ds_read_b64_tr_b16 v[56:57], v70 offset:4704
    ds_read_b64_tr_b16 v[58:59], v70 offset:5856
    s_waitcnt lgkmcnt(12)
    v_mfma_f32_32x32x16_bf16 v[224:239], v[60:63], v[28:31], v[224:239]
    v_mfma_f32_32x32x16_bf16 v[240:255], v[60:63], v[32:35], v[240:255]
    s_waitcnt vmcnt(4)
    s_barrier
    ds_read_b64_tr_b16 v[60:61], v70 offset:4736
    ds_read_b64_tr_b16 v[62:63], v70 offset:5888
    s_waitcnt lgkmcnt(8)
    v_mfma_f32_32x32x16_bf16 v[96:111], v[44:47], v[36:39], v[96:111]
    v_mfma_f32_32x32x16_bf16 v[112:127], v[44:47], v[40:43], v[112:127]
    s_add_u32 m0, s56, s50
    s_nop 0
    buffer_load_dwordx4 v8, s[16:19], s54 offen lds
    ds_read_b64_tr_b16 v[44:45], v73 offset:0
    ds_read_b64_tr_b16 v[46:47], v73 offset:1152
    ds_read_b64_tr_b16 v[28:29], v71 offset:0
    ds_read_b64_tr_b16 v[30:31], v71 offset:2048
    ds_read_b64_tr_b16 v[32:33], v72 offset:0
    ds_read_b64_tr_b16 v[34:35], v72 offset:2048
    s_waitcnt lgkmcnt(12)
    v_mfma_f32_32x32x16_bf16 v[128:143], v[48:51], v[36:39], v[128:143]
    v_mfma_f32_32x32x16_bf16 v[144:159], v[48:51], v[40:43], v[144:159]
    s_add_u32 m0, s56, s50
    s_nop 0
    buffer_load_dwordx4 v9, s[16:19], s54 offen offset:1024 lds
    ds_read_b64_tr_b16 v[48:49], v73 offset:32
    ds_read_b64_tr_b16 v[50:51], v73 offset:1184
    s_waitcnt lgkmcnt(12)
    v_mfma_f32_32x32x16_bf16 v[160:175], v[52:55], v[36:39], v[160:175]
    v_mfma_f32_32x32x16_bf16 v[176:191], v[52:55], v[40:43], v[176:191]
    ds_read_b64_tr_b16 v[52:53], v73 offset:64
    ds_read_b64_tr_b16 v[54:55], v73 offset:1216
    s_waitcnt lgkmcnt(12)
    v_mfma_f32_32x32x16_bf16 v[192:207], v[56:59], v[36:39], v[192:207]
    v_mfma_f32_32x32x16_bf16 v[208:223], v[56:59], v[40:43], v[208:223]
    ds_read_b64_tr_b16 v[56:57], v73 offset:96
    ds_read_b64_tr_b16 v[58:59], v73 offset:1248
    s_waitcnt lgkmcnt(12)
    v_mfma_f32_32x32x16_bf16 v[224:239], v[60:63], v[36:39], v[224:239]
    v_mfma_f32_32x32x16_bf16 v[240:255], v[60:63], v[40:43], v[240:255]
    s_add_u32 s70, s70, 1
    ds_read_b64_tr_b16 v[60:61], v73 offset:128
    ds_read_b64_tr_b16 v[62:63], v73 offset:1280
    s_waitcnt lgkmcnt(8)
    v_mfma_f32_32x32x16_bf16 v[96:111], v[44:47], v[28:31], v[96:111]
    v_mfma_f32_32x32x16_bf16 v[112:127], v[44:47], v[32:35], v[112:127]
    s_cmp_eq_u32 s70, 9
    s_cbranch_scc1 L_hkA_3
L_hrA_3:
    s_add_u32 m0, s56, s51
    s_nop 0
    buffer_load_dwordx4 v10, s[20:23], s55 offen lds
    ds_read_b64_tr_b16 v[44:45], v73 offset:4608
    ds_read_b64_tr_b16 v[46:47], v73 offset:5760
    ds_read_b64_tr_b16 v[36:37], v71 offset:8192
    ds_read_b64_tr_b16 v[38:39], v71 offset:10240
    ds_read_b64_tr_b16 v[40:41], v72 offset:8192
    ds_read_b64_tr_b16 v[42:43], v72 offset:10240
    s_waitcnt lgkmcnt(12)
    v_mfma_f32_32x32x16_bf16 v[128:143], v[48:51], v[28:31], v[128:143]
    v_mfma_f32_32x32x16_bf16 v[144:159], v[48:51], v[32:35], v[144:159]
    s_add_u32 m0, s56, s52
    s_nop 0
    buffer_load_dwordx4 v11, s[28:31], s55 offen lds
    s_add_u32 s54, s54, 131072
    s_add_u32 s55, s55, 294912
    s_add_u32 s56, s56, 34944
    s_cmp_eq_u32 s56, 139776
    s_cselect_b32 s56, 0, s56
    ds_read_b64_tr_b16 v[48:49], v73 offset:4640
    ds_read_b64_tr_b16 v[50:51], v73 offset:5792
    s_waitcnt lgkmcnt(12)
    v_mfma_f32_32x32x16_bf16 v[160:175], v[52:55], v[28:31], v[160:175]
    v_mfma_f32_32x32x16_bf16 v[176:191], v[52:55], v[32:35], v[176:191]
    ds_read_b64_tr_b16 v[52:53], v73 offset:4672
    ds_read_b64_tr_b16 v[54:55], v73 offset:5824
    s_waitcnt lgkmcnt(12)
    v_mfma_f32_32x32x16_bf16 v[192:207], v[56:59], v[28:31], v[192:207]
    v_mfma_f32_32x32x16_bf16 v[208:223], v[56:59], v[32:35], v[208:223]
    ds_read_b64_tr_b16 v[56:57], v73 offset:4704
    ds_read_b64_tr_b16 v[58:59], v73 offset:5856
    s_waitcnt lgkmcnt(12)
    v_mfma_f32_32x32x16_bf16 v[224:239], v[60:63], v[28:31], v[224:239]
    v_mfma_f32_32x32x16_bf16 v[240:255], v[60:63], v[32:35], v[240:255]
    s_waitcnt vmcnt(4)
    s_barrier
    s_cmp_eq_u32 s70, 13
    s_cbranch_scc1 L_hkA_4
L_hrA_4:
    ds_read_b64_tr_b16 v[60:61], v73 offset:4736
    ds_read_b64_tr_b16 v[62:63], v73 offset:5888
    s_waitcnt lgkmcnt(8)
    v_mfma_f32_32x32x16_bf16 v[96:111], v[44:47], v[36:39], v[96:111]
    v_mfma_f32_32x32x16_bf16 v[112:127], v[44:47], v[40:43], v[112:127]
    s_add_u32 m0, s56, s50
    s_nop 0
    buffer_load_dwordx4 v8, s[16:19], s54 offen lds
    ds_read_b64_tr_b16 v[44:45], v76 offset:0
    ds_read_b64_tr_b16 v[46:47], v76 offset:1152
    ds_read_b64_tr_b16 v[28:29], v74 offset:0
    ds_read_b64_tr_b16 v[30:31], v74 offset:2048
    ds_read_b64_tr_b16 v[32:33], v75 offset:0
    ds_read_b64_tr_b16 v[34:35], v75 offset:2048
    s_waitcnt lgkmcnt(12)
    v_mfma_f32_32x32x16_bf16 v[128:143], v[48:51], v[36:39], v[128:143]
    v_mfma_f32_32x32x16_bf16 v[144:159], v[48:51], v[40:43], v[144:159]
    s_add_u32 m0, s56, s50
    s_nop 0
    buffer_load_dwordx4 v9, s[16:19], s54 offen offset:1024 lds
    ds_read_b64_tr_b16 v[48:49], v76 offset:32
    ds_read_b64_tr_b16 v[50:51], v76 offset:1184
    s_waitcnt lgkmcnt(12)
    v_mfma_f32_32x32x16_bf16 v[160:175], v[52:55], v[36:39], v[160:175]
    v_mfma_f32_32x32x16_bf16 v[176:191], v[52:55], v[40:43], v[176:191]
    ds_read_b64_tr_b16 v[52:53], v76 offset:64
    ds_read_b64_tr_b16 v[54:55], v76 offset:1216
    s_waitcnt lgkmcnt(12)
    v_mfma_f32_32x32x16_bf16 v[192:207], v[56:59], v[36:39], v[192:207]
    v_mfma_f32_32x32x16_bf16 v[208:223], v[56:59], v[40:43], v[208:223]
    ds_read_b64_tr_b16 v[56:57], v76 offset:96
    ds_read_b64_tr_b16 v[58:59], v76 offset:1248
    s_waitcnt lgkmcnt(12)
    v_mfma_f32_32x32x16_bf16 v[224:239], v[60:63], v[36:39], v[224:239]
    v_mfma_f32_32x32x16_bf16 v[240:255], v[60:63], v[40:43], v[240:255]
    s_add_u32 s70, s70, 1
    ds_read_b64_tr_b16 v[60:61], v76 offset:128
    ds_read_b64_tr_b16 v[62:63], v76 offset:1280
    s_waitcnt lgkmcnt(8)
    v_mfma_f32_32x32x16_bf16 v[96:111], v[44:47], v[28:31], v[96:111]
    v_mfma_f32_32x32x16_bf16 v[112:127], v[44:47], v[32:35], v[112:127]
    s_add_u32 m0, s56, s51
    s_nop 0
    buffer_load_dwordx4 v10, s[20:23], s55 offen lds
    ds_read_b64_tr_b16 v[44:45], v76 offset:4608
    ds_read_b64_tr_b16 v[46:47], v76 offset:5760
    ds_read_b64_tr_b16 v[36:37], v74 offset:8192
    ds_read_b64_tr_b16 v[38:39], v74 offset:10240
    ds_read_b64_tr_b16 v[40:41], v75 offset:8192
    ds_read_b64_tr_b16 v[42:43], v75 offset:10240
    s_waitcnt lgkmcnt(12)
    v_mfma_f32_32x32x16_bf16 v[128:143], v[48:51], v[28:31], v[128:143]
    v_mfma_f32_32x32x16_bf16 v[144:159], v[48:51], v[32:35], v[144:159]
    s_add_u32 m0, s56, s52
    s_nop 0
    buffer_load_dwordx4 v11, s[28:31], s55 offen lds
    s_add_u32 s54, s54, 131072
    s_add_u32 s55, s55, 294912
    s_add_u32 s56, s56, 34944
    s_cmp_eq_u32 s56, 139776
    s_cselect_b32 s56, 0, s56
    ds_read_b64_tr_b16 v[48:49], v76 offset:4640
    ds_read_b64_tr_b16 v[50:51], v76 offset:5792
    s_waitcnt lgkmcnt(12)
    v_mfma_f32_32x32x16_bf16 v[160:175], v[52:55], v[28:31], v[160:175]
    v_mfma_f32_32x32x16_bf16 v[176:191], v[52:55], v[32:35], v[176:191]
    ds_read_b64_tr_b16 v[52:53], v76 offset:4672
    ds_read_b64_tr_b16 v[54:55], v76 offset:5824
    s_waitcnt lgkmcnt(12)
    v_mfma_f32_32x32x16_bf16 v[192:207], v[56:59], v[28:31], v[192:207]
    v_mfma_f32_32x32x16_bf16 v[208:223], v[56:59], v[32:35], v[208:223]
    ds_read_b64_tr_b16 v[56:57], v76 offset:4704
    ds_read_b64_tr_b16 v[58:59], v76 offset:5856
    s_waitcnt lgkmcnt(12)
    v_mfma_f32_32x32x16_bf16 v[224:239], v[60:63], v[28:31], v[224:239]
    v_mfma_f32_32x32x16_bf16 v[240:255], v[60:63], v[32:35], v[240:255]
    s_waitcnt vmcnt(4)
    s_barrier
    ds_read_b64_tr_b16 v[60:61], v76 offset:4736
    ds_read_b64_tr_b16 v[62:63], v76 offset:5888
    s_waitcnt lgkmcnt(8)
    v_mfma_f32_32x32x16_bf16 v[96:111], v[44:47], v[36:39], v[96:111]
    v_mfma_f32_32x32x16_bf16 v[112:127], v[44:47], v[40:43], v[112:127]
    s_add_u32 m0, s56, s50
    s_nop 0
    buffer_load_dwordx4 v8, s[16:19], s54 offen lds
    ds_read_b64_tr_b16 v[44:45], v79 offset:0
    ds_read_b64_tr_b16 v[46:47], v79 offset:1152
    ds_read_b64_tr_b16 v[28:29], v77 offset:0
    ds_read_b64_tr_b16 v[30:31], v77 offset:2048
    ds_read_b64_tr_b16 v[32:33], v78 offset:0
    ds_read_b64_tr_b16 v[34:35], v78 offset:2048
    s_waitcnt lgkmcnt(12)
    v_mfma_f32_32x32x16_bf16 v[128:143], v[48:51], v[36:39], v[128:143]
    v_mfma_f32_32x32x16_bf16 v[144:159], v[48:51], v[40:43], v[144:159]
    s_add_u32 m0, s56, s50
    s_nop 0
    buffer_load_dwordx4 v9, s[16:19], s54 offen offset:1024 lds
    ds_read_b64_tr_b16 v[48:49], v79 offset:32
    ds_read_b64_tr_b16 v[50:51], v79 offset:1184
    s_waitcnt lgkmcnt(12)
    v_mfma_f32_32x32x16_bf16 v[160:175], v[52:55], v[36:39], v[160:175]
    v_mfma_f32_32x32x16_bf16 v[176:191], v[52:55], v[40:43], v[176:191]
    ds_read_b64_tr_b16 v[52:53], v79 offset:64
    ds_read_b64_tr_b16 v[54:55], v79 offset:1216
    s_waitcnt lgkmcnt(12)
    v_mfma_f32_32x32x16_bf16 v[192:207], v[56:59], v[36:39], v[192:207]
    v_mfma_f32_32x32x16_bf16 v[208:223], v[56:59], v[40:43], v[208:223]
    ds_read_b64_tr_b16 v[56:57], v79 offset:96
    ds_read_b64_tr_b16 v[58:59], v79 offset:1248
    s_waitcnt lgkmcnt(12)
    v_mfma_f32_32x32x16_bf16 v[224:239], v[60:63], v[36:39], v[224:239]
    v_mfma_f32_32x32x16_bf16 v[240:255], v[60:63], v[40:43], v[240:255]
    s_add_u32 s70, s70, 1
    s_cmp_lt_u32 s70, 15
    s_cbranch_scc1 L_k4_loopA
    s_branch L_k4_postA
L_hkA_0:
    s_nop 4
    s_cmp_eq_u32 s15, 0
    s_cbranch_scc0 L_pollokA
    s_mov_b32 s46, 0
L_pollA:
    v_readfirstlane_b32 s44, v66
    s_nop 3
    s_cmp_ge_u32 s44, 32
    s_cbranch_scc1 L_pollokA
    s_add_u32 s46, s46, 1
    s_cmp_ge_u32 s46, 100000
    s_cbranch_scc1 L_pollokA
    s_sleep 8
    s_mov_b64 s[44:45], exec
    s_mov_b64 exec, 1
    global_atomic_add v66, v64, v65, s[40:41] sc0
    s_waitcnt vmcnt(0)
    s_mov_b64 exec, s[44:45]
    s_branch L_pollA
L_pollokA:
    s_nop 4
    s_branch L_hrA_0
L_hkA_1:
    s_nop 4
    s_cmp_eq_u32 s15, 0
    s_cbranch_scc0 L_nosigA
    s_lshl_b32 s44, s13, 2
    v_mov_b32 v64, s44
    v_mov_b32 v65, 1
    s_mov_b64 s[44:45], exec
    s_mov_b64 exec, 1
    global_atomic_add v64, v65, s[40:41]
    s_mov_b64 exec, s[44:45]
L_nosigA:
    s_nop 4
    s_branch L_hrA_1
L_hkA_2:
    s_nop 4
    v_and_b32 v64, 31, v1
    v_lshlrev_b32 v64, 2, v64
    s_lshl_b32 s44, s59, 2
    v_add_u32 v64, s44, v64
    global_load_dword v80, v64, s[64:65] sc1
    global_load_dword v81, v64, s[64:65] offset:128 sc1
    global_load_dword v82, v64, s[66:67] sc1
    global_load_dword v83, v64, s[66:67] offset:128 sc1
    s_nop 4
    s_branch L_hrA_2
L_hkA_3:
    s_nop 4
    s_cmp_eq_u32 s15, 0
    s_cbranch_scc0 L_nopollA
    s_lshl_b32 s44, s13, 2
    v_mov_b32 v64, s44
    v_mov_b32 v65, 0
    s_mov_b64 s[44:45], exec
    s_mov_b64 exec, 1
    global_atomic_add v66, v64, v65, s[40:41] sc0
    s_mov_b64 exec, s[44:45]
L_nopollA:
    s_nop 4
    s_branch L_hrA_3
L_hkA_4:
    s_nop 4
    v_mul_f32 v64, 0x3ae38e39, v80
    v_mul_f32 v65, 0x3ae38e39, v82
    v_fma_f32 v65, -v64, v64, v65
    v_max_f32 v65, 0, v65
    v_cvt_pk_bf16_f32 v66, v64, v65
    v_and_b32 v65, 0xffff0000, v66
    v_and_b32 v64, 0xffff, v66
    v_add_f32 v65, 0x3727c5ac, v65
    v_xor_b32 v64, 0x8000, v64
    v_cvt_pk_bf16_f32 v66, v65, v65
    v_lshl_or_b32 v64, v64, 16, v64
    v_lshlrev_b32 v65, 16, v66
    v_cmp_gt_u32 vcc, 32, v1
    v_sqrt_f32 v65, v65
    v_mov_b32 v89, 0
    v_cndmask_b32 v88, 0, v64, vcc
    v_cvt_pk_bf16_f32 v66, v65, v65
    v_mov_b32 v90, 0
    v_lshlrev_b32 v65, 16, v66
    v_mov_b32 v91, 0
    v_rcp_f32 v66, v65
    v_mul_f32 v84, v65, v65
    v_mul_f32 v80, 0xc0135761, v66
    v_mul_f32 v65, v66, v66
    v_mul_f32 v65, v65, v66
    v_mul_f32 v82, 0xbdd2d3e8, v65
    v_mul_f32 v64, 0x3ae38e39, v81
    v_mul_f32 v65, 0x3ae38e39, v83
    v_fma_f32 v65, -v64, v64, v65
    v_max_f32 v65, 0, v65
    v_cvt_pk_bf16_f32 v66, v64, v65
    v_and_b32 v65, 0xffff0000, v66
    v_and_b32 v64, 0xffff, v66
    v_add_f32 v65, 0x3727c5ac, v65
    v_xor_b32 v64, 0x8000, v64
    v_cvt_pk_bf16_f32 v66, v65, v65
    v_lshl_or_b32 v64, v64, 16, v64
    v_lshlrev_b32 v65, 16, v66
    v_cmp_gt_u32 vcc, 32, v1
    v_sqrt_f32 v65, v65
    v_mov_b32 v93, 0
    v_cndmask_b32 v92, 0, v64, vcc
    v_cvt_pk_bf16_f32 v66, v65, v65
    v_mov_b32 v94, 0
    v_lshlrev_b32 v65, 16, v66
    v_mov_b32 v95, 0
    v_rcp_f32 v66, v65
    v_mul_f32 v85, v65, v65
    v_mul_f32 v81, 0xc0135761, v66
    v_mul_f32 v65, v66, v66
    v_mul_f32 v65, v65, v66
    v_mul_f32 v83, 0xbdd2d3e8, v65
    s_nop 4
    s_branch L_hrA_4
L_k4_postA:
    s_waitcnt lgkmcnt(0)
    v_mov_b32 v15, 0
    v_mov_b32 v16, 0
    v_mov_b32 v17, 0
    v_mov_b32 v19, 0
    v_mov_b32 v20, 0
    v_mov_b32 v21, 0
    v_lshlrev_b32 v13, 2, v1
    v_add_u32 v13, 139776, v13
    ds_read_b32 v14, v13 offset:0
    ds_read_b32 v18, v13 offset:256
    s_waitcnt lgkmcnt(1)
    v_mfma_f32_32x32x16_bf16 v[96:111], v[14:17], v[88:91], v[96:111]
    v_mfma_f32_32x32x16_bf16 v[112:127], v[14:17], v[92:95], v[112:127]
    ds_read_b32 v14, v13 offset:512
    s_waitcnt lgkmcnt(1)
    v_mfma_f32_32x32x16_bf16 v[128:143], v[18:21], v[88:91], v[128:143]
    v_mfma_f32_32x32x16_bf16 v[144:159], v[18:21], v[92:95], v[144:159]
    ds_read_b32 v18, v13 offset:768
    s_waitcnt lgkmcnt(1)
    v_mfma_f32_32x32x16_bf16 v[160:175], v[14:17], v[88:91], v[160:175]
    v_mfma_f32_32x32x16_bf16 v[176:191], v[14:17], v[92:95], v[176:191]
    ds_read_b32 v14, v13 offset:1024
    s_waitcnt lgkmcnt(1)
    v_mfma_f32_32x32x16_bf16 v[192:207], v[18:21], v[88:91], v[192:207]
    v_mfma_f32_32x32x16_bf16 v[208:223], v[18:21], v[92:95], v[208:223]
    s_waitcnt lgkmcnt(0)
    v_mfma_f32_32x32x16_bf16 v[224:239], v[14:17], v[88:91], v[224:239]
    v_mfma_f32_32x32x16_bf16 v[240:255], v[14:17], v[92:95], v[240:255]
    ds_read_b64_tr_b16 v[28:29], v77 offset:0
    ds_read_b64_tr_b16 v[30:31], v77 offset:2048
    ds_read_b64_tr_b16 v[32:33], v78 offset:0
    ds_read_b64_tr_b16 v[34:35], v78 offset:2048
    ds_read_b64_tr_b16 v[44:45], v79 offset:0
    ds_read_b64_tr_b16 v[46:47], v79 offset:1152
    ds_read_b64_tr_b16 v[48:49], v79 offset:32
    ds_read_b64_tr_b16 v[50:51], v79 offset:1184
    ds_read_b64_tr_b16 v[36:37], v77 offset:8192
    ds_read_b64_tr_b16 v[38:39], v77 offset:10240
    ds_read_b64_tr_b16 v[40:41], v78 offset:8192
    ds_read_b64_tr_b16 v[42:43], v78 offset:10240
    ds_read_b64_tr_b16 v[52:53], v79 offset:4608
    ds_read_b64_tr_b16 v[54:55], v79 offset:5760
    ds_read_b64_tr_b16 v[56:57], v79 offset:4640
    ds_read_b64_tr_b16 v[58:59], v79 offset:5792
    s_add_u32 m0, s56, s51
    s_nop 0
    buffer_load_dwordx4 v10, s[20:23], s55 offen lds
    s_add_u32 m0, s56, s52
    s_nop 0
    buffer_load_dwordx4 v11, s[28:31], s55 offen lds
    s_add_u32 s54, s54, 131072
    s_add_u32 s55, s55, 294912
    s_add_u32 s56, s56, 34944
    s_cmp_eq_u32 s56, 139776
    s_cselect_b32 s56, 0, s56
    s_waitcnt lgkmcnt(8)
    v_mfma_f32_32x32x16_bf16 v[96:111], v[44:47], v[28:31], v[96:111]
    v_mfma_f32_32x32x16_bf16 v[112:127], v[44:47], v[32:35], v[112:127]
    v_mfma_f32_32x32x16_bf16 v[128:143], v[48:51], v[28:31], v[128:143]
    v_mfma_f32_32x32x16_bf16 v[144:159], v[48:51], v[32:35], v[144:159]
    s_waitcnt vmcnt(4)
    s_barrier
    ds_read_b64_tr_b16 v[28:29], v68 offset:0
    ds_read_b64_tr_b16 v[30:31], v68 offset:2048
    ds_read_b64_tr_b16 v[32:33], v69 offset:0
    ds_read_b64_tr_b16 v[34:35], v69 offset:2048
    ds_read_b64_tr_b16 v[44:45], v70 offset:0
    ds_read_b64_tr_b16 v[46:47], v70 offset:1152
    ds_read_b64_tr_b16 v[48:49], v70 offset:32
    ds_read_b64_tr_b16 v[50:51], v70 offset:1184
    s_waitcnt lgkmcnt(8)
    v_mfma_f32_32x32x16_bf16 v[96:111], v[52:55], v[36:39], v[96:111]
    v_mfma_f32_32x32x16_bf16 v[112:127], v[52:55], v[40:43], v[112:127]
    v_mfma_f32_32x32x16_bf16 v[128:143], v[56:59], v[36:39], v[128:143]
    v_mfma_f32_32x32x16_bf16 v[144:159], v[56:59], v[40:43], v[144:159]
    ds_read_b64_tr_b16 v[36:37], v68 offset:8192
    ds_read_b64_tr_b16 v[38:39], v68 offset:10240
    ds_read_b64_tr_b16 v[40:41], v69 offset:8192
    ds_read_b64_tr_b16 v[42:43], v69 offset:10240
    ds_read_b64_tr_b16 v[52:53], v70 offset:4608
    ds_read_b64_tr_b16 v[54:55], v70 offset:5760
    ds_read_b64_tr_b16 v[56:57], v70 offset:4640
    ds_read_b64_tr_b16 v[58:59], v70 offset:5792
    s_waitcnt lgkmcnt(8)
    v_mfma_f32_32x32x16_bf16 v[96:111], v[44:47], v[28:31], v[96:111]
    v_mfma_f32_32x32x16_bf16 v[112:127], v[44:47], v[32:35], v[112:127]
    v_mfma_f32_32x32x16_bf16 v[128:143], v[48:51], v[28:31], v[128:143]
    v_mfma_f32_32x32x16_bf16 v[144:159], v[48:51], v[32:35], v[144:159]
    s_waitcnt vmcnt(0)
    s_barrier
    ds_read_b64_tr_b16 v[28:29], v71 offset:0
    ds_read_b64_tr_b16 v[30:31], v71 offset:2048
    ds_read_b64_tr_b16 v[32:33], v72 offset:0
    ds_read_b64_tr_b16 v[34:35], v72 offset:2048
    ds_read_b64_tr_b16 v[44:45], v73 offset:0
    ds_read_b64_tr_b16 v[46:47], v73 offset:1152
    ds_read_b64_tr_b16 v[48:49], v73 offset:32
    ds_read_b64_tr_b16 v[50:51], v73 offset:1184
    s_waitcnt lgkmcnt(8)
    v_mfma_f32_32x32x16_bf16 v[96:111], v[52:55], v[36:39], v[96:111]
    v_mfma_f32_32x32x16_bf16 v[112:127], v[52:55], v[40:43], v[112:127]
    v_mfma_f32_32x32x16_bf16 v[128:143], v[56:59], v[36:39], v[128:143]
    v_mfma_f32_32x32x16_bf16 v[144:159], v[56:59], v[40:43], v[144:159]
    ds_read_b64_tr_b16 v[36:37], v71 offset:8192
    ds_read_b64_tr_b16 v[38:39], v71 offset:10240
    ds_read_b64_tr_b16 v[40:41], v72 offset:8192
    ds_read_b64_tr_b16 v[42:43], v72 offset:10240
    ds_read_b64_tr_b16 v[52:53], v73 offset:4608
    ds_read_b64_tr_b16 v[54:55], v73 offset:5760
    ds_read_b64_tr_b16 v[56:57], v73 offset:4640
    ds_read_b64_tr_b16 v[58:59], v73 offset:5792
    s_waitcnt lgkmcnt(8)
    v_mfma_f32_32x32x16_bf16 v[96:111], v[44:47], v[28:31], v[96:111]
    v_mfma_f32_32x32x16_bf16 v[112:127], v[44:47], v[32:35], v[112:127]
    v_mfma_f32_32x32x16_bf16 v[128:143], v[48:51], v[28:31], v[128:143]
    v_mfma_f32_32x32x16_bf16 v[144:159], v[48:51], v[32:35], v[144:159]
    ds_read_b64_tr_b16 v[28:29], v77 offset:0
    ds_read_b64_tr_b16 v[30:31], v77 offset:2048
    ds_read_b64_tr_b16 v[32:33], v78 offset:0
    ds_read_b64_tr_b16 v[34:35], v78 offset:2048
    ds_read_b64_tr_b16 v[44:45], v79 offset:64
    ds_read_b64_tr_b16 v[46:47], v79 offset:1216
    ds_read_b64_tr_b16 v[48:49], v79 offset:96
    ds_read_b64_tr_b16 v[50:51], v79 offset:1248
    s_waitcnt lgkmcnt(8)
    v_mfma_f32_32x32x16_bf16 v[96:111], v[52:55], v[36:39], v[96:111]
    v_mfma_f32_32x32x16_bf16 v[112:127], v[52:55], v[40:43], v[112:127]
    v_mfma_f32_32x32x16_bf16 v[128:143], v[56:59], v[36:39], v[128:143]
    v_mfma_f32_32x32x16_bf16 v[144:159], v[56:59], v[40:43], v[144:159]
    ds_read_b64_tr_b16 v[36:37], v77 offset:8192
    ds_read_b64_tr_b16 v[38:39], v77 offset:10240
    ds_read_b64_tr_b16 v[40:41], v78 offset:8192
    ds_read_b64_tr_b16 v[42:43], v78 offset:10240
    ds_read_b64_tr_b16 v[52:53], v79 offset:4672
    ds_read_b64_tr_b16 v[54:55], v79 offset:5824
    ds_read_b64_tr_b16 v[56:57], v79 offset:4704
    ds_read_b64_tr_b16 v[58:59], v79 offset:5856
    s_waitcnt lgkmcnt(8)
    v_mfma_f32_32x32x16_bf16 v[160:175], v[44:47], v[28:31], v[160:175]
    s_add_u32 s44, s62, 0
    s_lshr_b32 s45, s44, 1
    s_lshl_b32 s45, s45, 12
    s_and_b32 s44, s44, 1
    s_lshl_b32 s44, s44, 9
    s_add_u32 s45, s45, s44
    v_mfma_f32_32x32x16_bf16 v[176:191], v[44:47], v[32:35], v[176:191]
    s_add_u32 s68, s45, s61
    s_add_u32 s69, s68, 2048
    v_mul_f32 v14, v96, v96
    v_mul_f32 v16, v97, v97
    v_fma_f32 v14, v14, v82, v80
    v_fma_f32 v16, v16, v82, v80
    v_mfma_f32_32x32x16_bf16 v[192:207], v[48:51], v[28:31], v[192:207]
    v_mul_f32 v14, v14, v96
    v_mul_f32 v16, v16, v97
    v_exp_f32 v14, v14
    v_exp_f32 v16, v16
    v_mul_f32 v15, v96, v104
    v_mul_f32 v17, v97, v105
    v_mfma_f32_32x32x16_bf16 v[208:223], v[48:51], v[32:35], v[208:223]
    v_fma_f32 v14, v14, v84, v84
    v_fma_f32 v16, v16, v84, v84
    v_rcp_f32 v14, v14
    v_rcp_f32 v16, v16
    v_mul_f32 v15, v15, v14
    v_mul_f32 v17, v17, v16
    ds_read_b64_tr_b16 v[28:29], v68 offset:0
    ds_read_b64_tr_b16 v[30:31], v68 offset:2048
    ds_read_b64_tr_b16 v[32:33], v69 offset:0
    ds_read_b64_tr_b16 v[34:35], v69 offset:2048
    ds_read_b64_tr_b16 v[44:45], v70 offset:64
    ds_read_b64_tr_b16 v[46:47], v70 offset:1216
    ds_read_b64_tr_b16 v[48:49], v70 offset:96
    ds_read_b64_tr_b16 v[50:51], v70 offset:1248
    s_waitcnt lgkmcnt(8)
    v_mfma_f32_32x32x16_bf16 v[160:175], v[52:55], v[36:39], v[160:175]
    v_cvt_pk_bf16_f32 v64, v15, v17
    v_mul_f32 v18, v98, v98
    v_mul_f32 v20, v99, v99
    v_fma_f32 v18, v18, v82, v80
    v_fma_f32 v20, v20, v82, v80
    v_mul_f32 v18, v18, v98
    v_mfma_f32_32x32x16_bf16 v[176:191], v[52:55], v[40:43], v[176:191]
    v_mul_f32 v20, v20, v99
    v_exp_f32 v18, v18
    v_exp_f32 v20, v20
    v_mul_f32 v19, v98, v106
    v_mul_f32 v21, v99, v107
    v_fma_f32 v18, v18, v84, v84
    v_mfma_f32_32x32x16_bf16 v[192:207], v[56:59], v[36:39], v[192:207]
    v_fma_f32 v20, v20, v84, v84
    v_rcp_f32 v18, v18
    v_rcp_f32 v20, v20
    v_mul_f32 v19, v19, v18
    v_mul_f32 v21, v21, v20
    v_cvt_pk_bf16_f32 v65, v19, v21
    v_mfma_f32_32x32x16_bf16 v[208:223], v[56:59], v[40:43], v[208:223]
    v_mul_f32 v14, v100, v100
    v_mul_f32 v16, v101, v101
    v_fma_f32 v14, v14, v82, v80
    v_fma_f32 v16, v16, v82, v80
    v_mul_f32 v14, v14, v100
    v_mul_f32 v16, v16, v101
    ds_read_b64_tr_b16 v[36:37], v68 offset:8192
    ds_read_b64_tr_b16 v[38:39], v68 offset:10240
    ds_read_b64_tr_b16 v[40:41], v69 offset:8192
    ds_read_b64_tr_b16 v[42:43], v69 offset:10240
    ds_read_b64_tr_b16 v[52:53], v70 offset:4672
    ds_read_b64_tr_b16 v[54:55], v70 offset:5824
    ds_read_b64_tr_b16 v[56:57], v70 offset:4704
    ds_read_b64_tr_b16 v[58:59], v70 offset:5856
    s_waitcnt lgkmcnt(8)
    v_mfma_f32_32x32x16_bf16 v[160:175], v[44:47], v[28:31], v[160:175]
    v_exp_f32 v14, v14
    v_exp_f32 v16, v16
    v_mul_f32 v15, v100, v108
    v_mul_f32 v17, v101, v109
    v_fma_f32 v14, v14, v84, v84
    v_fma_f32 v16, v16, v84, v84
    v_mfma_f32_32x32x16_bf16 v[176:191], v[44:47], v[32:35], v[176:191]
    v_rcp_f32 v14, v14
    v_rcp_f32 v16, v16
    v_mul_f32 v15, v15, v14
    v_mul_f32 v17, v17, v16
    v_cvt_pk_bf16_f32 v66, v15, v17
    v_mul_f32 v18, v102, v102
    v_mfma_f32_32x32x16_bf16 v[192:207], v[48:51], v[28:31], v[192:207]
    v_mul_f32 v20, v103, v103
    v_fma_f32 v18, v18, v82, v80
    v_fma_f32 v20, v20, v82, v80
    v_mul_f32 v18, v18, v102
    v_mul_f32 v20, v20, v103
    v_exp_f32 v18, v18
    v_mfma_f32_32x32x16_bf16 v[208:223], v[48:51], v[32:35], v[208:223]
    v_exp_f32 v20, v20
    v_mul_f32 v19, v102, v110
    v_mul_f32 v21, v103, v111
    v_fma_f32 v18, v18, v84, v84
    v_fma_f32 v20, v20, v84, v84
    v_rcp_f32 v18, v18
    ds_read_b64_tr_b16 v[28:29], v71 offset:0
    ds_read_b64_tr_b16 v[30:31], v71 offset:2048
    ds_read_b64_tr_b16 v[32:33], v72 offset:0
    ds_read_b64_tr_b16 v[34:35], v72 offset:2048
    ds_read_b64_tr_b16 v[44:45], v73 offset:64
    ds_read_b64_tr_b16 v[46:47], v73 offset:1216
    ds_read_b64_tr_b16 v[48:49], v73 offset:96
    ds_read_b64_tr_b16 v[50:51], v73 offset:1248
    s_waitcnt lgkmcnt(8)
    v_mfma_f32_32x32x16_bf16 v[160:175], v[52:55], v[36:39], v[160:175]
    v_rcp_f32 v20, v20
    v_mul_f32 v19, v19, v18
    v_mul_f32 v21, v21, v20
    v_cvt_pk_bf16_f32 v67, v19, v21
    buffer_store_dwordx4 v[64:67], v25, s[32:35], s68 offen sc1
    v_mul_f32 v14, v112, v112
    v_mfma_f32_32x32x16_bf16 v[176:191], v[52:55], v[40:43], v[176:191]
    v_mul_f32 v16, v113, v113
    v_fma_f32 v14, v14, v83, v81
    v_fma_f32 v16, v16, v83, v81
    v_mul_f32 v14, v14, v112
    v_mul_f32 v16, v16, v113
    v_exp_f32 v14, v14
    v_mfma_f32_32x32x16_bf16 v[192:207], v[56:59], v[36:39], v[192:207]
    v_exp_f32 v16, v16
    v_mul_f32 v15, v112, v120
    v_mul_f32 v17, v113, v121
    v_fma_f32 v14, v14, v85, v85
    v_fma_f32 v16, v16, v85, v85
    v_rcp_f32 v14, v14
    v_mfma_f32_32x32x16_bf16 v[208:223], v[56:59], v[40:43], v[208:223]
    v_rcp_f32 v16, v16
    v_mul_f32 v15, v15, v14
    v_mul_f32 v17, v17, v16
    v_cvt_pk_bf16_f32 v88, v15, v17
    v_mul_f32 v18, v114, v114
    v_mul_f32 v20, v115, v115
    ds_read_b64_tr_b16 v[36:37], v71 offset:8192
    ds_read_b64_tr_b16 v[38:39], v71 offset:10240
    ds_read_b64_tr_b16 v[40:41], v72 offset:8192
    ds_read_b64_tr_b16 v[42:43], v72 offset:10240
    ds_read_b64_tr_b16 v[52:53], v73 offset:4672
    ds_read_b64_tr_b16 v[54:55], v73 offset:5824
    ds_read_b64_tr_b16 v[56:57], v73 offset:4704
    ds_read_b64_tr_b16 v[58:59], v73 offset:5856
    s_waitcnt lgkmcnt(8)
    v_mfma_f32_32x32x16_bf16 v[160:175], v[44:47], v[28:31], v[160:175]
    v_fma_f32 v18, v18, v83, v81
    v_fma_f32 v20, v20, v83, v81
    v_mul_f32 v18, v18, v114
    v_mul_f32 v20, v20, v115
    v_exp_f32 v18, v18
    v_exp_f32 v20, v20
    v_mfma_f32_32x32x16_bf16 v[176:191], v[44:47], v[32:35], v[176:191]
    v_mul_f32 v19, v114, v122
    v_mul_f32 v21, v115, v123
    v_fma_f32 v18, v18, v85, v85
    v_fma_f32 v20, v20, v85, v85
    v_rcp_f32 v18, v18
    v_rcp_f32 v20, v20
    v_mfma_f32_32x32x16_bf16 v[192:207], v[48:51], v[28:31], v[192:207]
    v_mul_f32 v19, v19, v18
    v_mul_f32 v21, v21, v20
    v_cvt_pk_bf16_f32 v89, v19, v21
    v_mul_f32 v14, v116, v116
    v_mul_f32 v16, v117, v117
    v_fma_f32 v14, v14, v83, v81
    v_mfma_f32_32x32x16_bf16 v[208:223], v[48:51], v[32:35], v[208:223]
    v_fma_f32 v16, v16, v83, v81
    v_mul_f32 v14, v14, v116
    v_mul_f32 v16, v16, v117
    v_exp_f32 v14, v14
    v_exp_f32 v16, v16
    v_mul_f32 v15, v116, v124
    ds_read_b64_tr_b16 v[28:29], v77 offset:0
    ds_read_b64_tr_b16 v[30:31], v77 offset:2048
    ds_read_b64_tr_b16 v[32:33], v78 offset:0
    ds_read_b64_tr_b16 v[34:35], v78 offset:2048
    ds_read_b64_tr_b16 v[44:45], v79 offset:128
    ds_read_b64_tr_b16 v[46:47], v79 offset:1280
    s_waitcnt lgkmcnt(6)
    v_mfma_f32_32x32x16_bf16 v[160:175], v[52:55], v[36:39], v[160:175]
    v_mul_f32 v17, v117, v125
    v_fma_f32 v14, v14, v85, v85
    v_fma_f32 v16, v16, v85, v85
    v_rcp_f32 v14, v14
    v_rcp_f32 v16, v16
    v_mul_f32 v15, v15, v14
    v_mfma_f32_32x32x16_bf16 v[176:191], v[52:55], v[40:43], v[176:191]
    v_mul_f32 v17, v17, v16
    v_cvt_pk_bf16_f32 v90, v15, v17
    v_mul_f32 v18, v118, v118
    v_mul_f32 v20, v119, v119
    v_fma_f32 v18, v18, v83, v81
    v_fma_f32 v20, v20, v83, v81
    v_mfma_f32_32x32x16_bf16 v[192:207], v[56:59], v[36:39], v[192:207]
    v_mul_f32 v18, v18, v118
    v_mul_f32 v20, v20, v119
    v_exp_f32 v18, v18
    v_exp_f32 v20, v20
    v_mul_f32 v19, v118, v126
    v_mul_f32 v21, v119, v127
    v_mfma_f32_32x32x16_bf16 v[208:223], v[56:59], v[40:43], v[208:223]
    v_fma_f32 v18, v18, v85, v85
    v_fma_f32 v20, v20, v85, v85
    v_rcp_f32 v18, v18
    v_rcp_f32 v20, v20
    v_mul_f32 v19, v19, v18
    v_mul_f32 v21, v21, v20
    ds_read_b64_tr_b16 v[36:37], v77 offset:8192
    ds_read_b64_tr_b16 v[38:39], v77 offset:10240
    ds_read_b64_tr_b16 v[40:41], v78 offset:8192
    ds_read_b64_tr_b16 v[42:43], v78 offset:10240
    ds_read_b64_tr_b16 v[52:53], v79 offset:4736
    ds_read_b64_tr_b16 v[54:55], v79 offset:5888
    s_waitcnt lgkmcnt(6)
    v_mfma_f32_32x32x16_bf16 v[224:239], v[44:47], v[28:31], v[224:239]
    v_cvt_pk_bf16_f32 v91, v19, v21
    buffer_store_dwordx4 v[88:91], v25, s[32:35], s69 offen sc1
    s_add_u32 s44, s62, 1
    s_lshr_b32 s45, s44, 1
    s_lshl_b32 s45, s45, 12
    s_and_b32 s44, s44, 1
    v_mfma_f32_32x32x16_bf16 v[240:255], v[44:47], v[32:35], v[240:255]
    s_lshl_b32 s44, s44, 9
    s_add_u32 s45, s45, s44
    s_add_u32 s68, s45, s61
    s_add_u32 s69, s68, 2048
    v_mul_f32 v14, v128, v128
    v_mul_f32 v16, v129, v129
    ds_read_b64_tr_b16 v[28:29], v68 offset:0
    ds_read_b64_tr_b16 v[30:31], v68 offset:2048
    ds_read_b64_tr_b16 v[32:33], v69 offset:0
    ds_read_b64_tr_b16 v[34:35], v69 offset:2048
    ds_read_b64_tr_b16 v[44:45], v70 offset:128
    ds_read_b64_tr_b16 v[46:47], v70 offset:1280
    s_waitcnt lgkmcnt(6)
    v_mfma_f32_32x32x16_bf16 v[224:239], v[52:55], v[36:39], v[224:239]
    v_fma_f32 v14, v14, v82, v80
    v_fma_f32 v16, v16, v82, v80
    v_mul_f32 v14, v14, v128
    v_mul_f32 v16, v16, v129
    v_exp_f32 v14, v14
    v_exp_f32 v16, v16
    v_mfma_f32_32x32x16_bf16 v[240:255], v[52:55], v[40:43], v[240:255]
    v_mul_f32 v15, v128, v136
    v_mul_f32 v17, v129, v137
    v_fma_f32 v14, v14, v84, v84
    v_fma_f32 v16, v16, v84, v84
    v_rcp_f32 v14, v14
    v_rcp_f32 v16, v16
    ds_read_b64_tr_b16 v[36:37], v68 offset:8192
    ds_read_b64_tr_b16 v[38:39], v68 offset:10240
    ds_read_b64_tr_b16 v[40:41], v69 offset:8192
    ds_read_b64_tr_b16 v[42:43], v69 offset:10240
    ds_read_b64_tr_b16 v[52:53], v70 offset:4736
    ds_read_b64_tr_b16 v[54:55], v70 offset:5888
    s_waitcnt lgkmcnt(6)
    v_mfma_f32_32x32x16_bf16 v[224:239], v[44:47], v[28:31], v[224:239]
    v_mul_f32 v15, v15, v14
    v_mul_f32 v17, v17, v16
    v_cvt_pk_bf16_f32 v64, v15, v17
    v_mul_f32 v18, v130, v130
    v_mul_f32 v20, v131, v131
    v_fma_f32 v18, v18, v82, v80
    v_mfma_f32_32x32x16_bf16 v[240:255], v[44:47], v[32:35], v[240:255]
    v_fma_f32 v20, v20, v82, v80
    v_mul_f32 v18, v18, v130
    v_mul_f32 v20, v20, v131
    v_exp_f32 v18, v18
    v_exp_f32 v20, v20
    v_mul_f32 v19, v130, v138
    ds_read_b64_tr_b16 v[28:29], v71 offset:0
    ds_read_b64_tr_b16 v[30:31], v71 offset:2048
    ds_read_b64_tr_b16 v[32:33], v72 offset:0
    ds_read_b64_tr_b16 v[34:35], v72 offset:2048
    ds_read_b64_tr_b16 v[44:45], v73 offset:128
    ds_read_b64_tr_b16 v[46:47], v73 offset:1280
    s_waitcnt lgkmcnt(6)
    v_mfma_f32_32x32x16_bf16 v[224:239], v[52:55], v[36:39], v[224:239]
    v_mul_f32 v21, v131, v139
    v_fma_f32 v18, v18, v84, v84
    v_fma_f32 v20, v20, v84, v84
    v_rcp_f32 v18, v18
    v_rcp_f32 v20, v20
    v_mul_f32 v19, v19, v18
    v_mfma_f32_32x32x16_bf16 v[240:255], v[52:55], v[40:43], v[240:255]
    v_mul_f32 v21, v21, v20
    v_cvt_pk_bf16_f32 v65, v19, v21
    v_mul_f32 v14, v132, v132
    v_mul_f32 v16, v133, v133
    v_fma_f32 v14, v14, v82, v80
    v_fma_f32 v16, v16, v82, v80
    ds_read_b64_tr_b16 v[36:37], v71 offset:8192
    ds_read_b64_tr_b16 v[38:39], v71 offset:10240
    ds_read_b64_tr_b16 v[40:41], v72 offset:8192
    ds_read_b64_tr_b16 v[42:43], v72 offset:10240
    ds_read_b64_tr_b16 v[52:53], v73 offset:4736
    ds_read_b64_tr_b16 v[54:55], v73 offset:5888
    s_waitcnt lgkmcnt(6)
    v_mfma_f32_32x32x16_bf16 v[224:239], v[44:47], v[28:31], v[224:239]
    v_mul_f32 v14, v14, v132
    v_mul_f32 v16, v16, v133
    v_exp_f32 v14, v14
    v_exp_f32 v16, v16
    v_mul_f32 v15, v132, v140
    v_mul_f32 v17, v133, v141
    v_mfma_f32_32x32x16_bf16 v[240:255], v[44:47], v[32:35], v[240:255]
    v_fma_f32 v14, v14, v84, v84
    v_fma_f32 v16, v16, v84, v84
    v_rcp_f32 v14, v14
    v_rcp_f32 v16, v16
    v_mul_f32 v15, v15, v14
    v_mul_f32 v17, v17, v16
    s_waitcnt lgkmcnt(0)
    v_mfma_f32_32x32x16_bf16 v[224:239], v[52:55], v[36:39], v[224:239]
    v_cvt_pk_bf16_f32 v66, v15, v17
    v_mul_f32 v18, v134, v134
    v_mul_f32 v20, v135, v135
    v_fma_f32 v18, v18, v82, v80
    v_fma_f32 v20, v20, v82, v80
    v_mul_f32 v18, v18, v134
    v_mfma_f32_32x32x16_bf16 v[240:255], v[52:55], v[40:43], v[240:255]
    v_mul_f32 v20, v20, v135
    v_exp_f32 v18, v18
    v_exp_f32 v20, v20
    v_mul_f32 v19, v134, v142
    v_mul_f32 v21, v135, v143
    v_fma_f32 v18, v18, v84, v84
    v_fma_f32 v20, v20, v84, v84
    v_rcp_f32 v18, v18
    v_rcp_f32 v20, v20
    v_mul_f32 v19, v19, v18
    v_mul_f32 v21, v21, v20
    v_cvt_pk_bf16_f32 v67, v19, v21
    s_barrier
    buffer_store_dwordx4 v[64:67], v25, s[32:35], s68 offen sc1
    v_pk_mul_f32 v[14:15], v[144:145], v[144:145]
    v_pk_mul_f32 v[18:19], v[146:147], v[146:147]
    v_pk_fma_f32 v[14:15], v[14:15], v[82:83], v[80:81] op_sel:[0,1,1] op_sel_hi:[1,1,1]
    v_pk_fma_f32 v[18:19], v[18:19], v[82:83], v[80:81] op_sel:[0,1,1] op_sel_hi:[1,1,1]
    v_pk_mul_f32 v[14:15], v[14:15], v[144:145]
    v_pk_mul_f32 v[18:19], v[18:19], v[146:147]
    v_exp_f32 v14, v14
    v_exp_f32 v18, v18
    v_exp_f32 v15, v15
    v_exp_f32 v19, v19
    v_pk_mul_f32 v[16:17], v[144:145], v[152:153]
    v_pk_mul_f32 v[20:21], v[146:147], v[154:155]
    v_pk_fma_f32 v[14:15], v[14:15], v[84:85], v[84:85] op_sel:[0,1,1] op_sel_hi:[1,1,1]
    v_pk_fma_f32 v[18:19], v[18:19], v[84:85], v[84:85] op_sel:[0,1,1] op_sel_hi:[1,1,1]
    v_rcp_f32 v14, v14
    v_rcp_f32 v18, v18
    v_rcp_f32 v15, v15
    v_rcp_f32 v19, v19
    v_pk_mul_f32 v[16:17], v[16:17], v[14:15]
    v_pk_mul_f32 v[20:21], v[20:21], v[18:19]
    v_cvt_pk_bf16_f32 v88, v16, v17
    v_cvt_pk_bf16_f32 v89, v20, v21
    v_pk_mul_f32 v[14:15], v[148:149], v[148:149]
    v_pk_mul_f32 v[18:19], v[150:151], v[150:151]
    v_pk_fma_f32 v[14:15], v[14:15], v[82:83], v[80:81] op_sel:[0,1,1] op_sel_hi:[1,1,1]
    v_pk_fma_f32 v[18:19], v[18:19], v[82:83], v[80:81] op_sel:[0,1,1] op_sel_hi:[1,1,1]
    v_pk_mul_f32 v[14:15], v[14:15], v[148:149]
    v_pk_mul_f32 v[18:19], v[18:19], v[150:151]
    v_exp_f32 v14, v14
    v_exp_f32 v18, v18
    v_exp_f32 v15, v15
    v_exp_f32 v19, v19
    v_pk_mul_f32 v[16:17], v[148:149], v[156:157]
    v_pk_mul_f32 v[20:21], v[150:151], v[158:159]
    v_pk_fma_f32 v[14:15], v[14:15], v[84:85], v[84:85] op_sel:[0,1,1] op_sel_hi:[1,1,1]
    v_pk_fma_f32 v[18:19], v[18:19], v[84:85], v[84:85] op_sel:[0,1,1] op_sel_hi:[1,1,1]
    v_rcp_f32 v14, v14
    v_rcp_f32 v18, v18
    v_rcp_f32 v15, v15
    v_rcp_f32 v19, v19
    v_pk_mul_f32 v[16:17], v[16:17], v[14:15]
    v_pk_mul_f32 v[20:21], v[20:21], v[18:19]
    v_cvt_pk_bf16_f32 v90, v16, v17
    v_cvt_pk_bf16_f32 v91, v20, v21
    buffer_store_dwordx4 v[88:91], v25, s[32:35], s69 offen sc1
    s_add_u32 s44, s62, 2
    s_lshr_b32 s45, s44, 1
    s_lshl_b32 s45, s45, 12
    s_and_b32 s44, s44, 1
    s_lshl_b32 s44, s44, 9
    s_add_u32 s45, s45, s44
    s_add_u32 s68, s45, s61
    s_add_u32 s69, s68, 2048
    v_pk_mul_f32 v[14:15], v[160:161], v[160:161]
    v_pk_mul_f32 v[18:19], v[162:163], v[162:163]
    v_pk_fma_f32 v[14:15], v[14:15], v[82:83], v[80:81] op_sel:[0,0,0] op_sel_hi:[1,0,0]
    v_pk_fma_f32 v[18:19], v[18:19], v[82:83], v[80:81] op_sel:[0,0,0] op_sel_hi:[1,0,0]
    v_pk_mul_f32 v[14:15], v[14:15], v[160:161]
    v_pk_mul_f32 v[18:19], v[18:19], v[162:163]
    v_exp_f32 v14, v14
    v_exp_f32 v18, v18
    v_exp_f32 v15, v15
    v_exp_f32 v19, v19
    v_pk_mul_f32 v[16:17], v[160:161], v[168:169]
    v_pk_mul_f32 v[20:21], v[162:163], v[170:171]
    v_pk_fma_f32 v[14:15], v[14:15], v[84:85], v[84:85] op_sel:[0,0,0] op_sel_hi:[1,0,0]
    v_pk_fma_f32 v[18:19], v[18:19], v[84:85], v[84:85] op_sel:[0,0,0] op_sel_hi:[1,0,0]
    v_rcp_f32 v14, v14
    v_rcp_f32 v18, v18
    v_rcp_f32 v15, v15
    v_rcp_f32 v19, v19
    v_pk_mul_f32 v[16:17], v[16:17], v[14:15]
    v_pk_mul_f32 v[20:21], v[20:21], v[18:19]
    v_cvt_pk_bf16_f32 v64, v16, v17
    v_cvt_pk_bf16_f32 v65, v20, v21
    v_pk_mul_f32 v[14:15], v[164:165], v[164:165]
    v_pk_mul_f32 v[18:19], v[166:167], v[166:167]
    v_pk_fma_f32 v[14:15], v[14:15], v[82:83], v[80:81] op_sel:[0,0,0] op_sel_hi:[1,0,0]
    v_pk_fma_f32 v[18:19], v[18:19], v[82:83], v[80:81] op_sel:[0,0,0] op_sel_hi:[1,0,0]
    v_pk_mul_f32 v[14:15], v[14:15], v[164:165]
    v_pk_mul_f32 v[18:19], v[18:19], v[166:167]
    v_exp_f32 v14, v14
    v_exp_f32 v18, v18
    v_exp_f32 v15, v15
    v_exp_f32 v19, v19
    v_pk_mul_f32 v[16:17], v[164:165], v[172:173]
    v_pk_mul_f32 v[20:21], v[166:167], v[174:175]
    v_pk_fma_f32 v[14:15], v[14:15], v[84:85], v[84:85] op_sel:[0,0,0] op_sel_hi:[1,0,0]
    v_pk_fma_f32 v[18:19], v[18:19], v[84:85], v[84:85] op_sel:[0,0,0] op_sel_hi:[1,0,0]
    v_rcp_f32 v14, v14
    v_rcp_f32 v18, v18
    v_rcp_f32 v15, v15
    v_rcp_f32 v19, v19
    v_pk_mul_f32 v[16:17], v[16:17], v[14:15]
    v_pk_mul_f32 v[20:21], v[20:21], v[18:19]
    v_cvt_pk_bf16_f32 v66, v16, v17
    v_cvt_pk_bf16_f32 v67, v20, v21
    buffer_store_dwordx4 v[64:67], v25, s[32:35], s68 offen sc1
    v_pk_mul_f32 v[14:15], v[176:177], v[176:177]
    v_pk_mul_f32 v[18:19], v[178:179], v[178:179]
    v_pk_fma_f32 v[14:15], v[14:15], v[82:83], v[80:81] op_sel:[0,1,1] op_sel_hi:[1,1,1]
    v_pk_fma_f32 v[18:19], v[18:19], v[82:83], v[80:81] op_sel:[0,1,1] op_sel_hi:[1,1,1]
    v_pk_mul_f32 v[14:15], v[14:15], v[176:177]
    v_pk_mul_f32 v[18:19], v[18:19], v[178:179]
    v_exp_f32 v14, v14
    v_exp_f32 v18, v18
    v_exp_f32 v15, v15
    v_exp_f32 v19, v19
    v_pk_mul_f32 v[16:17], v[176:177], v[184:185]
    v_pk_mul_f32 v[20:21], v[178:179], v[186:187]
    v_pk_fma_f32 v[14:15], v[14:15], v[84:85], v[84:85] op_sel:[0,1,1] op_sel_hi:[1,1,1]
    v_pk_fma_f32 v[18:19], v[18:19], v[84:85], v[84:85] op_sel:[0,1,1] op_sel_hi:[1,1,1]
    v_rcp_f32 v14, v14
    v_rcp_f32 v18, v18
    v_rcp_f32 v15, v15
    v_rcp_f32 v19, v19
    v_pk_mul_f32 v[16:17], v[16:17], v[14:15]
    v_pk_mul_f32 v[20:21], v[20:21], v[18:19]
    v_cvt_pk_bf16_f32 v88, v16, v17
    v_cvt_pk_bf16_f32 v89, v20, v21
    v_pk_mul_f32 v[14:15], v[180:181], v[180:181]
    v_pk_mul_f32 v[18:19], v[182:183], v[182:183]
    v_pk_fma_f32 v[14:15], v[14:15], v[82:83], v[80:81] op_sel:[0,1,1] op_sel_hi:[1,1,1]
    v_pk_fma_f32 v[18:19], v[18:19], v[82:83], v[80:81] op_sel:[0,1,1] op_sel_hi:[1,1,1]
    v_pk_mul_f32 v[14:15], v[14:15], v[180:181]
    v_pk_mul_f32 v[18:19], v[18:19], v[182:183]
    v_exp_f32 v14, v14
    v_exp_f32 v18, v18
    v_exp_f32 v15, v15
    v_exp_f32 v19, v19
    v_pk_mul_f32 v[16:17], v[180:181], v[188:189]
    v_pk_mul_f32 v[20:21], v[182:183], v[190:191]
    v_pk_fma_f32 v[14:15], v[14:15], v[84:85], v[84:85] op_sel:[0,1,1] op_sel_hi:[1,1,1]
    v_pk_fma_f32 v[18:19], v[18:19], v[84:85], v[84:85] op_sel:[0,1,1] op_sel_hi:[1,1,1]
    v_rcp_f32 v14, v14
    v_rcp_f32 v18, v18
    v_rcp_f32 v15, v15
    v_rcp_f32 v19, v19
    v_pk_mul_f32 v[16:17], v[16:17], v[14:15]
    v_pk_mul_f32 v[20:21], v[20:21], v[18:19]
    v_cvt_pk_bf16_f32 v90, v16, v17
    v_cvt_pk_bf16_f32 v91, v20, v21
    buffer_store_dwordx4 v[88:91], v25, s[32:35], s69 offen sc1
    s_add_u32 s44, s62, 3
    s_lshr_b32 s45, s44, 1
    s_lshl_b32 s45, s45, 12
    s_and_b32 s44, s44, 1
    s_lshl_b32 s44, s44, 9
    s_add_u32 s45, s45, s44
    s_add_u32 s68, s45, s61
    s_add_u32 s69, s68, 2048
    v_pk_mul_f32 v[14:15], v[192:193], v[192:193]
    v_pk_mul_f32 v[18:19], v[194:195], v[194:195]
    v_pk_fma_f32 v[14:15], v[14:15], v[82:83], v[80:81] op_sel:[0,0,0] op_sel_hi:[1,0,0]
    v_pk_fma_f32 v[18:19], v[18:19], v[82:83], v[80:81] op_sel:[0,0,0] op_sel_hi:[1,0,0]
    v_pk_mul_f32 v[14:15], v[14:15], v[192:193]
    v_pk_mul_f32 v[18:19], v[18:19], v[194:195]
    v_exp_f32 v14, v14
    v_exp_f32 v18, v18
    v_exp_f32 v15, v15
    v_exp_f32 v19, v19
    v_pk_mul_f32 v[16:17], v[192:193], v[200:201]
    v_pk_mul_f32 v[20:21], v[194:195], v[202:203]
    v_pk_fma_f32 v[14:15], v[14:15], v[84:85], v[84:85] op_sel:[0,0,0] op_sel_hi:[1,0,0]
    v_pk_fma_f32 v[18:19], v[18:19], v[84:85], v[84:85] op_sel:[0,0,0] op_sel_hi:[1,0,0]
    v_rcp_f32 v14, v14
    v_rcp_f32 v18, v18
    v_rcp_f32 v15, v15
    v_rcp_f32 v19, v19
    v_pk_mul_f32 v[16:17], v[16:17], v[14:15]
    v_pk_mul_f32 v[20:21], v[20:21], v[18:19]
    v_cvt_pk_bf16_f32 v64, v16, v17
    v_cvt_pk_bf16_f32 v65, v20, v21
    v_pk_mul_f32 v[14:15], v[196:197], v[196:197]
    v_pk_mul_f32 v[18:19], v[198:199], v[198:199]
    v_pk_fma_f32 v[14:15], v[14:15], v[82:83], v[80:81] op_sel:[0,0,0] op_sel_hi:[1,0,0]
    v_pk_fma_f32 v[18:19], v[18:19], v[82:83], v[80:81] op_sel:[0,0,0] op_sel_hi:[1,0,0]
    v_pk_mul_f32 v[14:15], v[14:15], v[196:197]
    v_pk_mul_f32 v[18:19], v[18:19], v[198:199]
    v_exp_f32 v14, v14
    v_exp_f32 v18, v18
    v_exp_f32 v15, v15
    v_exp_f32 v19, v19
    v_pk_mul_f32 v[16:17], v[196:197], v[204:205]
    v_pk_mul_f32 v[20:21], v[198:199], v[206:207]
    v_pk_fma_f32 v[14:15], v[14:15], v[84:85], v[84:85] op_sel:[0,0,0] op_sel_hi:[1,0,0]
    v_pk_fma_f32 v[18:19], v[18:19], v[84:85], v[84:85] op_sel:[0,0,0] op_sel_hi:[1,0,0]
    v_rcp_f32 v14, v14
    v_rcp_f32 v18, v18
    v_rcp_f32 v15, v15
    v_rcp_f32 v19, v19
    v_pk_mul_f32 v[16:17], v[16:17], v[14:15]
    v_pk_mul_f32 v[20:21], v[20:21], v[18:19]
    v_cvt_pk_bf16_f32 v66, v16, v17
    v_cvt_pk_bf16_f32 v67, v20, v21
    buffer_store_dwordx4 v[64:67], v25, s[32:35], s68 offen sc1
    v_pk_mul_f32 v[14:15], v[208:209], v[208:209]
    v_pk_mul_f32 v[18:19], v[210:211], v[210:211]
    v_pk_fma_f32 v[14:15], v[14:15], v[82:83], v[80:81] op_sel:[0,1,1] op_sel_hi:[1,1,1]
    v_pk_fma_f32 v[18:19], v[18:19], v[82:83], v[80:81] op_sel:[0,1,1] op_sel_hi:[1,1,1]
    v_pk_mul_f32 v[14:15], v[14:15], v[208:209]
    v_pk_mul_f32 v[18:19], v[18:19], v[210:211]
    v_exp_f32 v14, v14
    v_exp_f32 v18, v18
    v_exp_f32 v15, v15
    v_exp_f32 v19, v19
    v_pk_mul_f32 v[16:17], v[208:209], v[216:217]
    v_pk_mul_f32 v[20:21], v[210:211], v[218:219]
    v_pk_fma_f32 v[14:15], v[14:15], v[84:85], v[84:85] op_sel:[0,1,1] op_sel_hi:[1,1,1]
    v_pk_fma_f32 v[18:19], v[18:19], v[84:85], v[84:85] op_sel:[0,1,1] op_sel_hi:[1,1,1]
    v_rcp_f32 v14, v14
    v_rcp_f32 v18, v18
    v_rcp_f32 v15, v15
    v_rcp_f32 v19, v19
    v_pk_mul_f32 v[16:17], v[16:17], v[14:15]
    v_pk_mul_f32 v[20:21], v[20:21], v[18:19]
    v_cvt_pk_bf16_f32 v88, v16, v17
    v_cvt_pk_bf16_f32 v89, v20, v21
    v_pk_mul_f32 v[14:15], v[212:213], v[212:213]
    v_pk_mul_f32 v[18:19], v[214:215], v[214:215]
    v_pk_fma_f32 v[14:15], v[14:15], v[82:83], v[80:81] op_sel:[0,1,1] op_sel_hi:[1,1,1]
    v_pk_fma_f32 v[18:19], v[18:19], v[82:83], v[80:81] op_sel:[0,1,1] op_sel_hi:[1,1,1]
    v_pk_mul_f32 v[14:15], v[14:15], v[212:213]
    v_pk_mul_f32 v[18:19], v[18:19], v[214:215]
    v_exp_f32 v14, v14
    v_exp_f32 v18, v18
    v_exp_f32 v15, v15
    v_exp_f32 v19, v19
    v_pk_mul_f32 v[16:17], v[212:213], v[220:221]
    v_pk_mul_f32 v[20:21], v[214:215], v[222:223]
    v_pk_fma_f32 v[14:15], v[14:15], v[84:85], v[84:85] op_sel:[0,1,1] op_sel_hi:[1,1,1]
    v_pk_fma_f32 v[18:19], v[18:19], v[84:85], v[84:85] op_sel:[0,1,1] op_sel_hi:[1,1,1]
    v_rcp_f32 v14, v14
    v_rcp_f32 v18, v18
    v_rcp_f32 v15, v15
    v_rcp_f32 v19, v19
    v_pk_mul_f32 v[16:17], v[16:17], v[14:15]
    v_pk_mul_f32 v[20:21], v[20:21], v[18:19]
    v_cvt_pk_bf16_f32 v90, v16, v17
    v_cvt_pk_bf16_f32 v91, v20, v21
    buffer_store_dwordx4 v[88:91], v25, s[32:35], s69 offen sc1
    s_add_u32 s44, s62, 4
    s_lshr_b32 s45, s44, 1
    s_lshl_b32 s45, s45, 12
    s_and_b32 s44, s44, 1
    s_lshl_b32 s44, s44, 9
    s_add_u32 s45, s45, s44
    s_add_u32 s68, s45, s61
    s_add_u32 s69, s68, 2048
    v_pk_mul_f32 v[14:15], v[224:225], v[224:225]
    v_pk_mul_f32 v[18:19], v[226:227], v[226:227]
    v_pk_fma_f32 v[14:15], v[14:15], v[82:83], v[80:81] op_sel:[0,0,0] op_sel_hi:[1,0,0]
    v_pk_fma_f32 v[18:19], v[18:19], v[82:83], v[80:81] op_sel:[0,0,0] op_sel_hi:[1,0,0]
    v_pk_mul_f32 v[14:15], v[14:15], v[224:225]
    v_pk_mul_f32 v[18:19], v[18:19], v[226:227]
    v_exp_f32 v14, v14
    v_exp_f32 v18, v18
    v_exp_f32 v15, v15
    v_exp_f32 v19, v19
    v_pk_mul_f32 v[16:17], v[224:225], v[232:233]
    v_pk_mul_f32 v[20:21], v[226:227], v[234:235]
    v_pk_fma_f32 v[14:15], v[14:15], v[84:85], v[84:85] op_sel:[0,0,0] op_sel_hi:[1,0,0]
    v_pk_fma_f32 v[18:19], v[18:19], v[84:85], v[84:85] op_sel:[0,0,0] op_sel_hi:[1,0,0]
    v_rcp_f32 v14, v14
    v_rcp_f32 v18, v18
    v_rcp_f32 v15, v15
    v_rcp_f32 v19, v19
    v_pk_mul_f32 v[16:17], v[16:17], v[14:15]
    v_pk_mul_f32 v[20:21], v[20:21], v[18:19]
    v_cvt_pk_bf16_f32 v64, v16, v17
    v_cvt_pk_bf16_f32 v65, v20, v21
    v_pk_mul_f32 v[14:15], v[228:229], v[228:229]
    v_pk_mul_f32 v[18:19], v[230:231], v[230:231]
    v_pk_fma_f32 v[14:15], v[14:15], v[82:83], v[80:81] op_sel:[0,0,0] op_sel_hi:[1,0,0]
    v_pk_fma_f32 v[18:19], v[18:19], v[82:83], v[80:81] op_sel:[0,0,0] op_sel_hi:[1,0,0]
    v_pk_mul_f32 v[14:15], v[14:15], v[228:229]
    v_pk_mul_f32 v[18:19], v[18:19], v[230:231]
    v_exp_f32 v14, v14
    v_exp_f32 v18, v18
    v_exp_f32 v15, v15
    v_exp_f32 v19, v19
    v_pk_mul_f32 v[16:17], v[228:229], v[236:237]
    v_pk_mul_f32 v[20:21], v[230:231], v[238:239]
    v_pk_fma_f32 v[14:15], v[14:15], v[84:85], v[84:85] op_sel:[0,0,0] op_sel_hi:[1,0,0]
    v_pk_fma_f32 v[18:19], v[18:19], v[84:85], v[84:85] op_sel:[0,0,0] op_sel_hi:[1,0,0]
    v_rcp_f32 v14, v14
    v_rcp_f32 v18, v18
    v_rcp_f32 v15, v15
    v_rcp_f32 v19, v19
    v_pk_mul_f32 v[16:17], v[16:17], v[14:15]
    v_pk_mul_f32 v[20:21], v[20:21], v[18:19]
    v_cvt_pk_bf16_f32 v66, v16, v17
    v_cvt_pk_bf16_f32 v67, v20, v21
    buffer_store_dwordx4 v[64:67], v25, s[32:35], s68 offen sc1
    v_pk_mul_f32 v[14:15], v[240:241], v[240:241]
    v_pk_mul_f32 v[18:19], v[242:243], v[242:243]
    v_pk_fma_f32 v[14:15], v[14:15], v[82:83], v[80:81] op_sel:[0,1,1] op_sel_hi:[1,1,1]
    v_pk_fma_f32 v[18:19], v[18:19], v[82:83], v[80:81] op_sel:[0,1,1] op_sel_hi:[1,1,1]
    v_pk_mul_f32 v[14:15], v[14:15], v[240:241]
    v_pk_mul_f32 v[18:19], v[18:19], v[242:243]
    v_exp_f32 v14, v14
    v_exp_f32 v18, v18
    v_exp_f32 v15, v15
    v_exp_f32 v19, v19
    v_pk_mul_f32 v[16:17], v[240:241], v[248:249]
    v_pk_mul_f32 v[20:21], v[242:243], v[250:251]
    v_pk_fma_f32 v[14:15], v[14:15], v[84:85], v[84:85] op_sel:[0,1,1] op_sel_hi:[1,1,1]
    v_pk_fma_f32 v[18:19], v[18:19], v[84:85], v[84:85] op_sel:[0,1,1] op_sel_hi:[1,1,1]
    v_rcp_f32 v14, v14
    v_rcp_f32 v18, v18
    v_rcp_f32 v15, v15
    v_rcp_f32 v19, v19
    v_pk_mul_f32 v[16:17], v[16:17], v[14:15]
    v_pk_mul_f32 v[20:21], v[20:21], v[18:19]
    v_cvt_pk_bf16_f32 v88, v16, v17
    v_cvt_pk_bf16_f32 v89, v20, v21
    v_pk_mul_f32 v[14:15], v[244:245], v[244:245]
    v_pk_mul_f32 v[18:19], v[246:247], v[246:247]
    v_pk_fma_f32 v[14:15], v[14:15], v[82:83], v[80:81] op_sel:[0,1,1] op_sel_hi:[1,1,1]
    v_pk_fma_f32 v[18:19], v[18:19], v[82:83], v[80:81] op_sel:[0,1,1] op_sel_hi:[1,1,1]
    v_pk_mul_f32 v[14:15], v[14:15], v[244:245]
    v_pk_mul_f32 v[18:19], v[18:19], v[246:247]
    v_exp_f32 v14, v14
    v_exp_f32 v18, v18
    v_exp_f32 v15, v15
    v_exp_f32 v19, v19
    v_pk_mul_f32 v[16:17], v[244:245], v[252:253]
    v_pk_mul_f32 v[20:21], v[246:247], v[254:255]
    v_pk_fma_f32 v[14:15], v[14:15], v[84:85], v[84:85] op_sel:[0,1,1] op_sel_hi:[1,1,1]
    v_pk_fma_f32 v[18:19], v[18:19], v[84:85], v[84:85] op_sel:[0,1,1] op_sel_hi:[1,1,1]
    v_rcp_f32 v14, v14
    v_rcp_f32 v18, v18
    v_rcp_f32 v15, v15
    v_rcp_f32 v19, v19
    v_pk_mul_f32 v[16:17], v[16:17], v[14:15]
    v_pk_mul_f32 v[20:21], v[20:21], v[18:19]
    v_cvt_pk_bf16_f32 v90, v16, v17
    v_cvt_pk_bf16_f32 v91, v20, v21
    buffer_store_dwordx4 v[88:91], v25, s[32:35], s69 offen sc1
    s_branch L_k4_done
L_k4_B:
    s_setprio 1
    v_add_u32 v68, 0, v22
    v_add_u32 v69, 0, v23
    v_add_u32 v70, 0, v24
    v_add_u32 v71, 34944, v22
    v_add_u32 v72, 34944, v23
    v_add_u32 v73, 34944, v24
    v_add_u32 v74, 69888, v22
    v_add_u32 v75, 69888, v23
    v_add_u32 v76, 69888, v24
    v_add_u32 v77, 104832, v22
    v_add_u32 v78, 104832, v23
    v_add_u32 v79, 104832, v24
    ds_read_b64_tr_b16 v[28:29], v68 offset:0
    ds_read_b64_tr_b16 v[30:31], v68 offset:2048
    ds_read_b64_tr_b16 v[32:33], v69 offset:0
    ds_read_b64_tr_b16 v[34:35], v69 offset:2048
    ds_read_b64_tr_b16 v[44:45], v70 offset:160
    ds_read_b64_tr_b16 v[46:47], v70 offset:1312
    ds_read_b64_tr_b16 v[48:49], v70 offset:192
    ds_read_b64_tr_b16 v[50:51], v70 offset:1344
    ds_read_b64_tr_b16 v[52:53], v70 offset:224
    ds_read_b64_tr_b16 v[54:55], v70 offset:1376
    s_mov_b32 s70, 0
    s_mov_b32 s71, 0
    ds_read_b64_tr_b16 v[56:57], v70 offset:256
    ds_read_b64_tr_b16 v[58:59], v70 offset:1408
    s_waitcnt lgkmcnt(6)
    v_mfma_f32_32x32x16_bf16 v[96:111], v[44:47], v[28:31], 0
    v_mfma_f32_32x32x16_bf16 v[112:127], v[44:47], v[32:35], 0
    s_add_u32 m0, s56, s50
    s_nop 0
    buffer_load_dwordx4 v8, s[16:19], s54 offen lds
    s_add_u32 m0, s56, s50
    s_nop 0
    buffer_load_dwordx4 v9, s[16:19], s54 offen offset:1024 lds
    ds_read_b64_tr_b16 v[44:45], v70 offset:4768
    ds_read_b64_tr_b16 v[46:47], v70 offset:5920
    ds_read_b64_tr_b16 v[36:37], v68 offset:8192
    ds_read_b64_tr_b16 v[38:39], v68 offset:10240
    ds_read_b64_tr_b16 v[40:41], v69 offset:8192
    ds_read_b64_tr_b16 v[42:43], v69 offset:10240
    s_waitcnt lgkmcnt(10)
    v_mfma_f32_32x32x16_bf16 v[128:143], v[48:51], v[28:31], 0
    v_mfma_f32_32x32x16_bf16 v[144:159], v[48:51], v[32:35], 0
    s_add_u32 m0, s56, s51
    s_nop 0
    buffer_load_dwordx4 v10, s[20:23], s55 offen lds
    s_add_u32 m0, s56, s52
    s_nop 0
    buffer_load_dwordx4 v11, s[28:31], s55 offen lds
    s_cmp_eq_u32 s57, 0
    s_cbranch_scc1 L_noex_2
    s_add_u32 m0, s56, s53
    s_nop 0
    buffer_load_dwordx4 v12, s[24:27], s55 offen lds
L_noex_2:
    s_add_u32 s54, s54, 131072
    s_add_u32 s55, s55, 294912
    s_add_u32 s56, s56, 34944
    s_cmp_eq_u32 s56, 139776
    s_cselect_b32 s56, 0, s56
    ds_read_b64_tr_b16 v[48:49], v70 offset:4800
    ds_read_b64_tr_b16 v[50:51], v70 offset:5952
    s_waitcnt lgkmcnt(10)
    v_mfma_f32_32x32x16_bf16 v[160:175], v[52:55], v[28:31], 0
    v_mfma_f32_32x32x16_bf16 v[176:191], v[52:55], v[32:35], 0
    ds_read_b64_tr_b16 v[52:53], v70 offset:4832
    ds_read_b64_tr_b16 v[54:55], v70 offset:5984
    s_waitcnt lgkmcnt(10)
    v_mfma_f32_32x32x16_bf16 v[192:207], v[56:59], v[28:31], 0
    v_mfma_f32_32x32x16_bf16 v[208:223], v[56:59], v[32:35], 0
    s_waitcnt vmcnt(15)
    s_barrier
    ds_read_b64_tr_b16 v[56:57], v70 offset:4864
    ds_read_b64_tr_b16 v[58:59], v70 offset:6016
    s_waitcnt lgkmcnt(6)
    v_mfma_f32_32x32x16_bf16 v[96:111], v[44:47], v[36:39], v[96:111]
    v_mfma_f32_32x32x16_bf16 v[112:127], v[44:47], v[40:43], v[112:127]
    s_add_u32 m0, s56, s50
    s_nop 0
    buffer_load_dwordx4 v8, s[16:19], s54 offen lds
    s_add_u32 m0, s56, s50
    s_nop 0
    buffer_load_dwordx4 v9, s[16:19], s54 offen offset:1024 lds
    ds_read_b64_tr_b16 v[44:45], v73 offset:160
    ds_read_b64_tr_b16 v[46:47], v73 offset:1312
    ds_read_b64_tr_b16 v[28:29], v71 offset:0
    ds_read_b64_tr_b16 v[30:31], v71 offset:2048
    ds_read_b64_tr_b16 v[32:33], v72 offset:0
    ds_read_b64_tr_b16 v[34:35], v72 offset:2048
    s_waitcnt lgkmcnt(10)
    v_mfma_f32_32x32x16_bf16 v[128:143], v[48:51], v[36:39], v[128:143]
    v_mfma_f32_32x32x16_bf16 v[144:159], v[48:51], v[40:43], v[144:159]
    s_add_u32 m0, s56, s51
    s_nop 0
    buffer_load_dwordx4 v10, s[20:23], s55 offen lds
    s_add_u32 m0, s56, s52
    s_nop 0
    buffer_load_dwordx4 v11, s[28:31], s55 offen lds
    s_cmp_eq_u32 s57, 0
    s_cbranch_scc1 L_noex_3
    s_add_u32 m0, s56, s53
    s_nop 0
    buffer_load_dwordx4 v12, s[24:27], s55 offen lds
L_noex_3:
    s_add_u32 s54, s54, 131072
    s_add_u32 s55, s55, 294912
    s_add_u32 s56, s56, 34944
    s_cmp_eq_u32 s56, 139776
    s_cselect_b32 s56, 0, s56
    ds_read_b64_tr_b16 v[48:49], v73 offset:192
    ds_read_b64_tr_b16 v[50:51], v73 offset:1344
    s_waitcnt lgkmcnt(10)
    v_mfma_f32_32x32x16_bf16 v[160:175], v[52:55], v[36:39], v[160:175]
    v_mfma_f32_32x32x16_bf16 v[176:191], v[52:55], v[40:43], v[176:191]
    ds_read_b64_tr_b16 v[52:53], v73 offset:224
    ds_read_b64_tr_b16 v[54:55], v73 offset:1376
    s_waitcnt lgkmcnt(10)
    v_mfma_f32_32x32x16_bf16 v[192:207], v[56:59], v[36:39], v[192:207]
    v_mfma_f32_32x32x16_bf16 v[208:223], v[56:59], v[40:43], v[208:223]
    s_add_u32 s70, s70, 1
    ds_read_b64_tr_b16 v[56:57], v73 offset:256
    ds_read_b64_tr_b16 v[58:59], v73 offset:1408
    s_waitcnt lgkmcnt(6)
    v_mfma_f32_32x32x16_bf16 v[96:111], v[44:47], v[28:31], v[96:111]
    v_mfma_f32_32x32x16_bf16 v[112:127], v[44:47], v[32:35], v[112:127]
    ds_read_b64_tr_b16 v[44:45], v73 offset:4768
    ds_read_b64_tr_b16 v[46:47], v73 offset:5920
    ds_read_b64_tr_b16 v[36:37], v71 offset:8192
    ds_read_b64_tr_b16 v[38:39], v71 offset:10240
    ds_read_b64_tr_b16 v[40:41], v72 offset:8192
    ds_read_b64_tr_b16 v[42:43], v72 offset:10240
    s_waitcnt lgkmcnt(10)
    v_mfma_f32_32x32x16_bf16 v[128:143], v[48:51], v[28:31], v[128:143]
    v_mfma_f32_32x32x16_bf16 v[144:159], v[48:51], v[32:35], v[144:159]
    ds_read_b64_tr_b16 v[48:49], v73 offset:4800
    ds_read_b64_tr_b16 v[50:51], v73 offset:5952
    s_waitcnt lgkmcnt(10)
    v_mfma_f32_32x32x16_bf16 v[160:175], v[52:55], v[28:31], v[160:175]
    v_mfma_f32_32x32x16_bf16 v[176:191], v[52:55], v[32:35], v[176:191]
    ds_read_b64_tr_b16 v[52:53], v73 offset:4832
    ds_read_b64_tr_b16 v[54:55], v73 offset:5984
    s_waitcnt lgkmcnt(10)
    v_mfma_f32_32x32x16_bf16 v[192:207], v[56:59], v[28:31], v[192:207]
    v_mfma_f32_32x32x16_bf16 v[208:223], v[56:59], v[32:35], v[208:223]
    s_waitcnt vmcnt(4)
    s_barrier
    v_mov_b32 v86, 0
    v_mov_b32 v87, 0
    v_lshlrev_b32 v14, 16, v14
    v_add_f32 v86, v86, v14
    v_fmac_f32 v87, v14, v14
    v_lshlrev_b32 v15, 16, v15
    v_add_f32 v86, v86, v15
    v_fmac_f32 v87, v15, v15
    v_lshlrev_b32 v16, 16, v16
    v_add_f32 v86, v86, v16
    v_fmac_f32 v87, v16, v16
    v_lshlrev_b32 v17, 16, v17
    v_add_f32 v86, v86, v17
    v_fmac_f32 v87, v17, v17
    v_lshlrev_b32 v18, 16, v18
    v_add_f32 v86, v86, v18
    v_fmac_f32 v87, v18, v18
    v_lshlrev_b32 v19, 16, v19
    v_add_f32 v86, v86, v19
    v_fmac_f32 v87, v19, v19
    v_lshlrev_b32 v20, 16, v20
    v_add_f32 v86, v86, v20
    v_fmac_f32 v87, v20, v20
    v_lshlrev_b32 v21, 16, v21
    v_add_f32 v86, v86, v21
    v_fmac_f32 v87, v21, v21
    v_lshlrev_b32 v26, 16, v26
    v_add_f32 v86, v86, v26
    v_fmac_f32 v87, v26, v26
    v_lshlrev_b32 v14, 2, v1
    s_lshl_b32 s44, s59, 2
    v_add_u32 v14, s44, v14
    global_atomic_add_f32 v20, v14, v86, s[64:65] sc0
    global_atomic_add_f32 v21, v14, v87, s[66:67] sc0
    v_lshrrev_b32 v15, 4, v65
    v_bfe_u32 v16, v65, 3, 1
    v_bfe_u32 v17, v65, 2, 1
    v_and_b32 v18, 3, v65
    v_lshl_add_u32 v17, v64, 1, v17
    v_lshlrev_b32 v17, 3, v17
    v_lshl_add_u32 v17, v16, 2, v17
    v_add_u32 v17, v17, v18
    v_lshlrev_b32 v15, 8, v15
    v_lshl_add_u32 v15, v17, 2, v15
    v_add_u32 v15, 139776, v15
    v_lshrrev_b32 v16, 5, v0
    v_and_b32 v17, 31, v0
    v_lshlrev_b32 v16, 8, v16
    v_lshl_add_u32 v16, v17, 2, v16
    v_add_u32 v16, 139904, v16
    v_mov_b32 v17, 142080
    v_cmp_gt_u32 vcc, 288, v0
    s_nop 1
    v_cndmask_b32 v15, v17, v15, vcc
    v_cndmask_b32 v16, v17, v16, vcc
    v_add_f32 v27, v27, v67
    v_cvt_pk_bf16_f32 v18, v27, v27
    v_lshlrev_b32 v19, 16, v18
    v_sub_f32 v19, v27, v19
    v_cvt_pk_bf16_f32 v19, v19, v19
    v_and_b32 v18, 0xffff, v18
    v_lshl_or_b32 v18, v19, 16, v18
    v_mov_b32 v19, 0
    ds_write_b32 v15, v18
    ds_write_b32 v16, v19
    ds_read_b64_tr_b16 v[56:57], v73 offset:4864
    ds_read_b64_tr_b16 v[58:59], v73 offset:6016
    s_waitcnt lgkmcnt(8)
    v_mfma_f32_32x32x16_bf16 v[96:111], v[44:47], v[36:39], v[96:111]
    v_mfma_f32_32x32x16_bf16 v[112:127], v[44:47], v[40:43], v[112:127]
    s_add_u32 m0, s56, s50
    s_nop 0
    buffer_load_dwordx4 v8, s[16:19], s54 offen lds
    ds_read_b64_tr_b16 v[44:45], v76 offset:160
    ds_read_b64_tr_b16 v[46:47], v76 offset:1312
    ds_read_b64_tr_b16 v[28:29], v74 offset:0
    ds_read_b64_tr_b16 v[30:31], v74 offset:2048
    ds_read_b64_tr_b16 v[32:33], v75 offset:0
    ds_read_b64_tr_b16 v[34:35], v75 offset:2048
    s_waitcnt lgkmcnt(12)
    v_mfma_f32_32x32x16_bf16 v[128:143], v[48:51], v[36:39], v[128:143]
    v_mfma_f32_32x32x16_bf16 v[144:159], v[48:51], v[40:43], v[144:159]
    s_add_u32 m0, s56, s50
    s_nop 0
    buffer_load_dwordx4 v9, s[16:19], s54 offen offset:1024 lds
    ds_read_b64_tr_b16 v[48:49], v76 offset:192
    ds_read_b64_tr_b16 v[50:51], v76 offset:1344
    s_waitcnt lgkmcnt(12)
    v_mfma_f32_32x32x16_bf16 v[160:175], v[52:55], v[36:39], v[160:175]
    v_mfma_f32_32x32x16_bf16 v[176:191], v[52:55], v[40:43], v[176:191]
    ds_read_b64_tr_b16 v[52:53], v76 offset:224
    ds_read_b64_tr_b16 v[54:55], v76 offset:1376
    s_waitcnt lgkmcnt(10)
    v_mfma_f32_32x32x16_bf16 v[192:207], v[56:59], v[36:39], v[192:207]
    v_mfma_f32_32x32x16_bf16 v[208:223], v[56:59], v[40:43], v[208:223]
    s_add_u32 s70, s70, 1
    ds_read_b64_tr_b16 v[56:57], v76 offset:256
    ds_read_b64_tr_b16 v[58:59], v76 offset:1408
    s_waitcnt lgkmcnt(6)
    v_mfma_f32_32x32x16_bf16 v[96:111], v[44:47], v[28:31], v[96:111]
    v_mfma_f32_32x32x16_bf16 v[112:127], v[44:47], v[32:35], v[112:127]
    s_add_u32 m0, s56, s51
    s_nop 0
    buffer_load_dwordx4 v10, s[20:23], s55 offen lds
    ds_read_b64_tr_b16 v[44:45], v76 offset:4768
    ds_read_b64_tr_b16 v[46:47], v76 offset:5920
    ds_read_b64_tr_b16 v[36:37], v74 offset:8192
    ds_read_b64_tr_b16 v[38:39], v74 offset:10240
    ds_read_b64_tr_b16 v[40:41], v75 offset:8192
    ds_read_b64_tr_b16 v[42:43], v75 offset:10240
    s_waitcnt lgkmcnt(10)
    v_mfma_f32_32x32x16_bf16 v[128:143], v[48:51], v[28:31], v[128:143]
    v_mfma_f32_32x32x16_bf16 v[144:159], v[48:51], v[32:35], v[144:159]
    s_add_u32 m0, s56, s52
    s_nop 0
    buffer_load_dwordx4 v11, s[28:31], s55 offen lds
    s_cmp_eq_u32 s57, 0
    s_cbranch_scc1 L_noex_4
    s_add_u32 m0, s56, s53
    s_nop 0
    buffer_load_dwordx4 v12, s[24:27], s55 offen lds
L_noex_4:
    s_add_u32 s54, s54, 131072
    s_add_u32 s55, s55, 294912
    s_add_u32 s56, s56, 34944
    s_cmp_eq_u32 s56, 139776
    s_cselect_b32 s56, 0, s56
    ds_read_b64_tr_b16 v[48:49], v76 offset:4800
    ds_read_b64_tr_b16 v[50:51], v76 offset:5952
    s_waitcnt lgkmcnt(10)
    v_mfma_f32_32x32x16_bf16 v[160:175], v[52:55], v[28:31], v[160:175]
    v_mfma_f32_32x32x16_bf16 v[176:191], v[52:55], v[32:35], v[176:191]
    ds_read_b64_tr_b16 v[52:53], v76 offset:4832
    ds_read_b64_tr_b16 v[54:55], v76 offset:5984
    s_waitcnt lgkmcnt(10)
    v_mfma_f32_32x32x16_bf16 v[192:207], v[56:59], v[28:31], v[192:207]
    v_mfma_f32_32x32x16_bf16 v[208:223], v[56:59], v[32:35], v[208:223]
    s_waitcnt vmcnt(6)
    s_barrier
    ds_read_b64_tr_b16 v[56:57], v76 offset:4864
    ds_read_b64_tr_b16 v[58:59], v76 offset:6016
    s_waitcnt lgkmcnt(6)
    v_mfma_f32_32x32x16_bf16 v[96:111], v[44:47], v[36:39], v[96:111]
    v_mfma_f32_32x32x16_bf16 v[112:127], v[44:47], v[40:43], v[112:127]
    s_add_u32 m0, s56, s50
    s_nop 0
    buffer_load_dwordx4 v8, s[16:19], s54 offen lds
    ds_read_b64_tr_b16 v[44:45], v79 offset:160
    ds_read_b64_tr_b16 v[46:47], v79 offset:1312
    ds_read_b64_tr_b16 v[28:29], v77 offset:0
    ds_read_b64_tr_b16 v[30:31], v77 offset:2048
    ds_read_b64_tr_b16 v[32:33], v78 offset:0
    ds_read_b64_tr_b16 v[34:35], v78 offset:2048
    s_waitcnt lgkmcnt(10)
    v_mfma_f32_32x32x16_bf16 v[128:143], v[48:51], v[36:39], v[128:143]
    v_mfma_f32_32x32x16_bf16 v[144:159], v[48:51], v[40:43], v[144:159]
    s_add_u32 m0, s56, s50
    s_nop 0
    buffer_load_dwordx4 v9, s[16:19], s54 offen offset:1024 lds
    ds_read_b64_tr_b16 v[48:49], v79 offset:192
    ds_read_b64_tr_b16 v[50:51], v79 offset:1344
    s_waitcnt lgkmcnt(10)
    v_mfma_f32_32x32x16_bf16 v[160:175], v[52:55], v[36:39], v[160:175]
    v_mfma_f32_32x32x16_bf16 v[176:191], v[52:55], v[40:43], v[176:191]
    ds_read_b64_tr_b16 v[52:53], v79 offset:224
    ds_read_b64_tr_b16 v[54:55], v79 offset:1376
    s_waitcnt lgkmcnt(10)
    v_mfma_f32_32x32x16_bf16 v[192:207], v[56:59], v[36:39], v[192:207]
    v_mfma_f32_32x32x16_bf16 v[208:223], v[56:59], v[40:43], v[208:223]
    s_getpc_b64 s[4:5]
L_pf_k4B:
    s_sub_u32 s4, s4, L_pf_k4B-k4_kernel
    s_subb_u32 s5, s5, 0
    v_lshlrev_b32 v66, 4, v0
    s_mov_b32 s6, 0
    s_mov_b32 s7, L_k4_done-k4_kernel-4
L_pf_k4B_l:
    v_min_u32 v65, s7, v66
    global_load_dword v67, v65, s[4:5]
    v_add_u32 v66, 8192, v66
    s_add_u32 s6, s6, 8192
    s_cmp_lt_u32 s6, s7
    s_cbranch_scc1 L_pf_k4B_l
    s_add_u32 s70, s70, 1
L_k4_loopB:
    ds_read_b64_tr_b16 v[56:57], v79 offset:256
    ds_read_b64_tr_b16 v[58:59], v79 offset:1408
    s_waitcnt lgkmcnt(6)
    v_mfma_f32_32x32x16_bf16 v[96:111], v[44:47], v[28:31], v[96:111]
    v_mfma_f32_32x32x16_bf16 v[112:127], v[44:47], v[32:35], v[112:127]
    s_add_u32 m0, s56, s51
    s_nop 0
    buffer_load_dwordx4 v10, s[20:23], s55 offen lds
    ds_read_b64_tr_b16 v[44:45], v79 offset:4768
    ds_read_b64_tr_b16 v[46:47], v79 offset:5920
    ds_read_b64_tr_b16 v[36:37], v77 offset:8192
    ds_read_b64_tr_b16 v[38:39], v77 offset:10240
    ds_read_b64_tr_b16 v[40:41], v78 offset:8192
    ds_read_b64_tr_b16 v[42:43], v78 offset:10240
    s_waitcnt lgkmcnt(10)
    v_mfma_f32_32x32x16_bf16 v[128:143], v[48:51], v[28:31], v[128:143]
    v_mfma_f32_32x32x16_bf16 v[144:159], v[48:51], v[32:35], v[144:159]
    s_add_u32 m0, s56, s52
    s_nop 0
    buffer_load_dwordx4 v11, s[28:31], s55 offen lds
    s_cmp_eq_u32 s57, 0
    s_cbranch_scc1 L_noex_5
    s_add_u32 m0, s56, s53
    s_nop 0
    buffer_load_dwordx4 v12, s[24:27], s55 offen lds
L_noex_5:
    s_add_u32 s54, s54, 131072
    s_add_u32 s55, s55, 294912
    s_add_u32 s56, s56, 34944
    s_cmp_eq_u32 s56, 139776
    s_cselect_b32 s56, 0, s56
    ds_read_b64_tr_b16 v[48:49], v79 offset:4800
    ds_read_b64_tr_b16 v[50:51], v79 offset:5952
    s_waitcnt lgkmcnt(10)
    v_mfma_f32_32x32x16_bf16 v[160:175], v[52:55], v[28:31], v[160:175]
    v_mfma_f32_32x32x16_bf16 v[176:191], v[52:55], v[32:35], v[176:191]
    ds_read_b64_tr_b16 v[52:53], v79 offset:4832
    ds_read_b64_tr_b16 v[54:55], v79 offset:5984
    s_waitcnt lgkmcnt(10)
    v_mfma_f32_32x32x16_bf16 v[192:207], v[56:59], v[28:31], v[192:207]
    v_mfma_f32_32x32x16_bf16 v[208:223], v[56:59], v[32:35], v[208:223]
    s_waitcnt vmcnt(4)
    s_barrier
    s_cmp_eq_u32 s70, 11
    s_cbranch_scc1 L_hkB_0
L_hrB_0:
    ds_read_b64_tr_b16 v[56:57], v79 offset:4864
    ds_read_b64_tr_b16 v[58:59], v79 offset:6016
    s_waitcnt lgkmcnt(6)
    v_mfma_f32_32x32x16_bf16 v[96:111], v[44:47], v[36:39], v[96:111]
    v_mfma_f32_32x32x16_bf16 v[112:127], v[44:47], v[40:43], v[112:127]
    s_add_u32 m0, s56, s50
    s_nop 0
    buffer_load_dwordx4 v8, s[16:19], s54 offen lds
    ds_read_b64_tr_b16 v[44:45], v70 offset:160
    ds_read_b64_tr_b16 v[46:47], v70 offset:1312
    ds_read_b64_tr_b16 v[28:29], v68 offset:0
    ds_read_b64_tr_b16 v[30:31], v68 offset:2048
    ds_read_b64_tr_b16 v[32:33], v69 offset:0
    ds_read_b64_tr_b16 v[34:35], v69 offset:2048
    s_waitcnt lgkmcnt(10)
    v_mfma_f32_32x32x16_bf16 v[128:143], v[48:51], v[36:39], v[128:143]
    v_mfma_f32_32x32x16_bf16 v[144:159], v[48:51], v[40:43], v[144:159]
    s_add_u32 m0, s56, s50
    s_nop 0
    buffer_load_dwordx4 v9, s[16:19], s54 offen offset:1024 lds
    ds_read_b64_tr_b16 v[48:49], v70 offset:192
    ds_read_b64_tr_b16 v[50:51], v70 offset:1344
    s_waitcnt lgkmcnt(10)
    v_mfma_f32_32x32x16_bf16 v[160:175], v[52:55], v[36:39], v[160:175]
    v_mfma_f32_32x32x16_bf16 v[176:191], v[52:55], v[40:43], v[176:191]
    ds_read_b64_tr_b16 v[52:53], v70 offset:224
    ds_read_b64_tr_b16 v[54:55], v70 offset:1376
    s_waitcnt lgkmcnt(10)
    v_mfma_f32_32x32x16_bf16 v[192:207], v[56:59], v[36:39], v[192:207]
    v_mfma_f32_32x32x16_bf16 v[208:223], v[56:59], v[40:43], v[208:223]
    s_add_u32 s70, s70, 1
    ds_read_b64_tr_b16 v[56:57], v70 offset:256
    ds_read_b64_tr_b16 v[58:59], v70 offset:1408
    s_waitcnt lgkmcnt(6)
    v_mfma_f32_32x32x16_bf16 v[96:111], v[44:47], v[28:31], v[96:111]
    v_mfma_f32_32x32x16_bf16 v[112:127], v[44:47], v[32:35], v[112:127]
    s_add_u32 m0, s56, s51
    s_nop 0
    buffer_load_dwordx4 v10, s[20:23], s55 offen lds
    ds_read_b64_tr_b16 v[44:45], v70 offset:4768
    ds_read_b64_tr_b16 v[46:47], v70 offset:5920
    ds_read_b64_tr_b16 v[36:37], v68 offset:8192
    ds_read_b64_tr_b16 v[38:39], v68 offset:10240
    ds_read_b64_tr_b16 v[40:41], v69 offset:8192
    ds_read_b64_tr_b16 v[42:43], v69 offset:10240
    s_waitcnt lgkmcnt(10)
    v_mfma_f32_32x32x16_bf16 v[128:143], v[48:51], v[28:31], v[128:143]
    v_mfma_f32_32x32x16_bf16 v[144:159], v[48:51], v[32:35], v[144:159]
    s_add_u32 m0, s56, s52
    s_nop 0
    buffer_load_dwordx4 v11, s[28:31], s55 offen lds
    s_cmp_eq_u32 s57, 0
    s_cbranch_scc1 L_noex_6
    s_add_u32 m0, s56, s53
    s_nop 0
    buffer_load_dwordx4 v12, s[24:27], s55 offen lds
L_noex_6:
    s_add_u32 s54, s54, 131072
    s_add_u32 s55, s55, 294912
    s_add_u32 s56, s56, 34944
    s_cmp_eq_u32 s56, 139776
    s_cselect_b32 s56, 0, s56
    ds_read_b64_tr_b16 v[48:49], v70 offset:4800
    ds_read_b64_tr_b16 v[50:51], v70 offset:5952
    s_waitcnt lgkmcnt(10)
    v_mfma_f32_32x32x16_bf16 v[160:175], v[52:55], v[28:31], v[160:175]
    v_mfma_f32_32x32x16_bf16 v[176:191], v[52:55], v[32:35], v[176:191]
    ds_read_b64_tr_b16 v[52:53], v70 offset:4832
    ds_read_b64_tr_b16 v[54:55], v70 offset:5984
    s_waitcnt lgkmcnt(10)
    v_mfma_f32_32x32x16_bf16 v[192:207], v[56:59], v[28:31], v[192:207]
    v_mfma_f32_32x32x16_bf16 v[208:223], v[56:59], v[32:35], v[208:223]
    s_waitcnt vmcnt(4)
    s_barrier
    ds_read_b64_tr_b16 v[56:57], v70 offset:4864
    ds_read_b64_tr_b16 v[58:59], v70 offset:6016
    s_waitcnt lgkmcnt(6)
    v_mfma_f32_32x32x16_bf16 v[96:111], v[44:47], v[36:39], v[96:111]
    v_mfma_f32_32x32x16_bf16 v[112:127], v[44:47], v[40:43], v[112:127]
    s_add_u32 m0, s56, s50
    s_nop 0
    buffer_load_dwordx4 v8, s[16:19], s54 offen lds
    ds_read_b64_tr_b16 v[44:45], v73 offset:160
    ds_read_b64_tr_b16 v[46:47], v73 offset:1312
    ds_read_b64_tr_b16 v[28:29], v71 offset:0
    ds_read_b64_tr_b16 v[30:31], v71 offset:2048
    ds_read_b64_tr_b16 v[32:33], v72 offset:0
    ds_read_b64_tr_b16 v[34:35], v72 offset:2048
    s_waitcnt lgkmcnt(10)
    v_mfma_f32_32x32x16_bf16 v[128:143], v[48:51], v[36:39], v[128:143]
    v_mfma_f32_32x32x16_bf16 v[144:159], v[48:51], v[40:43], v[144:159]
    s_add_u32 m0, s56, s50
    s_nop 0
    buffer_load_dwordx4 v9, s[16:19], s54 offen offset:1024 lds
    ds_read_b64_tr_b16 v[48:49], v73 offset:192
    ds_read_b64_tr_b16 v[50:51], v73 offset:1344
    s_waitcnt lgkmcnt(10)
    v_mfma_f32_32x32x16_bf16 v[160:175], v[52:55], v[36:39], v[160:175]
    v_mfma_f32_32x32x16_bf16 v[176:191], v[52:55], v[40:43], v[176:191]
    ds_read_b64_tr_b16 v[52:53], v73 offset:224
    ds_read_b64_tr_b16 v[54:55], v73 offset:1376
    s_waitcnt lgkmcnt(10)
    v_mfma_f32_32x32x16_bf16 v[192:207], v[56:59], v[36:39], v[192:207]
    v_mfma_f32_32x32x16_bf16 v[208:223], v[56:59], v[40:43], v[208:223]
    s_add_u32 s70, s70, 1
    ds_read_b64_tr_b16 v[56:57], v73 offset:256
    ds_read_b64_tr_b16 v[58:59], v73 offset:1408
    s_waitcnt lgkmcnt(6)
    v_mfma_f32_32x32x16_bf16 v[96:111], v[44:47], v[28:31], v[96:111]
    v_mfma_f32_32x32x16_bf16 v[112:127], v[44:47], v[32:35], v[112:127]
    s_add_u32 m0, s56, s51
    s_nop 0
    buffer_load_dwordx4 v10, s[20:23], s55 offen lds
    ds_read_b64_tr_b16 v[44:45], v73 offset:4768
    ds_read_b64_tr_b16 v[46:47], v73 offset:5920
    ds_read_b64_tr_b16 v[36:37], v71 offset:8192
    ds_read_b64_tr_b16 v[38:39], v71 offset:10240
    ds_read_b64_tr_b16 v[40:41], v72 offset:8192
    ds_read_b64_tr_b16 v[42:43], v72 offset:10240
    s_waitcnt lgkmcnt(10)
    v_mfma_f32_32x32x16_bf16 v[128:143], v[48:51], v[28:31], v[128:143]
    v_mfma_f32_32x32x16_bf16 v[144:159], v[48:51], v[32:35], v[144:159]
    s_add_u32 m0, s56, s52
    s_nop 0
    buffer_load_dwordx4 v11, s[28:31], s55 offen lds
    s_cmp_eq_u32 s57, 0
    s_cbranch_scc1 L_noex_7
    s_add_u32 m0, s56, s53
    s_nop 0
    buffer_load_dwordx4 v12, s[24:27], s55 offen lds
L_noex_7:
    s_add_u32 s54, s54, 131072
    s_add_u32 s55, s55, 294912
    s_add_u32 s56, s56, 34944
    s_cmp_eq_u32 s56, 139776
    s_cselect_b32 s56, 0, s56
    ds_read_b64_tr_b16 v[48:49], v73 offset:4800
    ds_read_b64_tr_b16 v[50:51], v73 offset:5952
    s_waitcnt lgkmcnt(10)
    v_mfma_f32_32x32x16_bf16 v[160:175], v[52:55], v[28:31], v[160:175]
    v_mfma_f32_32x32x16_bf16 v[176:191], v[52:55], v[32:35], v[176:191]
    ds_read_b64_tr_b16 v[52:53], v73 offset:4832
    ds_read_b64_tr_b16 v[54:55], v73 offset:5984
    s_waitcnt lgkmcnt(10)
    v_mfma_f32_32x32x16_bf16 v[192:207], v[56:59], v[28:31], v[192:207]
    v_mfma_f32_32x32x16_bf16 v[208:223], v[56:59], v[32:35], v[208:223]
    s_waitcnt vmcnt(4)
    s_barrier
    s_cmp_eq_u32 s70, 13
    s_cbranch_scc1 L_hkB_1
L_hrB_1:
    ds_read_b64_tr_b16 v[56:57], v73 offset:4864
    ds_read_b64_tr_b16 v[58:59], v73 offset:6016
    s_waitcnt lgkmcnt(6)
    v_mfma_f32_32x32x16_bf16 v[96:111], v[44:47], v[36:39], v[96:111]
    v_mfma_f32_32x32x16_bf16 v[112:127], v[44:47], v[40:43], v[112:127]
    s_add_u32 m0, s56, s50
    s_nop 0
    buffer_load_dwordx4 v8, s[16:19], s54 offen lds
    ds_read_b64_tr_b16 v[44:45], v76 offset:160
    ds_read_b64_tr_b16 v[46:47], v76 offset:1312
    ds_read_b64_tr_b16 v[28:29], v74 offset:0
    ds_read_b64_tr_b16 v[30:31], v74 offset:2048
    ds_read_b64_tr_b16 v[32:33], v75 offset:0
    ds_read_b64_tr_b16 v[34:35], v75 offset:2048
    s_waitcnt lgkmcnt(10)
    v_mfma_f32_32x32x16_bf16 v[128:143], v[48:51], v[36:39], v[128:143]
    v_mfma_f32_32x32x16_bf16 v[144:159], v[48:51], v[40:43], v[144:159]
    s_add_u32 m0, s56, s50
    s_nop 0
    buffer_load_dwordx4 v9, s[16:19], s54 offen offset:1024 lds
    ds_read_b64_tr_b16 v[48:49], v76 offset:192
    ds_read_b64_tr_b16 v[50:51], v76 offset:1344
    s_waitcnt lgkmcnt(10)
    v_mfma_f32_32x32x16_bf16 v[160:175], v[52:55], v[36:39], v[160:175]
    v_mfma_f32_32x32x16_bf16 v[176:191], v[52:55], v[40:43], v[176:191]
    ds_read_b64_tr_b16 v[52:53], v76 offset:224
    ds_read_b64_tr_b16 v[54:55], v76 offset:1376
    s_waitcnt lgkmcnt(10)
    v_mfma_f32_32x32x16_bf16 v[192:207], v[56:59], v[36:39], v[192:207]
    v_mfma_f32_32x32x16_bf16 v[208:223], v[56:59], v[40:43], v[208:223]
    s_add_u32 s70, s70, 1
    ds_read_b64_tr_b16 v[56:57], v76 offset:256
    ds_read_b64_tr_b16 v[58:59], v76 offset:1408
    s_waitcnt lgkmcnt(6)
    v_mfma_f32_32x32x16_bf16 v[96:111], v[44:47], v[28:31], v[96:111]
    v_mfma_f32_32x32x16_bf16 v[112:127], v[44:47], v[32:35], v[112:127]
    s_add_u32 m0, s56, s51
    s_nop 0
    buffer_load_dwordx4 v10, s[20:23], s55 offen lds
    ds_read_b64_tr_b16 v[44:45], v76 offset:4768
    ds_read_b64_tr_b16 v[46:47], v76 offset:5920
    ds_read_b64_tr_b16 v[36:37], v74 offset:8192
    ds_read_b64_tr_b16 v[38:39], v74 offset:10240
    ds_read_b64_tr_b16 v[40:41], v75 offset:8192
    ds_read_b64_tr_b16 v[42:43], v75 offset:10240
    s_waitcnt lgkmcnt(10)
    v_mfma_f32_32x32x16_bf16 v[128:143], v[48:51], v[28:31], v[128:143]
    v_mfma_f32_32x32x16_bf16 v[144:159], v[48:51], v[32:35], v[144:159]
    s_add_u32 m0, s56, s52
    s_nop 0
    buffer_load_dwordx4 v11, s[28:31], s55 offen lds
    s_cmp_eq_u32 s57, 0
    s_cbranch_scc1 L_noex_8
    s_add_u32 m0, s56, s53
    s_nop 0
    buffer_load_dwordx4 v12, s[24:27], s55 offen lds
L_noex_8:
    s_add_u32 s54, s54, 131072
    s_add_u32 s55, s55, 294912
    s_add_u32 s56, s56, 34944
    s_cmp_eq_u32 s56, 139776
    s_cselect_b32 s56, 0, s56
    ds_read_b64_tr_b16 v[48:49], v76 offset:4800
    ds_read_b64_tr_b16 v[50:51], v76 offset:5952
    s_waitcnt lgkmcnt(10)
    v_mfma_f32_32x32x16_bf16 v[160:175], v[52:55], v[28:31], v[160:175]
    v_mfma_f32_32x32x16_bf16 v[176:191], v[52:55], v[32:35], v[176:191]
    ds_read_b64_tr_b16 v[52:53], v76 offset:4832
    ds_read_b64_tr_b16 v[54:55], v76 offset:5984
    s_waitcnt lgkmcnt(10)
    v_mfma_f32_32x32x16_bf16 v[192:207], v[56:59], v[28:31], v[192:207]
    v_mfma_f32_32x32x16_bf16 v[208:223], v[56:59], v[32:35], v[208:223]
    s_waitcnt vmcnt(4)
    s_barrier
    ds_read_b64_tr_b16 v[56:57], v76 offset:4864
    ds_read_b64_tr_b16 v[58:59], v76 offset:6016
    s_waitcnt lgkmcnt(6)
    v_mfma_f32_32x32x16_bf16 v[96:111], v[44:47], v[36:39], v[96:111]
    v_mfma_f32_32x32x16_bf16 v[112:127], v[44:47], v[40:43], v[112:127]
    s_add_u32 m0, s56, s50
    s_nop 0
    buffer_load_dwordx4 v8, s[16:19], s54 offen lds
    ds_read_b64_tr_b16 v[44:45], v79 offset:160
    ds_read_b64_tr_b16 v[46:47], v79 offset:1312
    ds_read_b64_tr_b16 v[28:29], v77 offset:0
    ds_read_b64_tr_b16 v[30:31], v77 offset:2048
    ds_read_b64_tr_b16 v[32:33], v78 offset:0
    ds_read_b64_tr_b16 v[34:35], v78 offset:2048
    s_waitcnt lgkmcnt(10)
    v_mfma_f32_32x32x16_bf16 v[128:143], v[48:51], v[36:39], v[128:143]
    v_mfma_f32_32x32x16_bf16 v[144:159], v[48:51], v[40:43], v[144:159]
    s_add_u32 m0, s56, s50
    s_nop 0
    buffer_load_dwordx4 v9, s[16:19], s54 offen offset:1024 lds
    ds_read_b64_tr_b16 v[48:49], v79 offset:192
    ds_read_b64_tr_b16 v[50:51], v79 offset:1344
    s_waitcnt lgkmcnt(10)
    v_mfma_f32_32x32x16_bf16 v[160:175], v[52:55], v[36:39], v[160:175]
    v_mfma_f32_32x32x16_bf16 v[176:191], v[52:55], v[40:43], v[176:191]
    ds_read_b64_tr_b16 v[52:53], v79 offset:224
    ds_read_b64_tr_b16 v[54:55], v79 offset:1376
    s_waitcnt lgkmcnt(10)
    v_mfma_f32_32x32x16_bf16 v[192:207], v[56:59], v[36:39], v[192:207]
    v_mfma_f32_32x32x16_bf16 v[208:223], v[56:59], v[40:43], v[208:223]
    s_add_u32 s70, s70, 1
    s_cmp_lt_u32 s70, 15
    s_cbranch_scc1 L_k4_loopB
    s_branch L_k4_postB
L_hkB_0:
    s_nop 4
    v_and_b32 v64, 31, v1
    v_lshlrev_b32 v64, 2, v64
    s_lshl_b32 s44, s59, 2
    v_add_u32 v64, s44, v64
    global_load_dword v80, v64, s[64:65] sc1
    global_load_dword v81, v64, s[64:65] offset:128 sc1
    global_load_dword v82, v64, s[66:67] sc1
    global_load_dword v83, v64, s[66:67] offset:128 sc1
    s_nop 4
    s_branch L_hrB_0
L_hkB_1:
    s_nop 4
    v_mul_f32 v64, 0x3ae38e39, v80
    v_mul_f32 v65, 0x3ae38e39, v82
    v_fma_f32 v65, -v64, v64, v65
    v_max_f32 v65, 0, v65
    v_cvt_pk_bf16_f32 v66, v64, v65
    v_and_b32 v65, 0xffff0000, v66
    v_and_b32 v64, 0xffff, v66
    v_add_f32 v65, 0x3727c5ac, v65
    v_xor_b32 v64, 0x8000, v64
    v_cvt_pk_bf16_f32 v66, v65, v65
    v_lshl_or_b32 v64, v64, 16, v64
    v_lshlrev_b32 v65, 16, v66
    v_cmp_gt_u32 vcc, 32, v1
    v_sqrt_f32 v65, v65
    v_mov_b32 v89, 0
    v_cndmask_b32 v88, 0, v64, vcc
    v_cvt_pk_bf16_f32 v66, v65, v65
    v_mov_b32 v90, 0
    v_lshlrev_b32 v65, 16, v66
    v_mov_b32 v91, 0
    v_rcp_f32 v66, v65
    v_mul_f32 v84, v65, v65
    v_mul_f32 v80, 0xc0135761, v66
    v_mul_f32 v65, v66, v66
    v_mul_f32 v65, v65, v66
    v_mul_f32 v82, 0xbdd2d3e8, v65
    v_mul_f32 v64, 0x3ae38e39, v81
    v_mul_f32 v65, 0x3ae38e39, v83
    v_fma_f32 v65, -v64, v64, v65
    v_max_f32 v65, 0, v65
    v_cvt_pk_bf16_f32 v66, v64, v65
    v_and_b32 v65, 0xffff0000, v66
    v_and_b32 v64, 0xffff, v66
    v_add_f32 v65, 0x3727c5ac, v65
    v_xor_b32 v64, 0x8000, v64
    v_cvt_pk_bf16_f32 v66, v65, v65
    v_lshl_or_b32 v64, v64, 16, v64
    v_lshlrev_b32 v65, 16, v66
    v_cmp_gt_u32 vcc, 32, v1
    v_sqrt_f32 v65, v65
    v_mov_b32 v93, 0
    v_cndmask_b32 v92, 0, v64, vcc
    v_cvt_pk_bf16_f32 v66, v65, v65
    v_mov_b32 v94, 0
    v_lshlrev_b32 v65, 16, v66
    v_mov_b32 v95, 0
    v_rcp_f32 v66, v65
    v_mul_f32 v85, v65, v65
    v_mul_f32 v81, 0xc0135761, v66
    v_mul_f32 v65, v66, v66
    v_mul_f32 v65, v65, v66
    v_mul_f32 v83, 0xbdd2d3e8, v65
    s_nop 4
    s_branch L_hrB_1
L_k4_postB:
    s_waitcnt lgkmcnt(0)
    v_mov_b32 v15, 0
    v_mov_b32 v16, 0
    v_mov_b32 v17, 0
    v_mov_b32 v19, 0
    v_mov_b32 v20, 0
    v_mov_b32 v21, 0
    v_lshlrev_b32 v13, 2, v1
    v_add_u32 v13, 139776, v13
    ds_read_b32 v14, v13 offset:1280
    ds_read_b32 v18, v13 offset:1536
    s_waitcnt lgkmcnt(1)
    v_mfma_f32_32x32x16_bf16 v[96:111], v[14:17], v[88:91], v[96:111]
    v_mfma_f32_32x32x16_bf16 v[112:127], v[14:17], v[92:95], v[112:127]
    ds_read_b32 v14, v13 offset:1792
    s_waitcnt lgkmcnt(1)
    v_mfma_f32_32x32x16_bf16 v[128:143], v[18:21], v[88:91], v[128:143]
    v_mfma_f32_32x32x16_bf16 v[144:159], v[18:21], v[92:95], v[144:159]
    ds_read_b32 v18, v13 offset:2048
    s_waitcnt lgkmcnt(1)
    v_mfma_f32_32x32x16_bf16 v[160:175], v[14:17], v[88:91], v[160:175]
    v_mfma_f32_32x32x16_bf16 v[176:191], v[14:17], v[92:95], v[176:191]
    s_waitcnt lgkmcnt(0)
    v_mfma_f32_32x32x16_bf16 v[192:207], v[18:21], v[88:91], v[192:207]
    v_mfma_f32_32x32x16_bf16 v[208:223], v[18:21], v[92:95], v[208:223]
    s_mov_b32 s72, s36
    s_and_b32 s73, s37, 0xffff
    s_mov_b32 s74, 5308416
    s_mov_b32 s75, 0x20000
    ds_read_b64_tr_b16 v[28:29], v77 offset:0
    ds_read_b64_tr_b16 v[30:31], v77 offset:2048
    ds_read_b64_tr_b16 v[32:33], v78 offset:0
    ds_read_b64_tr_b16 v[34:35], v78 offset:2048
    ds_read_b64_tr_b16 v[44:45], v79 offset:160
    ds_read_b64_tr_b16 v[46:47], v79 offset:1312
    ds_read_b64_tr_b16 v[48:49], v79 offset:192
    ds_read_b64_tr_b16 v[50:51], v79 offset:1344
    ds_read_b64_tr_b16 v[36:37], v77 offset:8192
    ds_read_b64_tr_b16 v[38:39], v77 offset:10240
    ds_read_b64_tr_b16 v[40:41], v78 offset:8192
    ds_read_b64_tr_b16 v[42:43], v78 offset:10240
    ds_read_b64_tr_b16 v[52:53], v79 offset:4768
    ds_read_b64_tr_b16 v[54:55], v79 offset:5920
    ds_read_b64_tr_b16 v[56:57], v79 offset:4800
    ds_read_b64_tr_b16 v[58:59], v79 offset:5952
    s_add_u32 m0, s56, s51
    s_nop 0
    buffer_load_dwordx4 v10, s[20:23], s55 offen lds
    s_add_u32 m0, s56, s52
    s_nop 0
    buffer_load_dwordx4 v11, s[28:31], s55 offen lds
    s_cmp_eq_u32 s57, 0
    s_cbranch_scc1 L_noex_9
    s_add_u32 m0, s56, s53
    s_nop 0
    buffer_load_dwordx4 v12, s[24:27], s55 offen lds
L_noex_9:
    s_add_u32 s54, s54, 131072
    s_add_u32 s55, s55, 294912
    s_add_u32 s56, s56, 34944
    s_cmp_eq_u32 s56, 139776
    s_cselect_b32 s56, 0, s56
    s_waitcnt lgkmcnt(8)
    v_mfma_f32_32x32x16_bf16 v[96:111], v[44:47], v[28:31], v[96:111]
    v_mfma_f32_32x32x16_bf16 v[112:127], v[44:47], v[32:35], v[112:127]
    v_mfma_f32_32x32x16_bf16 v[128:143], v[48:51], v[28:31], v[128:143]
    v_mfma_f32_32x32x16_bf16 v[144:159], v[48:51], v[32:35], v[144:159]
    s_waitcnt vmcnt(4)
    s_barrier
    ds_read_b64_tr_b16 v[28:29], v68 offset:0
    ds_read_b64_tr_b16 v[30:31], v68 offset:2048
    ds_read_b64_tr_b16 v[32:33], v69 offset:0
    ds_read_b64_tr_b16 v[34:35], v69 offset:2048
    ds_read_b64_tr_b16 v[44:45], v70 offset:160
    ds_read_b64_tr_b16 v[46:47], v70 offset:1312
    ds_read_b64_tr_b16 v[48:49], v70 offset:192
    ds_read_b64_tr_b16 v[50:51], v70 offset:1344
    s_waitcnt lgkmcnt(8)
    v_mfma_f32_32x32x16_bf16 v[96:111], v[52:55], v[36:39], v[96:111]
    v_mfma_f32_32x32x16_bf16 v[112:127], v[52:55], v[40:43], v[112:127]
    v_mfma_f32_32x32x16_bf16 v[128:143], v[56:59], v[36:39], v[128:143]
    v_mfma_f32_32x32x16_bf16 v[144:159], v[56:59], v[40:43], v[144:159]
    ds_read_b64_tr_b16 v[36:37], v68 offset:8192
    ds_read_b64_tr_b16 v[38:39], v68 offset:10240
    ds_read_b64_tr_b16 v[40:41], v69 offset:8192
    ds_read_b64_tr_b16 v[42:43], v69 offset:10240
    ds_read_b64_tr_b16 v[52:53], v70 offset:4768
    ds_read_b64_tr_b16 v[54:55], v70 offset:5920
    ds_read_b64_tr_b16 v[56:57], v70 offset:4800
    ds_read_b64_tr_b16 v[58:59], v70 offset:5952
    s_waitcnt lgkmcnt(8)
    v_mfma_f32_32x32x16_bf16 v[96:111], v[44:47], v[28:31], v[96:111]
    v_mfma_f32_32x32x16_bf16 v[112:127], v[44:47], v[32:35], v[112:127]
    v_mfma_f32_32x32x16_bf16 v[128:143], v[48:51], v[28:31], v[128:143]
    v_mfma_f32_32x32x16_bf16 v[144:159], v[48:51], v[32:35], v[144:159]
    s_waitcnt vmcnt(0)
    s_barrier
    s_mul_i32 s44, s2, 20736
    s_sub_u32 s45, s15, 4
    s_mul_i32 s45, s45, 5184
    s_add_u32 s44, s44, s45
    s_add_u32 s44, s44, 0
    v_lshlrev_b32 v228, 4, v1
    buffer_load_dwordx4 v[224:227], v228, s[72:75], s44 offen
    buffer_load_dwordx4 v[224:227], v228, s[72:75], s44 offen offset:1024
    s_mul_i32 s44, s2, 20736
    s_sub_u32 s45, s15, 4
    s_mul_i32 s45, s45, 5184
    s_add_u32 s44, s44, s45
    s_add_u32 s44, s44, 2048
    v_lshlrev_b32 v228, 4, v1
    buffer_load_dwordx4 v[224:227], v228, s[72:75], s44 offen
    buffer_load_dwordx4 v[224:227], v228, s[72:75], s44 offen offset:1024
    s_mul_i32 s44, s2, 20736
    s_sub_u32 s45, s15, 4
    s_mul_i32 s45, s45, 5184
    s_add_u32 s44, s44, s45
    s_add_u32 s44, s44, 4096
    v_lshlrev_b32 v228, 4, v1
    buffer_load_dwordx4 v[224:227], v228, s[72:75], s44 offen
    buffer_load_dwordx4 v[224:227], v228, s[72:75], s44 offen offset:1024
    ds_read_b64_tr_b16 v[28:29], v71 offset:0
    ds_read_b64_tr_b16 v[30:31], v71 offset:2048
    ds_read_b64_tr_b16 v[32:33], v72 offset:0
    ds_read_b64_tr_b16 v[34:35], v72 offset:2048
    ds_read_b64_tr_b16 v[44:45], v73 offset:160
    ds_read_b64_tr_b16 v[46:47], v73 offset:1312
    ds_read_b64_tr_b16 v[48:49], v73 offset:192
    ds_read_b64_tr_b16 v[50:51], v73 offset:1344
    s_waitcnt lgkmcnt(8)
    v_mfma_f32_32x32x16_bf16 v[96:111], v[52:55], v[36:39], v[96:111]
    v_mfma_f32_32x32x16_bf16 v[112:127], v[52:55], v[40:43], v[112:127]
    v_mfma_f32_32x32x16_bf16 v[128:143], v[56:59], v[36:39], v[128:143]
    v_mfma_f32_32x32x16_bf16 v[144:159], v[56:59], v[40:43], v[144:159]
    ds_read_b64_tr_b16 v[36:37], v71 offset:8192
    ds_read_b64_tr_b16 v[38:39], v71 offset:10240
    ds_read_b64_tr_b16 v[40:41], v72 offset:8192
    ds_read_b64_tr_b16 v[42:43], v72 offset:10240
    ds_read_b64_tr_b16 v[52:53], v73 offset:4768
    ds_read_b64_tr_b16 v[54:55], v73 offset:5920
    ds_read_b64_tr_b16 v[56:57], v73 offset:4800
    ds_read_b64_tr_b16 v[58:59], v73 offset:5952
    s_waitcnt lgkmcnt(8)
    v_mfma_f32_32x32x16_bf16 v[96:111], v[44:47], v[28:31], v[96:111]
    v_mfma_f32_32x32x16_bf16 v[112:127], v[44:47], v[32:35], v[112:127]
    v_mfma_f32_32x32x16_bf16 v[128:143], v[48:51], v[28:31], v[128:143]
    v_mfma_f32_32x32x16_bf16 v[144:159], v[48:51], v[32:35], v[144:159]
    ds_read_b64_tr_b16 v[28:29], v77 offset:0
    ds_read_b64_tr_b16 v[30:31], v77 offset:2048
    ds_read_b64_tr_b16 v[32:33], v78 offset:0
    ds_read_b64_tr_b16 v[34:35], v78 offset:2048
    ds_read_b64_tr_b16 v[44:45], v79 offset:224
    ds_read_b64_tr_b16 v[46:47], v79 offset:1376
    ds_read_b64_tr_b16 v[48:49], v79 offset:256
    ds_read_b64_tr_b16 v[50:51], v79 offset:1408
    s_waitcnt lgkmcnt(8)
    v_mfma_f32_32x32x16_bf16 v[96:111], v[52:55], v[36:39], v[96:111]
    v_mfma_f32_32x32x16_bf16 v[112:127], v[52:55], v[40:43], v[112:127]
    v_mfma_f32_32x32x16_bf16 v[128:143], v[56:59], v[36:39], v[128:143]
    v_mfma_f32_32x32x16_bf16 v[144:159], v[56:59], v[40:43], v[144:159]
    ds_read_b64_tr_b16 v[36:37], v77 offset:8192
    ds_read_b64_tr_b16 v[38:39], v77 offset:10240
    ds_read_b64_tr_b16 v[40:41], v78 offset:8192
    ds_read_b64_tr_b16 v[42:43], v78 offset:10240
    ds_read_b64_tr_b16 v[52:53], v79 offset:4832
    ds_read_b64_tr_b16 v[54:55], v79 offset:5984
    ds_read_b64_tr_b16 v[56:57], v79 offset:4864
    ds_read_b64_tr_b16 v[58:59], v79 offset:6016
    s_waitcnt lgkmcnt(8)
    v_mfma_f32_32x32x16_bf16 v[160:175], v[44:47], v[28:31], v[160:175]
    s_add_u32 s44, s62, 5
    s_lshr_b32 s45, s44, 1
    s_lshl_b32 s45, s45, 12
    s_and_b32 s44, s44, 1
    s_lshl_b32 s44, s44, 9
    s_add_u32 s45, s45, s44
    v_mfma_f32_32x32x16_bf16 v[176:191], v[44:47], v[32:35], v[176:191]
    s_add_u32 s68, s45, s61
    s_add_u32 s69, s68, 2048
    v_mul_f32 v14, v96, v96
    v_mul_f32 v16, v97, v97
    v_fma_f32 v14, v14, v82, v80
    v_fma_f32 v16, v16, v82, v80
    v_mfma_f32_32x32x16_bf16 v[192:207], v[48:51], v[28:31], v[192:207]
    v_mul_f32 v14, v14, v96
    v_mul_f32 v16, v16, v97
    v_exp_f32 v14, v14
    v_exp_f32 v16, v16
    v_mul_f32 v15, v96, v104
    v_mul_f32 v17, v97, v105
    v_mfma_f32_32x32x16_bf16 v[208:223], v[48:51], v[32:35], v[208:223]
    v_fma_f32 v14, v14, v84, v84
    v_fma_f32 v16, v16, v84, v84
    v_rcp_f32 v14, v14
    v_rcp_f32 v16, v16
    v_mul_f32 v15, v15, v14
    v_mul_f32 v17, v17, v16
    ds_read_b64_tr_b16 v[28:29], v68 offset:0
    ds_read_b64_tr_b16 v[30:31], v68 offset:2048
    ds_read_b64_tr_b16 v[32:33], v69 offset:0
    ds_read_b64_tr_b16 v[34:35], v69 offset:2048
    ds_read_b64_tr_b16 v[44:45], v70 offset:224
    ds_read_b64_tr_b16 v[46:47], v70 offset:1376
    ds_read_b64_tr_b16 v[48:49], v70 offset:256
    ds_read_b64_tr_b16 v[50:51], v70 offset:1408
    s_waitcnt lgkmcnt(8)
    v_mfma_f32_32x32x16_bf16 v[160:175], v[52:55], v[36:39], v[160:175]
    v_cvt_pk_bf16_f32 v64, v15, v17
    v_mul_f32 v18, v98, v98
    v_mul_f32 v20, v99, v99
    v_fma_f32 v18, v18, v82, v80
    v_fma_f32 v20, v20, v82, v80
    v_mul_f32 v18, v18, v98
    v_mfma_f32_32x32x16_bf16 v[176:191], v[52:55], v[40:43], v[176:191]
    v_mul_f32 v20, v20, v99
    v_exp_f32 v18, v18
    v_exp_f32 v20, v20
    v_mul_f32 v19, v98, v106
    v_mul_f32 v21, v99, v107
    v_fma_f32 v18, v18, v84, v84
    v_mfma_f32_32x32x16_bf16 v[192:207], v[56:59], v[36:39], v[192:207]
    v_fma_f32 v20, v20, v84, v84
    v_rcp_f32 v18, v18
    v_rcp_f32 v20, v20
    v_mul_f32 v19, v19, v18
    v_mul_f32 v21, v21, v20
    v_cvt_pk_bf16_f32 v65, v19, v21
    v_mfma_f32_32x32x16_bf16 v[208:223], v[56:59], v[40:43], v[208:223]
    v_mul_f32 v14, v100, v100
    v_mul_f32 v16, v101, v101
    v_fma_f32 v14, v14, v82, v80
    v_fma_f32 v16, v16, v82, v80
    v_mul_f32 v14, v14, v100
    v_mul_f32 v16, v16, v101
    ds_read_b64_tr_b16 v[36:37], v68 offset:8192
    ds_read_b64_tr_b16 v[38:39], v68 offset:10240
    ds_read_b64_tr_b16 v[40:41], v69 offset:8192
    ds_read_b64_tr_b16 v[42:43], v69 offset:10240
    ds_read_b64_tr_b16 v[52:53], v70 offset:4832
    ds_read_b64_tr_b16 v[54:55], v70 offset:5984
    ds_read_b64_tr_b16 v[56:57], v70 offset:4864
    ds_read_b64_tr_b16 v[58:59], v70 offset:6016
    s_waitcnt lgkmcnt(8)
    v_mfma_f32_32x32x16_bf16 v[160:175], v[44:47], v[28:31], v[160:175]
    v_exp_f32 v14, v14
    v_exp_f32 v16, v16
    v_mul_f32 v15, v100, v108
    v_mul_f32 v17, v101, v109
    v_fma_f32 v14, v14, v84, v84
    v_fma_f32 v16, v16, v84, v84
    v_mfma_f32_32x32x16_bf16 v[176:191], v[44:47], v[32:35], v[176:191]
    v_rcp_f32 v14, v14
    v_rcp_f32 v16, v16
    v_mul_f32 v15, v15, v14
    v_mul_f32 v17, v17, v16
    v_cvt_pk_bf16_f32 v66, v15, v17
    v_mul_f32 v18, v102, v102
    v_mfma_f32_32x32x16_bf16 v[192:207], v[48:51], v[28:31], v[192:207]
    v_mul_f32 v20, v103, v103
    v_fma_f32 v18, v18, v82, v80
    v_fma_f32 v20, v20, v82, v80
    v_mul_f32 v18, v18, v102
    v_mul_f32 v20, v20, v103
    v_exp_f32 v18, v18
    v_mfma_f32_32x32x16_bf16 v[208:223], v[48:51], v[32:35], v[208:223]
    v_exp_f32 v20, v20
    v_mul_f32 v19, v102, v110
    v_mul_f32 v21, v103, v111
    v_fma_f32 v18, v18, v84, v84
    v_fma_f32 v20, v20, v84, v84
    v_rcp_f32 v18, v18
    ds_read_b64_tr_b16 v[28:29], v71 offset:0
    ds_read_b64_tr_b16 v[30:31], v71 offset:2048
    ds_read_b64_tr_b16 v[32:33], v72 offset:0
    ds_read_b64_tr_b16 v[34:35], v72 offset:2048
    ds_read_b64_tr_b16 v[44:45], v73 offset:224
    ds_read_b64_tr_b16 v[46:47], v73 offset:1376
    ds_read_b64_tr_b16 v[48:49], v73 offset:256
    ds_read_b64_tr_b16 v[50:51], v73 offset:1408
    s_waitcnt lgkmcnt(8)
    v_mfma_f32_32x32x16_bf16 v[160:175], v[52:55], v[36:39], v[160:175]
    v_rcp_f32 v20, v20
    v_mul_f32 v19, v19, v18
    v_mul_f32 v21, v21, v20
    v_cvt_pk_bf16_f32 v67, v19, v21
    buffer_store_dwordx4 v[64:67], v25, s[32:35], s68 offen sc1
    v_mul_f32 v14, v112, v112
    v_mfma_f32_32x32x16_bf16 v[176:191], v[52:55], v[40:43], v[176:191]
    v_mul_f32 v16, v113, v113
    v_fma_f32 v14, v14, v83, v81
    v_fma_f32 v16, v16, v83, v81
    v_mul_f32 v14, v14, v112
    v_mul_f32 v16, v16, v113
    v_exp_f32 v14, v14
    v_mfma_f32_32x32x16_bf16 v[192:207], v[56:59], v[36:39], v[192:207]
    v_exp_f32 v16, v16
    v_mul_f32 v15, v112, v120
    v_mul_f32 v17, v113, v121
    v_fma_f32 v14, v14, v85, v85
    v_fma_f32 v16, v16, v85, v85
    v_rcp_f32 v14, v14
    v_mfma_f32_32x32x16_bf16 v[208:223], v[56:59], v[40:43], v[208:223]
    v_rcp_f32 v16, v16
    v_mul_f32 v15, v15, v14
    v_mul_f32 v17, v17, v16
    v_cvt_pk_bf16_f32 v88, v15, v17
    v_mul_f32 v18, v114, v114
    v_mul_f32 v20, v115, v115
    ds_read_b64_tr_b16 v[36:37], v71 offset:8192
    ds_read_b64_tr_b16 v[38:39], v71 offset:10240
    ds_read_b64_tr_b16 v[40:41], v72 offset:8192
    ds_read_b64_tr_b16 v[42:43], v72 offset:10240
    ds_read_b64_tr_b16 v[52:53], v73 offset:4832
    ds_read_b64_tr_b16 v[54:55], v73 offset:5984
    ds_read_b64_tr_b16 v[56:57], v73 offset:4864
    ds_read_b64_tr_b16 v[58:59], v73 offset:6016
    s_waitcnt lgkmcnt(8)
    v_mfma_f32_32x32x16_bf16 v[160:175], v[44:47], v[28:31], v[160:175]
    v_fma_f32 v18, v18, v83, v81
    v_fma_f32 v20, v20, v83, v81
    v_mul_f32 v18, v18, v114
    v_mul_f32 v20, v20, v115
    v_exp_f32 v18, v18
    v_exp_f32 v20, v20
    v_mfma_f32_32x32x16_bf16 v[176:191], v[44:47], v[32:35], v[176:191]
    v_mul_f32 v19, v114, v122
    v_mul_f32 v21, v115, v123
    v_fma_f32 v18, v18, v85, v85
    v_fma_f32 v20, v20, v85, v85
    v_rcp_f32 v18, v18
    v_rcp_f32 v20, v20
    v_mfma_f32_32x32x16_bf16 v[192:207], v[48:51], v[28:31], v[192:207]
    v_mul_f32 v19, v19, v18
    v_mul_f32 v21, v21, v20
    v_cvt_pk_bf16_f32 v89, v19, v21
    v_mul_f32 v14, v116, v116
    v_mul_f32 v16, v117, v117
    v_fma_f32 v14, v14, v83, v81
    v_mfma_f32_32x32x16_bf16 v[208:223], v[48:51], v[32:35], v[208:223]
    v_fma_f32 v16, v16, v83, v81
    v_mul_f32 v14, v14, v116
    v_mul_f32 v16, v16, v117
    v_exp_f32 v14, v14
    v_exp_f32 v16, v16
    v_mul_f32 v15, v116, v124
    s_waitcnt lgkmcnt(0)
    v_mfma_f32_32x32x16_bf16 v[160:175], v[52:55], v[36:39], v[160:175]
    v_mul_f32 v17, v117, v125
    v_fma_f32 v14, v14, v85, v85
    v_fma_f32 v16, v16, v85, v85
    v_rcp_f32 v14, v14
    v_rcp_f32 v16, v16
    v_mul_f32 v15, v15, v14
    v_mfma_f32_32x32x16_bf16 v[176:191], v[52:55], v[40:43], v[176:191]
    v_mul_f32 v17, v17, v16
    v_cvt_pk_bf16_f32 v90, v15, v17
    v_mul_f32 v18, v118, v118
    v_mul_f32 v20, v119, v119
    v_fma_f32 v18, v18, v83, v81
    v_fma_f32 v20, v20, v83, v81
    v_mfma_f32_32x32x16_bf16 v[192:207], v[56:59], v[36:39], v[192:207]
    v_mul_f32 v18, v18, v118
    v_mul_f32 v20, v20, v119
    v_exp_f32 v18, v18
    v_exp_f32 v20, v20
    v_mul_f32 v19, v118, v126
    v_mul_f32 v21, v119, v127
    v_mfma_f32_32x32x16_bf16 v[208:223], v[56:59], v[40:43], v[208:223]
    v_fma_f32 v18, v18, v85, v85
    v_fma_f32 v20, v20, v85, v85
    v_rcp_f32 v18, v18
    v_rcp_f32 v20, v20
    v_mul_f32 v19, v19, v18
    v_mul_f32 v21, v21, v20
    v_cvt_pk_bf16_f32 v91, v19, v21
    s_barrier
    buffer_store_dwordx4 v[88:91], v25, s[32:35], s69 offen sc1
    s_add_u32 s44, s62, 6
    s_lshr_b32 s45, s44, 1
    s_lshl_b32 s45, s45, 12
    s_and_b32 s44, s44, 1
    s_lshl_b32 s44, s44, 9
    s_add_u32 s45, s45, s44
    s_add_u32 s68, s45, s61
    s_add_u32 s69, s68, 2048
    v_pk_mul_f32 v[14:15], v[128:129], v[128:129]
    v_pk_mul_f32 v[18:19], v[130:131], v[130:131]
    v_pk_fma_f32 v[14:15], v[14:15], v[82:83], v[80:81] op_sel:[0,0,0] op_sel_hi:[1,0,0]
    v_pk_fma_f32 v[18:19], v[18:19], v[82:83], v[80:81] op_sel:[0,0,0] op_sel_hi:[1,0,0]
    v_pk_mul_f32 v[14:15], v[14:15], v[128:129]
    v_pk_mul_f32 v[18:19], v[18:19], v[130:131]
    v_exp_f32 v14, v14
    v_exp_f32 v18, v18
    v_exp_f32 v15, v15
    v_exp_f32 v19, v19
    v_pk_mul_f32 v[16:17], v[128:129], v[136:137]
    v_pk_mul_f32 v[20:21], v[130:131], v[138:139]
    v_pk_fma_f32 v[14:15], v[14:15], v[84:85], v[84:85] op_sel:[0,0,0] op_sel_hi:[1,0,0]
    v_pk_fma_f32 v[18:19], v[18:19], v[84:85], v[84:85] op_sel:[0,0,0] op_sel_hi:[1,0,0]
    v_rcp_f32 v14, v14
    v_rcp_f32 v18, v18
    v_rcp_f32 v15, v15
    v_rcp_f32 v19, v19
    v_pk_mul_f32 v[16:17], v[16:17], v[14:15]
    v_pk_mul_f32 v[20:21], v[20:21], v[18:19]
    v_cvt_pk_bf16_f32 v64, v16, v17
    v_cvt_pk_bf16_f32 v65, v20, v21
    v_pk_mul_f32 v[14:15], v[132:133], v[132:133]
    v_pk_mul_f32 v[18:19], v[134:135], v[134:135]
    v_pk_fma_f32 v[14:15], v[14:15], v[82:83], v[80:81] op_sel:[0,0,0] op_sel_hi:[1,0,0]
    v_pk_fma_f32 v[18:19], v[18:19], v[82:83], v[80:81] op_sel:[0,0,0] op_sel_hi:[1,0,0]
    v_pk_mul_f32 v[14:15], v[14:15], v[132:133]
    v_pk_mul_f32 v[18:19], v[18:19], v[134:135]
    v_exp_f32 v14, v14
    v_exp_f32 v18, v18
    v_exp_f32 v15, v15
    v_exp_f32 v19, v19
    v_pk_mul_f32 v[16:17], v[132:133], v[140:141]
    v_pk_mul_f32 v[20:21], v[134:135], v[142:143]
    v_pk_fma_f32 v[14:15], v[14:15], v[84:85], v[84:85] op_sel:[0,0,0] op_sel_hi:[1,0,0]
    v_pk_fma_f32 v[18:19], v[18:19], v[84:85], v[84:85] op_sel:[0,0,0] op_sel_hi:[1,0,0]
    v_rcp_f32 v14, v14
    v_rcp_f32 v18, v18
    v_rcp_f32 v15, v15
    v_rcp_f32 v19, v19
    v_pk_mul_f32 v[16:17], v[16:17], v[14:15]
    v_pk_mul_f32 v[20:21], v[20:21], v[18:19]
    v_cvt_pk_bf16_f32 v66, v16, v17
    v_cvt_pk_bf16_f32 v67, v20, v21
    buffer_store_dwordx4 v[64:67], v25, s[32:35], s68 offen sc1
    v_pk_mul_f32 v[14:15], v[144:145], v[144:145]
    v_pk_mul_f32 v[18:19], v[146:147], v[146:147]
    v_pk_fma_f32 v[14:15], v[14:15], v[82:83], v[80:81] op_sel:[0,1,1] op_sel_hi:[1,1,1]
    v_pk_fma_f32 v[18:19], v[18:19], v[82:83], v[80:81] op_sel:[0,1,1] op_sel_hi:[1,1,1]
    v_pk_mul_f32 v[14:15], v[14:15], v[144:145]
    v_pk_mul_f32 v[18:19], v[18:19], v[146:147]
    v_exp_f32 v14, v14
    v_exp_f32 v18, v18
    v_exp_f32 v15, v15
    v_exp_f32 v19, v19
    v_pk_mul_f32 v[16:17], v[144:145], v[152:153]
    v_pk_mul_f32 v[20:21], v[146:147], v[154:155]
    v_pk_fma_f32 v[14:15], v[14:15], v[84:85], v[84:85] op_sel:[0,1,1] op_sel_hi:[1,1,1]
    v_pk_fma_f32 v[18:19], v[18:19], v[84:85], v[84:85] op_sel:[0,1,1] op_sel_hi:[1,1,1]
    v_rcp_f32 v14, v14
    v_rcp_f32 v18, v18
    v_rcp_f32 v15, v15
    v_rcp_f32 v19, v19
    v_pk_mul_f32 v[16:17], v[16:17], v[14:15]
    v_pk_mul_f32 v[20:21], v[20:21], v[18:19]
    v_cvt_pk_bf16_f32 v88, v16, v17
    v_cvt_pk_bf16_f32 v89, v20, v21
    v_pk_mul_f32 v[14:15], v[148:149], v[148:149]
    v_pk_mul_f32 v[18:19], v[150:151], v[150:151]
    v_pk_fma_f32 v[14:15], v[14:15], v[82:83], v[80:81] op_sel:[0,1,1] op_sel_hi:[1,1,1]
    v_pk_fma_f32 v[18:19], v[18:19], v[82:83], v[80:81] op_sel:[0,1,1] op_sel_hi:[1,1,1]
    v_pk_mul_f32 v[14:15], v[14:15], v[148:149]
    v_pk_mul_f32 v[18:19], v[18:19], v[150:151]
    v_exp_f32 v14, v14
    v_exp_f32 v18, v18
    v_exp_f32 v15, v15
    v_exp_f32 v19, v19
    v_pk_mul_f32 v[16:17], v[148:149], v[156:157]
    v_pk_mul_f32 v[20:21], v[150:151], v[158:159]
    v_pk_fma_f32 v[14:15], v[14:15], v[84:85], v[84:85] op_sel:[0,1,1] op_sel_hi:[1,1,1]
    v_pk_fma_f32 v[18:19], v[18:19], v[84:85], v[84:85] op_sel:[0,1,1] op_sel_hi:[1,1,1]
    v_rcp_f32 v14, v14
    v_rcp_f32 v18, v18
    v_rcp_f32 v15, v15
    v_rcp_f32 v19, v19
    v_pk_mul_f32 v[16:17], v[16:17], v[14:15]
    v_pk_mul_f32 v[20:21], v[20:21], v[18:19]
    v_cvt_pk_bf16_f32 v90, v16, v17
    v_cvt_pk_bf16_f32 v91, v20, v21
    buffer_store_dwordx4 v[88:91], v25, s[32:35], s69 offen sc1
    s_add_u32 s44, s62, 7
    s_lshr_b32 s45, s44, 1
    s_lshl_b32 s45, s45, 12
    s_and_b32 s44, s44, 1
    s_lshl_b32 s44, s44, 9
    s_add_u32 s45, s45, s44
    s_add_u32 s68, s45, s61
    s_add_u32 s69, s68, 2048
    v_pk_mul_f32 v[14:15], v[160:161], v[160:161]
    v_pk_mul_f32 v[18:19], v[162:163], v[162:163]
    v_pk_fma_f32 v[14:15], v[14:15], v[82:83], v[80:81] op_sel:[0,0,0] op_sel_hi:[1,0,0]
    v_pk_fma_f32 v[18:19], v[18:19], v[82:83], v[80:81] op_sel:[0,0,0] op_sel_hi:[1,0,0]
    v_pk_mul_f32 v[14:15], v[14:15], v[160:161]
    v_pk_mul_f32 v[18:19], v[18:19], v[162:163]
    v_exp_f32 v14, v14
    v_exp_f32 v18, v18
    v_exp_f32 v15, v15
    v_exp_f32 v19, v19
    v_pk_mul_f32 v[16:17], v[160:161], v[168:169]
    v_pk_mul_f32 v[20:21], v[162:163], v[170:171]
    v_pk_fma_f32 v[14:15], v[14:15], v[84:85], v[84:85] op_sel:[0,0,0] op_sel_hi:[1,0,0]
    v_pk_fma_f32 v[18:19], v[18:19], v[84:85], v[84:85] op_sel:[0,0,0] op_sel_hi:[1,0,0]
    v_rcp_f32 v14, v14
    v_rcp_f32 v18, v18
    v_rcp_f32 v15, v15
    v_rcp_f32 v19, v19
    v_pk_mul_f32 v[16:17], v[16:17], v[14:15]
    v_pk_mul_f32 v[20:21], v[20:21], v[18:19]
    v_cvt_pk_bf16_f32 v64, v16, v17
    v_cvt_pk_bf16_f32 v65, v20, v21
    v_pk_mul_f32 v[14:15], v[164:165], v[164:165]
    v_pk_mul_f32 v[18:19], v[166:167], v[166:167]
    v_pk_fma_f32 v[14:15], v[14:15], v[82:83], v[80:81] op_sel:[0,0,0] op_sel_hi:[1,0,0]
    v_pk_fma_f32 v[18:19], v[18:19], v[82:83], v[80:81] op_sel:[0,0,0] op_sel_hi:[1,0,0]
    v_pk_mul_f32 v[14:15], v[14:15], v[164:165]
    v_pk_mul_f32 v[18:19], v[18:19], v[166:167]
    v_exp_f32 v14, v14
    v_exp_f32 v18, v18
    v_exp_f32 v15, v15
    v_exp_f32 v19, v19
    v_pk_mul_f32 v[16:17], v[164:165], v[172:173]
    v_pk_mul_f32 v[20:21], v[166:167], v[174:175]
    v_pk_fma_f32 v[14:15], v[14:15], v[84:85], v[84:85] op_sel:[0,0,0] op_sel_hi:[1,0,0]
    v_pk_fma_f32 v[18:19], v[18:19], v[84:85], v[84:85] op_sel:[0,0,0] op_sel_hi:[1,0,0]
    v_rcp_f32 v14, v14
    v_rcp_f32 v18, v18
    v_rcp_f32 v15, v15
    v_rcp_f32 v19, v19
    v_pk_mul_f32 v[16:17], v[16:17], v[14:15]
    v_pk_mul_f32 v[20:21], v[20:21], v[18:19]
    v_cvt_pk_bf16_f32 v66, v16, v17
    v_cvt_pk_bf16_f32 v67, v20, v21
    buffer_store_dwordx4 v[64:67], v25, s[32:35], s68 offen sc1
    v_pk_mul_f32 v[14:15], v[176:177], v[176:177]
    v_pk_mul_f32 v[18:19], v[178:179], v[178:179]
    v_pk_fma_f32 v[14:15], v[14:15], v[82:83], v[80:81] op_sel:[0,1,1] op_sel_hi:[1,1,1]
    v_pk_fma_f32 v[18:19], v[18:19], v[82:83], v[80:81] op_sel:[0,1,1] op_sel_hi:[1,1,1]
    v_pk_mul_f32 v[14:15], v[14:15], v[176:177]
    v_pk_mul_f32 v[18:19], v[18:19], v[178:179]
    v_exp_f32 v14, v14
    v_exp_f32 v18, v18
    v_exp_f32 v15, v15
    v_exp_f32 v19, v19
    v_pk_mul_f32 v[16:17], v[176:177], v[184:185]
    v_pk_mul_f32 v[20:21], v[178:179], v[186:187]
    v_pk_fma_f32 v[14:15], v[14:15], v[84:85], v[84:85] op_sel:[0,1,1] op_sel_hi:[1,1,1]
    v_pk_fma_f32 v[18:19], v[18:19], v[84:85], v[84:85] op_sel:[0,1,1] op_sel_hi:[1,1,1]
    v_rcp_f32 v14, v14
    v_rcp_f32 v18, v18
    v_rcp_f32 v15, v15
    v_rcp_f32 v19, v19
    v_pk_mul_f32 v[16:17], v[16:17], v[14:15]
    v_pk_mul_f32 v[20:21], v[20:21], v[18:19]
    v_cvt_pk_bf16_f32 v88, v16, v17
    v_cvt_pk_bf16_f32 v89, v20, v21
    v_pk_mul_f32 v[14:15], v[180:181], v[180:181]
    v_pk_mul_f32 v[18:19], v[182:183], v[182:183]
    v_pk_fma_f32 v[14:15], v[14:15], v[82:83], v[80:81] op_sel:[0,1,1] op_sel_hi:[1,1,1]
    v_pk_fma_f32 v[18:19], v[18:19], v[82:83], v[80:81] op_sel:[0,1,1] op_sel_hi:[1,1,1]
    v_pk_mul_f32 v[14:15], v[14:15], v[180:181]
    v_pk_mul_f32 v[18:19], v[18:19], v[182:183]
    v_exp_f32 v14, v14
    v_exp_f32 v18, v18
    v_exp_f32 v15, v15
    v_exp_f32 v19, v19
    v_pk_mul_f32 v[16:17], v[180:181], v[188:189]
    v_pk_mul_f32 v[20:21], v[182:183], v[190:191]
    v_pk_fma_f32 v[14:15], v[14:15], v[84:85], v[84:85] op_sel:[0,1,1] op_sel_hi:[1,1,1]
    v_pk_fma_f32 v[18:19], v[18:19], v[84:85], v[84:85] op_sel:[0,1,1] op_sel_hi:[1,1,1]
    v_rcp_f32 v14, v14
    v_rcp_f32 v18, v18
    v_rcp_f32 v15, v15
    v_rcp_f32 v19, v19
    v_pk_mul_f32 v[16:17], v[16:17], v[14:15]
    v_pk_mul_f32 v[20:21], v[20:21], v[18:19]
    v_cvt_pk_bf16_f32 v90, v16, v17
    v_cvt_pk_bf16_f32 v91, v20, v21
    buffer_store_dwordx4 v[88:91], v25, s[32:35], s69 offen sc1
    s_add_u32 s44, s62, 8
    s_lshr_b32 s45, s44, 1
    s_lshl_b32 s45, s45, 12
    s_and_b32 s44, s44, 1
    s_lshl_b32 s44, s44, 9
    s_add_u32 s45, s45, s44
    s_add_u32 s68, s45, s61
    s_add_u32 s69, s68, 2048
    v_pk_mul_f32 v[14:15], v[192:193], v[192:193]
    v_pk_mul_f32 v[18:19], v[194:195], v[194:195]
    v_pk_fma_f32 v[14:15], v[14:15], v[82:83], v[80:81] op_sel:[0,0,0] op_sel_hi:[1,0,0]
    v_pk_fma_f32 v[18:19], v[18:19], v[82:83], v[80:81] op_sel:[0,0,0] op_sel_hi:[1,0,0]
    v_pk_mul_f32 v[14:15], v[14:15], v[192:193]
    v_pk_mul_f32 v[18:19], v[18:19], v[194:195]
    v_exp_f32 v14, v14
    v_exp_f32 v18, v18
    v_exp_f32 v15, v15
    v_exp_f32 v19, v19
    v_pk_mul_f32 v[16:17], v[192:193], v[200:201]
    v_pk_mul_f32 v[20:21], v[194:195], v[202:203]
    v_pk_fma_f32 v[14:15], v[14:15], v[84:85], v[84:85] op_sel:[0,0,0] op_sel_hi:[1,0,0]
    v_pk_fma_f32 v[18:19], v[18:19], v[84:85], v[84:85] op_sel:[0,0,0] op_sel_hi:[1,0,0]
    v_rcp_f32 v14, v14
    v_rcp_f32 v18, v18
    v_rcp_f32 v15, v15
    v_rcp_f32 v19, v19
    v_pk_mul_f32 v[16:17], v[16:17], v[14:15]
    v_pk_mul_f32 v[20:21], v[20:21], v[18:19]
    v_cvt_pk_bf16_f32 v64, v16, v17
    v_cvt_pk_bf16_f32 v65, v20, v21
    v_pk_mul_f32 v[14:15], v[196:197], v[196:197]
    v_pk_mul_f32 v[18:19], v[198:199], v[198:199]
    v_pk_fma_f32 v[14:15], v[14:15], v[82:83], v[80:81] op_sel:[0,0,0] op_sel_hi:[1,0,0]
    v_pk_fma_f32 v[18:19], v[18:19], v[82:83], v[80:81] op_sel:[0,0,0] op_sel_hi:[1,0,0]
    v_pk_mul_f32 v[14:15], v[14:15], v[196:197]
    v_pk_mul_f32 v[18:19], v[18:19], v[198:199]
    v_exp_f32 v14, v14
    v_exp_f32 v18, v18
    v_exp_f32 v15, v15
    v_exp_f32 v19, v19
    v_pk_mul_f32 v[16:17], v[196:197], v[204:205]
    v_pk_mul_f32 v[20:21], v[198:199], v[206:207]
    v_pk_fma_f32 v[14:15], v[14:15], v[84:85], v[84:85] op_sel:[0,0,0] op_sel_hi:[1,0,0]
    v_pk_fma_f32 v[18:19], v[18:19], v[84:85], v[84:85] op_sel:[0,0,0] op_sel_hi:[1,0,0]
    v_rcp_f32 v14, v14
    v_rcp_f32 v18, v18
    v_rcp_f32 v15, v15
    v_rcp_f32 v19, v19
    v_pk_mul_f32 v[16:17], v[16:17], v[14:15]
    v_pk_mul_f32 v[20:21], v[20:21], v[18:19]
    v_cvt_pk_bf16_f32 v66, v16, v17
    v_cvt_pk_bf16_f32 v67, v20, v21
    buffer_store_dwordx4 v[64:67], v25, s[32:35], s68 offen sc1
    v_pk_mul_f32 v[14:15], v[208:209], v[208:209]
    v_pk_mul_f32 v[18:19], v[210:211], v[210:211]
    v_pk_fma_f32 v[14:15], v[14:15], v[82:83], v[80:81] op_sel:[0,1,1] op_sel_hi:[1,1,1]
    v_pk_fma_f32 v[18:19], v[18:19], v[82:83], v[80:81] op_sel:[0,1,1] op_sel_hi:[1,1,1]
    v_pk_mul_f32 v[14:15], v[14:15], v[208:209]
    v_pk_mul_f32 v[18:19], v[18:19], v[210:211]
    v_exp_f32 v14, v14
    v_exp_f32 v18, v18
    v_exp_f32 v15, v15
    v_exp_f32 v19, v19
    v_pk_mul_f32 v[16:17], v[208:209], v[216:217]
    v_pk_mul_f32 v[20:21], v[210:211], v[218:219]
    v_pk_fma_f32 v[14:15], v[14:15], v[84:85], v[84:85] op_sel:[0,1,1] op_sel_hi:[1,1,1]
    v_pk_fma_f32 v[18:19], v[18:19], v[84:85], v[84:85] op_sel:[0,1,1] op_sel_hi:[1,1,1]
    v_rcp_f32 v14, v14
    v_rcp_f32 v18, v18
    v_rcp_f32 v15, v15
    v_rcp_f32 v19, v19
    v_pk_mul_f32 v[16:17], v[16:17], v[14:15]
    v_pk_mul_f32 v[20:21], v[20:21], v[18:19]
    v_cvt_pk_bf16_f32 v88, v16, v17
    v_cvt_pk_bf16_f32 v89, v20, v21
    v_pk_mul_f32 v[14:15], v[212:213], v[212:213]
    v_pk_mul_f32 v[18:19], v[214:215], v[214:215]
    v_pk_fma_f32 v[14:15], v[14:15], v[82:83], v[80:81] op_sel:[0,1,1] op_sel_hi:[1,1,1]
    v_pk_fma_f32 v[18:19], v[18:19], v[82:83], v[80:81] op_sel:[0,1,1] op_sel_hi:[1,1,1]
    v_pk_mul_f32 v[14:15], v[14:15], v[212:213]
    v_pk_mul_f32 v[18:19], v[18:19], v[214:215]
    v_exp_f32 v14, v14
    v_exp_f32 v18, v18
    v_exp_f32 v15, v15
    v_exp_f32 v19, v19
    v_pk_mul_f32 v[16:17], v[212:213], v[220:221]
    v_pk_mul_f32 v[20:21], v[214:215], v[222:223]
    v_pk_fma_f32 v[14:15], v[14:15], v[84:85], v[84:85] op_sel:[0,1,1] op_sel_hi:[1,1,1]
    v_pk_fma_f32 v[18:19], v[18:19], v[84:85], v[84:85] op_sel:[0,1,1] op_sel_hi:[1,1,1]
    v_rcp_f32 v14, v14
    v_rcp_f32 v18, v18
    v_rcp_f32 v15, v15
    v_rcp_f32 v19, v19
    v_pk_mul_f32 v[16:17], v[16:17], v[14:15]
    v_pk_mul_f32 v[20:21], v[20:21], v[18:19]
    v_cvt_pk_bf16_f32 v90, v16, v17
    v_cvt_pk_bf16_f32 v91, v20, v21
    buffer_store_dwordx4 v[88:91], v25, s[32:35], s69 offen sc1
L_k4_done:
    s_endpgm
.section .rodata,"a"
.p2align 6
.amdhsa_kernel k4_kernel
  .amdhsa_next_free_vgpr 256
  .amdhsa_next_free_sgpr 102
  .amdhsa_accum_offset 256
  .amdhsa_group_segment_fixed_size 0
  .amdhsa_kernarg_size 112
  .amdhsa_user_sgpr_count 2
  .amdhsa_user_sgpr_kernarg_segment_ptr 1
  .amdhsa_system_sgpr_workgroup_id_x 1
.end_amdhsa_kernel
.text
.globl k5_kernel
.p2align 8
.type k5_kernel,@function
k5_kernel:
    s_load_dwordx16 s[16:31], s[0:1], 0
    s_load_dwordx8 s[32:39], s[0:1], 64
    s_load_dwordx4 s[40:43], s[0:1], 96
    s_cmp_ge_u32 s2, 256
    s_cbranch_scc1 L_k5_done
    s_and_b32 s12, s2, 7
    s_lshr_b32 s13, s2, 3
    s_lshr_b32 s14, s12, 1
    s_and_b32 s15, s12, 1
    s_lshl_b32 s15, s15, 3
    s_lshr_b32 s44, s13, 2
    s_add_u32 s15, s15, s44
    s_and_b32 s46, s13, 3
    v_and_b32 v1, 63, v0
    v_lshrrev_b32 v2, 6, v0
    s_nop 0
    v_readfirstlane_b32 s47, v2
    v_lshlrev_b32 v3, 4, v1
    s_mul_i32 s51, s14, 1327104
    s_mul_i32 s44, s46, 288
    s_add_u32 s51, s51, s44
    s_add_u32 s44, s47, 0
    s_mul_i32 s45, s44, 7282
    s_lshr_b32 s45, s45, 16
    s_mul_i32 s52, s45, 36864
    s_add_u32 s54, s52, s51
    s_lshl_b32 s60, s44, 10
    s_mul_i32 s52, s45, 9
    s_sub_u32 s52, s44, s52
    s_lshl_b32 s52, s52, 6
    v_add_u32 v15, s52, v1
    v_mul_u32_u24 v16, 0xe38f, v15
    v_lshrrev_b32 v16, 20, v16
    v_mul_u32_u24 v17, 18, v16
    v_sub_u32 v17, v15, v17
    v_and_b32 v18, 0x13, v16
    v_and_b32 v19, 4, v16
    v_lshl_or_b32 v18, v19, 1, v18
    v_and_b32 v19, 8, v16
    v_lshrrev_b32 v19, 1, v19
    v_or_b32 v18, v18, v19
    v_mul_u32_u24 v18, 1152, v18
    v_lshl_add_u32 v20, v17, 4, v18
    s_add_u32 s44, s47, 8
    s_mul_i32 s45, s44, 7282
    s_lshr_b32 s45, s45, 16
    s_mul_i32 s52, s45, 36864
    s_add_u32 s55, s52, s51
    s_lshl_b32 s61, s44, 10
    s_mul_i32 s52, s45, 9
    s_sub_u32 s52, s44, s52
    s_lshl_b32 s52, s52, 6
    v_add_u32 v15, s52, v1
    v_mul_u32_u24 v16, 0xe38f, v15
    v_lshrrev_b32 v16, 20, v16
    v_mul_u32_u24 v17, 18, v16
    v_sub_u32 v17, v15, v17
    v_and_b32 v18, 0x13, v16
    v_and_b32 v19, 4, v16
    v_lshl_or_b32 v18, v19, 1, v18
    v_and_b32 v19, 8, v16
    v_lshrrev_b32 v19, 1, v19
    v_or_b32 v18, v18, v19
    v_mul_u32_u24 v18, 1152, v18
    v_lshl_add_u32 v21, v17, 4, v18
    s_add_u32 s44, s47, 16
    s_mul_i32 s45, s44, 7282
    s_lshr_b32 s45, s45, 16
    s_mul_i32 s52, s45, 36864
    s_add_u32 s56, s52, s51
    s_lshl_b32 s62, s44, 10
    s_mul_i32 s52, s45, 9
    s_sub_u32 s52, s44, s52
    s_lshl_b32 s52, s52, 6
    v_add_u32 v15, s52, v1
    v_mul_u32_u24 v16, 0xe38f, v15
    v_lshrrev_b32 v16, 20, v16
    v_mul_u32_u24 v17, 18, v16
    v_sub_u32 v17, v15, v17
    v_and_b32 v18, 0x13, v16
    v_and_b32 v19, 4, v16
    v_lshl_or_b32 v18, v19, 1, v18
    v_and_b32 v19, 8, v16
    v_lshrrev_b32 v19, 1, v19
    v_or_b32 v18, v18, v19
    v_mul_u32_u24 v18, 1152, v18
    v_lshl_add_u32 v22, v17, 4, v18
    s_add_u32 s44, s47, 24
    s_mul_i32 s45, s44, 7282
    s_lshr_b32 s45, s45, 16
    s_mul_i32 s52, s45, 36864
    s_add_u32 s57, s52, s51
    s_lshl_b32 s63, s44, 10
    s_mul_i32 s52, s45, 9
    s_sub_u32 s52, s44, s52
    s_lshl_b32 s52, s52, 6
    v_add_u32 v15, s52, v1
    v_mul_u32_u24 v16, 0xe38f, v15
    v_lshrrev_b32 v16, 20, v16
    v_mul_u32_u24 v17, 18, v16
    v_sub_u32 v17, v15, v17
    v_and_b32 v18, 0x13, v16
    v_and_b32 v19, 4, v16
    v_lshl_or_b32 v18, v19, 1, v18
    v_and_b32 v19, 8, v16
    v_lshrrev_b32 v19, 1, v19
    v_or_b32 v18, v18, v19
    v_mul_u32_u24 v18, 1152, v18
    v_lshl_add_u32 v23, v17, 4, v18
    s_add_u32 s44, s47, 32
    s_mul_i32 s45, s44, 7282
    s_lshr_b32 s45, s45, 16
    s_mul_i32 s52, s45, 36864
    s_add_u32 s58, s52, s51
    s_lshl_b32 s64, s44, 10
    s_mul_i32 s52, s45, 9
    s_sub_u32 s52, s44, s52
    s_lshl_b32 s52, s52, 6
    v_add_u32 v15, s52, v1
    v_mul_u32_u24 v16, 0xe38f, v15
    v_lshrrev_b32 v16, 20, v16
    v_mul_u32_u24 v17, 18, v16
    v_sub_u32 v17, v15, v17
    v_and_b32 v18, 0x13, v16
    v_and_b32 v19, 4, v16
    v_lshl_or_b32 v18, v19, 1, v18
    v_and_b32 v19, 8, v16
    v_lshrrev_b32 v19, 1, v19
    v_or_b32 v18, v18, v19
    v_mul_u32_u24 v18, 1152, v18
    v_lshl_add_u32 v24, v17, 4, v18
    s_mov_b32 s53, 0
    s_mov_b32 s59, 0
    s_and_b32 s48, s47, 3
    s_lshr_b32 s49, s47, 2
    s_lshl_b32 s50, s15, 1
    s_lshr_b32 s44, s48, 1
    s_add_u32 s50, s50, s44
    s_mul_i32 s50, s50, 144
    s_mul_i32 s44, s14, 36
    s_add_u32 s50, s50, s44
    s_add_u32 s50, s50, s49
    s_lshl_b32 s50, s50, 2
    s_and_b32 s44, s48, 1
    s_lshl_b32 s44, s44, 1
    s_add_u32 s50, s50, s44
    s_lshl_b32 s50, s50, 10
    s_waitcnt lgkmcnt(0)
    s_mov_b32 s20, s36
    s_and_b32 s21, s37, 0xffff
    s_mov_b32 s22, 5308416
    s_mov_b32 s23, 0x20000
    s_add_u32 s16, s42, 27832320
    s_addc_u32 s17, s43, 0
    s_and_b32 s17, s17, 0xffff
    s_mov_b32 s18, 18874368
    s_mov_b32 s19, 0x20000
    s_add_u32 m0, s53, s60
    s_add_u32 s44, s59, s54
    buffer_load_dwordx4 v20, s[20:23], s44 offen lds
    s_add_u32 m0, s53, s61
    s_add_u32 s44, s59, s55
    buffer_load_dwordx4 v21, s[20:23], s44 offen lds
    s_add_u32 m0, s53, s62
    s_add_u32 s44, s59, s56
    buffer_load_dwordx4 v22, s[20:23], s44 offen lds
    s_add_u32 m0, s53, s63
    s_add_u32 s44, s59, s57
    buffer_load_dwordx4 v23, s[20:23], s44 offen lds
    s_cmp_ge_u32 s47, 4
    s_cbranch_scc1 L_no5_0
    s_add_u32 m0, s53, s64
    s_add_u32 s44, s59, s58
    buffer_load_dwordx4 v24, s[20:23], s44 offen lds
L_no5_0:
    s_add_u32 s59, s59, 147456
    s_add_u32 s53, s53, 36864
    s_cmp_eq_u32 s53, 147456
    s_cselect_b32 s53, 0, s53
    s_add_u32 s45, s50, 0
    buffer_load_dwordx4 v[176:179], v3, s[16:19], s45 offen
    buffer_load_dwordx4 v[180:183], v3, s[16:19], s45 offen offset:1024
    s_add_u32 s45, s50, 8192
    buffer_load_dwordx4 v[184:187], v3, s[16:19], s45 offen
    buffer_load_dwordx4 v[188:191], v3, s[16:19], s45 offen offset:1024
    s_add_u32 s24, s42, 7096320
    s_addc_u32 s25, s43, 0
    s_and_b32 s25, s25, 0xffff
    s_mov_b32 s26, 2359296
    s_mov_b32 s27, 0x20000
    s_mov_b32 s28, s38
    s_and_b32 s29, s39, 0xffff
    s_mov_b32 s30, 2359296
    s_mov_b32 s31, 0x20000
    s_add_u32 s32, s42, 46706688
    s_addc_u32 s33, s43, 0
    s_and_b32 s33, s33, 0xffff
    s_mov_b32 s34, 18874368
    s_mov_b32 s35, 0x20000
    s_add_u32 m0, s53, s60
    s_add_u32 s44, s59, s54
    buffer_load_dwordx4 v20, s[20:23], s44 offen lds
    s_add_u32 m0, s53, s61
    s_add_u32 s44, s59, s55
    buffer_load_dwordx4 v21, s[20:23], s44 offen lds
    s_add_u32 m0, s53, s62
    s_add_u32 s44, s59, s56
    buffer_load_dwordx4 v22, s[20:23], s44 offen lds
    s_add_u32 m0, s53, s63
    s_add_u32 s44, s59, s57
    buffer_load_dwordx4 v23, s[20:23], s44 offen lds
    s_cmp_ge_u32 s47, 4
    s_cbranch_scc1 L_no5_1
    s_add_u32 m0, s53, s64
    s_add_u32 s44, s59, s58
    buffer_load_dwordx4 v24, s[20:23], s44 offen lds
L_no5_1:
    s_add_u32 s59, s59, 147456
    s_add_u32 s53, s53, 36864
    s_cmp_eq_u32 s53, 147456
    s_cselect_b32 s53, 0, s53
    s_add_u32 s45, s50, 16384
    buffer_load_dwordx4 v[192:195], v3, s[16:19], s45 offen
    buffer_load_dwordx4 v[196:199], v3, s[16:19], s45 offen offset:1024
    s_add_u32 s45, s50, 24576
    buffer_load_dwordx4 v[200:203], v3, s[16:19], s45 offen
    buffer_load_dwordx4 v[204:207], v3, s[16:19], s45 offen offset:1024
    v_lshrrev_b32 v15, 5, v1
    v_lshlrev_b32 v15, 4, v15
    v_bfe_u32 v16, v1, 4, 1
    v_lshl_add_u32 v15, v16, 2, v15
    v_bfe_u32 v16, v1, 2, 2
    v_add_u32 v15, v15, v16
    v_mul_u32_u24 v15, 288, v15
    v_and_b32 v16, 3, v1
    v_lshl_add_u32 v15, v16, 3, v15
    s_mul_i32 s44, s49, 9216
    v_add_u32 v4, s44, v15
    v_add_u32 v5, 0, v4
    v_add_u32 v6, 36864, v4
    v_add_u32 v7, 73728, v4
    v_add_u32 v8, 110592, v4
    s_waitcnt vmcnt(12)
    s_barrier
    ds_read_b64_tr_b16 v[28:29], v5 offset:0
    ds_read_b64_tr_b16 v[30:31], v5 offset:2304
    ds_read_b64_tr_b16 v[32:33], v5 offset:32
    ds_read_b64_tr_b16 v[34:35], v5 offset:2336
    ds_read_b64_tr_b16 v[36:37], v5 offset:64
    ds_read_b64_tr_b16 v[38:39], v5 offset:2368
    ds_read_b64_tr_b16 v[40:41], v5 offset:96
    ds_read_b64_tr_b16 v[42:43], v5 offset:2400
    ds_read_b64_tr_b16 v[44:45], v5 offset:128
    ds_read_b64_tr_b16 v[46:47], v5 offset:2432
    s_waitcnt vmcnt(10)
    ds_read_b64_tr_b16 v[48:49], v5 offset:160
    ds_read_b64_tr_b16 v[50:51], v5 offset:2464
    s_waitcnt lgkmcnt(10)
    v_mfma_f32_16x16x32_bf16 v[96:99], v[28:31], v[176:179], 0
    v_mfma_f32_16x16x32_bf16 v[132:135], v[28:31], v[180:183], 0
    s_add_u32 m0, s53, s60
    s_add_u32 s44, s59, s54
    buffer_load_dwordx4 v20, s[20:23], s44 offen lds
    s_add_u32 m0, s53, s61
    s_add_u32 s44, s59, s55
    buffer_load_dwordx4 v21, s[20:23], s44 offen lds
    s_add_u32 m0, s53, s62
    s_add_u32 s44, s59, s56
    buffer_load_dwordx4 v22, s[20:23], s44 offen lds
    s_add_u32 m0, s53, s63
    s_add_u32 s44, s59, s57
    buffer_load_dwordx4 v23, s[20:23], s44 offen lds
    s_cmp_ge_u32 s47, 4
    s_cbranch_scc1 L_no5_2
    s_add_u32 m0, s53, s64
    s_add_u32 s44, s59, s58
    buffer_load_dwordx4 v24, s[20:23], s44 offen lds
L_no5_2:
    s_add_u32 s59, s59, 147456
    s_add_u32 s53, s53, 36864
    s_cmp_eq_u32 s53, 147456
    s_cselect_b32 s53, 0, s53
    s_getpc_b64 s[4:5]
L_pf_k5:
    s_sub_u32 s4, s4, L_pf_k5-k5_kernel
    s_subb_u32 s5, s5, 0
    v_lshlrev_b32 v254, 4, v0
    s_mov_b32 s6, 0
    s_mov_b32 s7, L_k5_done-k5_kernel-4
L_pf_k5_l:
    v_min_u32 v253, s7, v254
    global_load_dword v255, v253, s[4:5]
    v_add_u32 v254, 8192, v254
    s_add_u32 s6, s6, 8192
    s_cmp_lt_u32 s6, s7
    s_cbranch_scc1 L_pf_k5_l
    v_and_b32 v10, 15, v1
    v_lshrrev_b32 v11, 4, v1
    v_lshlrev_b32 v12, 14, v11
    v_lshl_add_u32 v12, v10, 1, v12
    v_add_u32 v14, 4096, v12
    v_mul_u32_u24 v13, 1152, v10
    v_lshl_add_u32 v13, v11, 3, v13
    s_lshl_b32 s65, s15, 7
    s_lshl_b32 s44, s14, 5
    s_add_u32 s65, s65, s44
    s_mul_i32 s66, s46, 144
    s_min_u32 s79, s47, 5
    s_mul_i32 s44, s79, 3
    s_add_u32 s44, s44, 0
    s_cmp_ge_u32 s44, 9
    s_cselect_b32 s45, 1, 0
    s_mul_i32 s68, s45, 9
    s_sub_u32 s68, s44, s68
    s_mov_b32 s70, s45
    s_mov_b32 s73, s68
    s_lshl_b32 s69, s68, 4
    s_add_u32 s69, s69, s66
    s_lshl_b32 s45, s45, 4
    s_add_u32 s45, s45, s65
    s_lshl_b32 s80, s69, 12
    s_lshl_b32 s81, s45, 1
    s_add_u32 s80, s80, s81
    s_add_u32 s81, s80, 8192
    buffer_load_ushort v224, v12, s[24:27], s80 offen
    buffer_load_ushort v225, v14, s[24:27], s80 offen
    buffer_load_ushort v226, v12, s[24:27], s81 offen
    buffer_load_ushort v227, v14, s[24:27], s81 offen
    s_mul_i32 s80, s45, 1152
    s_lshl_b32 s81, s69, 1
    s_add_u32 s76, s80, s81
    s_mul_i32 s44, s79, 3
    s_add_u32 s44, s44, 1
    s_cmp_ge_u32 s44, 9
    s_cselect_b32 s45, 1, 0
    s_mul_i32 s68, s45, 9
    s_sub_u32 s68, s44, s68
    s_mov_b32 s71, s45
    s_mov_b32 s74, s68
    s_lshl_b32 s69, s68, 4
    s_add_u32 s69, s69, s66
    s_lshl_b32 s45, s45, 4
    s_add_u32 s45, s45, s65
    s_lshl_b32 s80, s69, 12
    s_lshl_b32 s81, s45, 1
    s_add_u32 s80, s80, s81
    s_add_u32 s81, s80, 8192
    buffer_load_ushort v228, v12, s[24:27], s80 offen
    buffer_load_ushort v229, v14, s[24:27], s80 offen
    buffer_load_ushort v230, v12, s[24:27], s81 offen
    buffer_load_ushort v231, v14, s[24:27], s81 offen
    s_mul_i32 s80, s45, 1152
    s_lshl_b32 s81, s69, 1
    s_add_u32 s77, s80, s81
    s_mul_i32 s44, s79, 3
    s_add_u32 s44, s44, 2
    s_cmp_ge_u32 s44, 9
    s_cselect_b32 s45, 1, 0
    s_mul_i32 s68, s45, 9
    s_sub_u32 s68, s44, s68
    s_mov_b32 s72, s45
    s_mov_b32 s75, s68
    s_lshl_b32 s69, s68, 4
    s_add_u32 s69, s69, s66
    s_lshl_b32 s45, s45, 4
    s_add_u32 s45, s45, s65
    s_lshl_b32 s80, s69, 12
    s_lshl_b32 s81, s45, 1
    s_add_u32 s80, s80, s81
    s_add_u32 s81, s80, 8192
    buffer_load_ushort v232, v12, s[24:27], s80 offen
    buffer_load_ushort v233, v14, s[24:27], s80 offen
    buffer_load_ushort v234, v12, s[24:27], s81 offen
    buffer_load_ushort v235, v14, s[24:27], s81 offen
    s_mul_i32 s80, s45, 1152
    s_lshl_b32 s81, s69, 1
    s_add_u32 s78, s80, s81
    ds_read_b64_tr_b16 v[52:53], v5 offset:192
    ds_read_b64_tr_b16 v[54:55], v5 offset:2496
    s_waitcnt lgkmcnt(10)
    v_mfma_f32_16x16x32_bf16 v[100:103], v[32:35], v[176:179], 0
    v_mfma_f32_16x16x32_bf16 v[136:139], v[32:35], v[180:183], 0
    s_add_u32 s45, s50, 32768
    buffer_load_dwordx4 v[208:211], v3, s[16:19], s45 offen
    buffer_load_dwordx4 v[212:215], v3, s[16:19], s45 offen offset:1024
    ds_read_b64_tr_b16 v[56:57], v5 offset:224
    ds_read_b64_tr_b16 v[58:59], v5 offset:2528
    s_waitcnt lgkmcnt(10)
    v_mfma_f32_16x16x32_bf16 v[104:107], v[36:39], v[176:179], 0
    v_mfma_f32_16x16x32_bf16 v[140:143], v[36:39], v[180:183], 0
    ds_read_b64_tr_b16 v[60:61], v5 offset:256
    ds_read_b64_tr_b16 v[62:63], v5 offset:2560
    s_waitcnt lgkmcnt(10)
    v_mfma_f32_16x16x32_bf16 v[108:111], v[40:43], v[176:179], 0
    v_mfma_f32_16x16x32_bf16 v[144:147], v[40:43], v[180:183], 0
    ds_read_b64_tr_b16 v[28:29], v5 offset:18432
    ds_read_b64_tr_b16 v[30:31], v5 offset:20736
    s_waitcnt lgkmcnt(10)
    v_mfma_f32_16x16x32_bf16 v[112:115], v[44:47], v[176:179], 0
    v_mfma_f32_16x16x32_bf16 v[148:151], v[44:47], v[180:183], 0
    ds_read_b64_tr_b16 v[32:33], v5 offset:18464
    ds_read_b64_tr_b16 v[34:35], v5 offset:20768
    s_waitcnt lgkmcnt(10)
    v_mfma_f32_16x16x32_bf16 v[116:119], v[48:51], v[176:179], 0
    v_mfma_f32_16x16x32_bf16 v[152:155], v[48:51], v[180:183], 0
    s_add_u32 s45, s50, 40960
    buffer_load_dwordx4 v[216:219], v3, s[16:19], s45 offen
    buffer_load_dwordx4 v[220:223], v3, s[16:19], s45 offen offset:1024
    ds_read_b64_tr_b16 v[36:37], v5 offset:18496
    ds_read_b64_tr_b16 v[38:39], v5 offset:20800
    s_waitcnt lgkmcnt(10)
    v_mfma_f32_16x16x32_bf16 v[120:123], v[52:55], v[176:179], 0
    v_mfma_f32_16x16x32_bf16 v[156:159], v[52:55], v[180:183], 0
    ds_read_b64_tr_b16 v[40:41], v5 offset:18528
    ds_read_b64_tr_b16 v[42:43], v5 offset:20832
    s_waitcnt lgkmcnt(10)
    v_mfma_f32_16x16x32_bf16 v[124:127], v[56:59], v[176:179], 0
    v_mfma_f32_16x16x32_bf16 v[160:163], v[56:59], v[180:183], 0
    ds_read_b64_tr_b16 v[44:45], v5 offset:18560
    ds_read_b64_tr_b16 v[46:47], v5 offset:20864
    s_waitcnt lgkmcnt(10)
    v_mfma_f32_16x16x32_bf16 v[128:131], v[60:63], v[176:179], 0
    v_mfma_f32_16x16x32_bf16 v[164:167], v[60:63], v[180:183], 0
    s_waitcnt vmcnt(24)
    s_barrier
    ds_read_b64_tr_b16 v[48:49], v5 offset:18592
    ds_read_b64_tr_b16 v[50:51], v5 offset:20896
    s_waitcnt lgkmcnt(10)
    v_mfma_f32_16x16x32_bf16 v[96:99], v[28:31], v[184:187], v[96:99]
    v_mfma_f32_16x16x32_bf16 v[132:135], v[28:31], v[188:191], v[132:135]
    s_add_u32 m0, s53, s60
    s_add_u32 s44, s59, s54
    buffer_load_dwordx4 v20, s[20:23], s44 offen lds
    ds_read_b64_tr_b16 v[52:53], v5 offset:18624
    ds_read_b64_tr_b16 v[54:55], v5 offset:20928
    s_waitcnt lgkmcnt(10)
    v_mfma_f32_16x16x32_bf16 v[100:103], v[32:35], v[184:187], v[100:103]
    v_mfma_f32_16x16x32_bf16 v[136:139], v[32:35], v[188:191], v[136:139]
    ds_read_b64_tr_b16 v[56:57], v5 offset:18656
    ds_read_b64_tr_b16 v[58:59], v5 offset:20960
    s_waitcnt lgkmcnt(10)
    v_mfma_f32_16x16x32_bf16 v[104:107], v[36:39], v[184:187], v[104:107]
    v_mfma_f32_16x16x32_bf16 v[140:143], v[36:39], v[188:191], v[140:143]
    s_add_u32 m0, s53, s61
    s_add_u32 s44, s59, s55
    buffer_load_dwordx4 v21, s[20:23], s44 offen lds
    ds_read_b64_tr_b16 v[60:61], v5 offset:18688
    ds_read_b64_tr_b16 v[62:63], v5 offset:20992
    s_waitcnt lgkmcnt(10)
    v_mfma_f32_16x16x32_bf16 v[108:111], v[40:43], v[184:187], v[108:111]
    v_mfma_f32_16x16x32_bf16 v[144:147], v[40:43], v[188:191], v[144:147]
    ds_read_b64_tr_b16 v[28:29], v6 offset:0
    ds_read_b64_tr_b16 v[30:31], v6 offset:2304
    s_waitcnt lgkmcnt(10)
    v_mfma_f32_16x16x32_bf16 v[112:115], v[44:47], v[184:187], v[112:115]
    v_mfma_f32_16x16x32_bf16 v[148:151], v[44:47], v[188:191], v[148:151]
    s_add_u32 m0, s53, s62
    s_add_u32 s44, s59, s56
    buffer_load_dwordx4 v22, s[20:23], s44 offen lds
    ds_read_b64_tr_b16 v[32:33], v6 offset:32
    ds_read_b64_tr_b16 v[34:35], v6 offset:2336
    s_waitcnt lgkmcnt(10)
    v_mfma_f32_16x16x32_bf16 v[116:119], v[48:51], v[184:187], v[116:119]
    v_mfma_f32_16x16x32_bf16 v[152:155], v[48:51], v[188:191], v[152:155]
    ds_read_b64_tr_b16 v[36:37], v6 offset:64
    ds_read_b64_tr_b16 v[38:39], v6 offset:2368
    s_waitcnt lgkmcnt(10)
    v_mfma_f32_16x16x32_bf16 v[120:123], v[52:55], v[184:187], v[120:123]
    v_mfma_f32_16x16x32_bf16 v[156:159], v[52:55], v[188:191], v[156:159]
    s_add_u32 m0, s53, s63
    s_add_u32 s44, s59, s57
    buffer_load_dwordx4 v23, s[20:23], s44 offen lds
    ds_read_b64_tr_b16 v[40:41], v6 offset:96
    ds_read_b64_tr_b16 v[42:43], v6 offset:2400
    s_waitcnt lgkmcnt(10)
    v_mfma_f32_16x16x32_bf16 v[124:127], v[56:59], v[184:187], v[124:127]
    v_mfma_f32_16x16x32_bf16 v[160:163], v[56:59], v[188:191], v[160:163]
    ds_read_b64_tr_b16 v[44:45], v6 offset:128
    ds_read_b64_tr_b16 v[46:47], v6 offset:2432
    s_waitcnt lgkmcnt(10)
    v_mfma_f32_16x16x32_bf16 v[128:131], v[60:63], v[184:187], v[128:131]
    v_mfma_f32_16x16x32_bf16 v[164:167], v[60:63], v[188:191], v[164:167]
    s_cmp_ge_u32 s47, 4
    s_cbranch_scc1 L_no5_3
    s_add_u32 m0, s53, s64
    s_add_u32 s44, s59, s58
    buffer_load_dwordx4 v24, s[20:23], s44 offen lds
L_no5_3:
    s_add_u32 s59, s59, 147456
    s_add_u32 s53, s53, 36864
    s_cmp_eq_u32 s53, 147456
    s_cselect_b32 s53, 0, s53
    s_waitcnt vmcnt(26)
    ds_read_b64_tr_b16 v[48:49], v6 offset:160
    ds_read_b64_tr_b16 v[50:51], v6 offset:2464
    s_waitcnt lgkmcnt(10)
    v_mfma_f32_16x16x32_bf16 v[96:99], v[28:31], v[192:195], v[96:99]
    v_mfma_f32_16x16x32_bf16 v[132:135], v[28:31], v[196:199], v[132:135]
    ds_read_b64_tr_b16 v[52:53], v6 offset:192
    ds_read_b64_tr_b16 v[54:55], v6 offset:2496
    s_waitcnt lgkmcnt(10)
    v_mfma_f32_16x16x32_bf16 v[100:103], v[32:35], v[192:195], v[100:103]
    v_mfma_f32_16x16x32_bf16 v[136:139], v[32:35], v[196:199], v[136:139]
    s_add_u32 s45, s50, 49152
    buffer_load_dwordx4 v[176:179], v3, s[16:19], s45 offen
    buffer_load_dwordx4 v[180:183], v3, s[16:19], s45 offen offset:1024
    ds_read_b64_tr_b16 v[56:57], v6 offset:224
    ds_read_b64_tr_b16 v[58:59], v6 offset:2528
    s_waitcnt lgkmcnt(10)
    v_mfma_f32_16x16x32_bf16 v[104:107], v[36:39], v[192:195], v[104:107]
    v_mfma_f32_16x16x32_bf16 v[140:143], v[36:39], v[196:199], v[140:143]
    ds_read_b64_tr_b16 v[60:61], v6 offset:256
    ds_read_b64_tr_b16 v[62:63], v6 offset:2560
    s_waitcnt lgkmcnt(10)
    v_mfma_f32_16x16x32_bf16 v[108:111], v[40:43], v[192:195], v[108:111]
    v_mfma_f32_16x16x32_bf16 v[144:147], v[40:43], v[196:199], v[144:147]
    ds_read_b64_tr_b16 v[28:29], v6 offset:18432
    ds_read_b64_tr_b16 v[30:31], v6 offset:20736
    s_waitcnt lgkmcnt(10)
    v_mfma_f32_16x16x32_bf16 v[112:115], v[44:47], v[192:195], v[112:115]
    v_mfma_f32_16x16x32_bf16 v[148:151], v[44:47], v[196:199], v[148:151]
    ds_read_b64_tr_b16 v[32:33], v6 offset:18464
    ds_read_b64_tr_b16 v[34:35], v6 offset:20768
    s_waitcnt lgkmcnt(10)
    v_mfma_f32_16x16x32_bf16 v[116:119], v[48:51], v[192:195], v[116:119]
    v_mfma_f32_16x16x32_bf16 v[152:155], v[48:51], v[196:199], v[152:155]
    s_add_u32 s45, s50, 57344
    buffer_load_dwordx4 v[184:187], v3, s[16:19], s45 offen
    buffer_load_dwordx4 v[188:191], v3, s[16:19], s45 offen offset:1024
    ds_read_b64_tr_b16 v[36:37], v6 offset:18496
    ds_read_b64_tr_b16 v[38:39], v6 offset:20800
    s_waitcnt lgkmcnt(10)
    v_mfma_f32_16x16x32_bf16 v[120:123], v[52:55], v[192:195], v[120:123]
    v_mfma_f32_16x16x32_bf16 v[156:159], v[52:55], v[196:199], v[156:159]
    ds_read_b64_tr_b16 v[40:41], v6 offset:18528
    ds_read_b64_tr_b16 v[42:43], v6 offset:20832
    s_waitcnt lgkmcnt(10)
    v_mfma_f32_16x16x32_bf16 v[124:127], v[56:59], v[192:195], v[124:127]
    v_mfma_f32_16x16x32_bf16 v[160:163], v[56:59], v[196:199], v[160:163]
    ds_read_b64_tr_b16 v[44:45], v6 offset:18560
    ds_read_b64_tr_b16 v[46:47], v6 offset:20864
    s_waitcnt lgkmcnt(10)
    v_mfma_f32_16x16x32_bf16 v[128:131], v[60:63], v[192:195], v[128:131]
    v_mfma_f32_16x16x32_bf16 v[164:167], v[60:63], v[196:199], v[164:167]
    s_waitcnt vmcnt(24)
    s_barrier
    ds_read_b64_tr_b16 v[48:49], v6 offset:18592
    ds_read_b64_tr_b16 v[50:51], v6 offset:20896
    s_waitcnt lgkmcnt(10)
    v_mfma_f32_16x16x32_bf16 v[96:99], v[28:31], v[200:203], v[96:99]
    v_mfma_f32_16x16x32_bf16 v[132:135], v[28:31], v[204:207], v[132:135]
    s_add_u32 m0, s53, s60
    s_add_u32 s44, s59, s54
    buffer_load_dwordx4 v20, s[20:23], s44 offen lds
    ds_read_b64_tr_b16 v[52:53], v6 offset:18624
    ds_read_b64_tr_b16 v[54:55], v6 offset:20928
    s_waitcnt lgkmcnt(10)
    v_mfma_f32_16x16x32_bf16 v[100:103], v[32:35], v[200:203], v[100:103]
    v_mfma_f32_16x16x32_bf16 v[136:139], v[32:35], v[204:207], v[136:139]
    ds_read_b64_tr_b16 v[56:57], v6 offset:18656
    ds_read_b64_tr_b16 v[58:59], v6 offset:20960
    s_waitcnt lgkmcnt(10)
    v_mfma_f32_16x16x32_bf16 v[104:107], v[36:39], v[200:203], v[104:107]
    v_mfma_f32_16x16x32_bf16 v[140:143], v[36:39], v[204:207], v[140:143]
    s_add_u32 m0, s53, s61
    s_add_u32 s44, s59, s55
    buffer_load_dwordx4 v21, s[20:23], s44 offen lds
    ds_read_b64_tr_b16 v[60:61], v6 offset:18688
    ds_read_b64_tr_b16 v[62:63], v6 offset:20992
    s_waitcnt lgkmcnt(10)
    v_mfma_f32_16x16x32_bf16 v[108:111], v[40:43], v[200:203], v[108:111]
    v_mfma_f32_16x16x32_bf16 v[144:147], v[40:43], v[204:207], v[144:147]
    ds_read_b64_tr_b16 v[28:29], v7 offset:0
    ds_read_b64_tr_b16 v[30:31], v7 offset:2304
    s_waitcnt lgkmcnt(10)
    v_mfma_f32_16x16x32_bf16 v[112:115], v[44:47], v[200:203], v[112:115]
    v_mfma_f32_16x16x32_bf16 v[148:151], v[44:47], v[204:207], v[148:151]
    s_add_u32 m0, s53, s62
    s_add_u32 s44, s59, s56
    buffer_load_dwordx4 v22, s[20:23], s44 offen lds
    ds_read_b64_tr_b16 v[32:33], v7 offset:32
    ds_read_b64_tr_b16 v[34:35], v7 offset:2336
    s_waitcnt lgkmcnt(10)
    v_mfma_f32_16x16x32_bf16 v[116:119], v[48:51], v[200:203], v[116:119]
    v_mfma_f32_16x16x32_bf16 v[152:155], v[48:51], v[204:207], v[152:155]
    ds_read_b64_tr_b16 v[36:37], v7 offset:64
    ds_read_b64_tr_b16 v[38:39], v7 offset:2368
    s_waitcnt lgkmcnt(10)
    v_mfma_f32_16x16x32_bf16 v[120:123], v[52:55], v[200:203], v[120:123]
    v_mfma_f32_16x16x32_bf16 v[156:159], v[52:55], v[204:207], v[156:159]
    s_add_u32 m0, s53, s63
    s_add_u32 s44, s59, s57
    buffer_load_dwordx4 v23, s[20:23], s44 offen lds
    ds_read_b64_tr_b16 v[40:41], v7 offset:96
    ds_read_b64_tr_b16 v[42:43], v7 offset:2400
    s_waitcnt lgkmcnt(10)
    v_mfma_f32_16x16x32_bf16 v[124:127], v[56:59], v[200:203], v[124:127]
    v_mfma_f32_16x16x32_bf16 v[160:163], v[56:59], v[204:207], v[160:163]
    ds_read_b64_tr_b16 v[44:45], v7 offset:128
    ds_read_b64_tr_b16 v[46:47], v7 offset:2432
    s_waitcnt lgkmcnt(10)
    v_mfma_f32_16x16x32_bf16 v[128:131], v[60:63], v[200:203], v[128:131]
    v_mfma_f32_16x16x32_bf16 v[164:167], v[60:63], v[204:207], v[164:167]
    s_cmp_ge_u32 s47, 4
    s_cbranch_scc1 L_no5_4
    s_add_u32 m0, s53, s64
    s_add_u32 s44, s59, s58
    buffer_load_dwordx4 v24, s[20:23], s44 offen lds
L_no5_4:
    s_add_u32 s59, s59, 147456
    s_add_u32 s53, s53, 36864
    s_cmp_eq_u32 s53, 147456
    s_cselect_b32 s53, 0, s53
    s_waitcnt vmcnt(14)
    ds_read_b64_tr_b16 v[48:49], v7 offset:160
    ds_read_b64_tr_b16 v[50:51], v7 offset:2464
    s_waitcnt lgkmcnt(10)
    v_mfma_f32_16x16x32_bf16 v[96:99], v[28:31], v[208:211], v[96:99]
    v_mfma_f32_16x16x32_bf16 v[132:135], v[28:31], v[212:215], v[132:135]
    ds_read_b64_tr_b16 v[52:53], v7 offset:192
    ds_read_b64_tr_b16 v[54:55], v7 offset:2496
    s_waitcnt lgkmcnt(10)
    v_mfma_f32_16x16x32_bf16 v[100:103], v[32:35], v[208:211], v[100:103]
    v_mfma_f32_16x16x32_bf16 v[136:139], v[32:35], v[212:215], v[136:139]
    s_add_u32 s45, s50, 65536
    buffer_load_dwordx4 v[192:195], v3, s[16:19], s45 offen
    buffer_load_dwordx4 v[196:199], v3, s[16:19], s45 offen offset:1024
    ds_read_b64_tr_b16 v[56:57], v7 offset:224
    ds_read_b64_tr_b16 v[58:59], v7 offset:2528
    s_waitcnt lgkmcnt(10)
    v_mfma_f32_16x16x32_bf16 v[104:107], v[36:39], v[208:211], v[104:107]
    v_mfma_f32_16x16x32_bf16 v[140:143], v[36:39], v[212:215], v[140:143]
    ds_read_b64_tr_b16 v[60:61], v7 offset:256
    ds_read_b64_tr_b16 v[62:63], v7 offset:2560
    s_waitcnt lgkmcnt(10)
    v_mfma_f32_16x16x32_bf16 v[108:111], v[40:43], v[208:211], v[108:111]
    v_mfma_f32_16x16x32_bf16 v[144:147], v[40:43], v[212:215], v[144:147]
    ds_read_b64_tr_b16 v[28:29], v7 offset:18432
    ds_read_b64_tr_b16 v[30:31], v7 offset:20736
    s_waitcnt lgkmcnt(10)
    v_mfma_f32_16x16x32_bf16 v[112:115], v[44:47], v[208:211], v[112:115]
    v_mfma_f32_16x16x32_bf16 v[148:151], v[44:47], v[212:215], v[148:151]
    ds_read_b64_tr_b16 v[32:33], v7 offset:18464
    ds_read_b64_tr_b16 v[34:35], v7 offset:20768
    s_waitcnt lgkmcnt(10)
    v_mfma_f32_16x16x32_bf16 v[116:119], v[48:51], v[208:211], v[116:119]
    v_mfma_f32_16x16x32_bf16 v[152:155], v[48:51], v[212:215], v[152:155]
    s_add_u32 s45, s50, 73728
    buffer_load_dwordx4 v[200:203], v3, s[16:19], s45 offen
    buffer_load_dwordx4 v[204:207], v3, s[16:19], s45 offen offset:1024
    ds_read_b64_tr_b16 v[36:37], v7 offset:18496
    ds_read_b64_tr_b16 v[38:39], v7 offset:20800
    s_waitcnt lgkmcnt(10)
    v_mfma_f32_16x16x32_bf16 v[120:123], v[52:55], v[208:211], v[120:123]
    v_mfma_f32_16x16x32_bf16 v[156:159], v[52:55], v[212:215], v[156:159]
    ds_read_b64_tr_b16 v[40:41], v7 offset:18528
    ds_read_b64_tr_b16 v[42:43], v7 offset:20832
    s_waitcnt lgkmcnt(10)
    v_mfma_f32_16x16x32_bf16 v[124:127], v[56:59], v[208:211], v[124:127]
    v_mfma_f32_16x16x32_bf16 v[160:163], v[56:59], v[212:215], v[160:163]
    ds_read_b64_tr_b16 v[44:45], v7 offset:18560
    ds_read_b64_tr_b16 v[46:47], v7 offset:20864
    s_waitcnt lgkmcnt(10)
    v_mfma_f32_16x16x32_bf16 v[128:131], v[60:63], v[208:211], v[128:131]
    v_mfma_f32_16x16x32_bf16 v[164:167], v[60:63], v[212:215], v[164:167]
    s_waitcnt vmcnt(12)
    s_barrier
    ds_read_b64_tr_b16 v[48:49], v7 offset:18592
    ds_read_b64_tr_b16 v[50:51], v7 offset:20896
    s_waitcnt lgkmcnt(10)
    v_mfma_f32_16x16x32_bf16 v[96:99], v[28:31], v[216:219], v[96:99]
    v_mfma_f32_16x16x32_bf16 v[132:135], v[28:31], v[220:223], v[132:135]
    s_add_u32 m0, s53, s60
    s_add_u32 s44, s59, s54
    buffer_load_dwordx4 v20, s[20:23], s44 offen lds
    ds_read_b64_tr_b16 v[52:53], v7 offset:18624
    ds_read_b64_tr_b16 v[54:55], v7 offset:20928
    s_waitcnt lgkmcnt(10)
    v_mfma_f32_16x16x32_bf16 v[100:103], v[32:35], v[216:219], v[100:103]
    v_mfma_f32_16x16x32_bf16 v[136:139], v[32:35], v[220:223], v[136:139]
    ds_read_b64_tr_b16 v[56:57], v7 offset:18656
    ds_read_b64_tr_b16 v[58:59], v7 offset:20960
    s_waitcnt lgkmcnt(10)
    v_mfma_f32_16x16x32_bf16 v[104:107], v[36:39], v[216:219], v[104:107]
    v_mfma_f32_16x16x32_bf16 v[140:143], v[36:39], v[220:223], v[140:143]
    s_add_u32 m0, s53, s61
    s_add_u32 s44, s59, s55
    buffer_load_dwordx4 v21, s[20:23], s44 offen lds
    ds_read_b64_tr_b16 v[60:61], v7 offset:18688
    ds_read_b64_tr_b16 v[62:63], v7 offset:20992
    s_waitcnt lgkmcnt(10)
    v_mfma_f32_16x16x32_bf16 v[108:111], v[40:43], v[216:219], v[108:111]
    v_mfma_f32_16x16x32_bf16 v[144:147], v[40:43], v[220:223], v[144:147]
    ds_read_b64_tr_b16 v[28:29], v8 offset:0
    ds_read_b64_tr_b16 v[30:31], v8 offset:2304
    s_waitcnt lgkmcnt(10)
    v_mfma_f32_16x16x32_bf16 v[112:115], v[44:47], v[216:219], v[112:115]
    v_mfma_f32_16x16x32_bf16 v[148:151], v[44:47], v[220:223], v[148:151]
    s_add_u32 m0, s53, s62
    s_add_u32 s44, s59, s56
    buffer_load_dwordx4 v22, s[20:23], s44 offen lds
    ds_read_b64_tr_b16 v[32:33], v8 offset:32
    ds_read_b64_tr_b16 v[34:35], v8 offset:2336
    s_waitcnt lgkmcnt(10)
    v_mfma_f32_16x16x32_bf16 v[116:119], v[48:51], v[216:219], v[116:119]
    v_mfma_f32_16x16x32_bf16 v[152:155], v[48:51], v[220:223], v[152:155]
    ds_read_b64_tr_b16 v[36:37], v8 offset:64
    ds_read_b64_tr_b16 v[38:39], v8 offset:2368
    s_waitcnt lgkmcnt(10)
    v_mfma_f32_16x16x32_bf16 v[120:123], v[52:55], v[216:219], v[120:123]
    v_mfma_f32_16x16x32_bf16 v[156:159], v[52:55], v[220:223], v[156:159]
    s_add_u32 m0, s53, s63
    s_add_u32 s44, s59, s57
    buffer_load_dwordx4 v23, s[20:23], s44 offen lds
    ds_read_b64_tr_b16 v[40:41], v8 offset:96
    ds_read_b64_tr_b16 v[42:43], v8 offset:2400
    s_waitcnt lgkmcnt(10)
    v_mfma_f32_16x16x32_bf16 v[124:127], v[56:59], v[216:219], v[124:127]
    v_mfma_f32_16x16x32_bf16 v[160:163], v[56:59], v[220:223], v[160:163]
    ds_read_b64_tr_b16 v[44:45], v8 offset:128
    ds_read_b64_tr_b16 v[46:47], v8 offset:2432
    s_waitcnt lgkmcnt(10)
    v_mfma_f32_16x16x32_bf16 v[128:131], v[60:63], v[216:219], v[128:131]
    v_mfma_f32_16x16x32_bf16 v[164:167], v[60:63], v[220:223], v[164:167]
    s_cmp_ge_u32 s47, 4
    s_cbranch_scc1 L_no5_5
    s_add_u32 m0, s53, s64
    s_add_u32 s44, s59, s58
    buffer_load_dwordx4 v24, s[20:23], s44 offen lds
L_no5_5:
    s_add_u32 s59, s59, 147456
    s_add_u32 s53, s53, 36864
    s_cmp_eq_u32 s53, 147456
    s_cselect_b32 s53, 0, s53
    s_waitcnt vmcnt(14)
    ds_read_b64_tr_b16 v[48:49], v8 offset:160
    ds_read_b64_tr_b16 v[50:51], v8 offset:2464
    s_waitcnt lgkmcnt(10)
    v_mfma_f32_16x16x32_bf16 v[96:99], v[28:31], v[176:179], v[96:99]
    v_mfma_f32_16x16x32_bf16 v[132:135], v[28:31], v[180:183], v[132:135]
    ds_read_b64_tr_b16 v[52:53], v8 offset:192
    ds_read_b64_tr_b16 v[54:55], v8 offset:2496
    s_waitcnt lgkmcnt(10)
    v_mfma_f32_16x16x32_bf16 v[100:103], v[32:35], v[176:179], v[100:103]
    v_mfma_f32_16x16x32_bf16 v[136:139], v[32:35], v[180:183], v[136:139]
    s_add_u32 s45, s50, 81920
    buffer_load_dwordx4 v[208:211], v3, s[16:19], s45 offen
    buffer_load_dwordx4 v[212:215], v3, s[16:19], s45 offen offset:1024
    ds_read_b64_tr_b16 v[56:57], v8 offset:224
    ds_read_b64_tr_b16 v[58:59], v8 offset:2528
    s_waitcnt lgkmcnt(10)
    v_mfma_f32_16x16x32_bf16 v[104:107], v[36:39], v[176:179], v[104:107]
    v_mfma_f32_16x16x32_bf16 v[140:143], v[36:39], v[180:183], v[140:143]
    ds_read_b64_tr_b16 v[60:61], v8 offset:256
    ds_read_b64_tr_b16 v[62:63], v8 offset:2560
    s_waitcnt lgkmcnt(10)
    v_mfma_f32_16x16x32_bf16 v[108:111], v[40:43], v[176:179], v[108:111]
    v_mfma_f32_16x16x32_bf16 v[144:147], v[40:43], v[180:183], v[144:147]
    ds_read_b64_tr_b16 v[28:29], v8 offset:18432
    ds_read_b64_tr_b16 v[30:31], v8 offset:20736
    s_waitcnt lgkmcnt(10)
    v_mfma_f32_16x16x32_bf16 v[112:115], v[44:47], v[176:179], v[112:115]
    v_mfma_f32_16x16x32_bf16 v[148:151], v[44:47], v[180:183], v[148:151]
    ds_read_b64_tr_b16 v[32:33], v8 offset:18464
    ds_read_b64_tr_b16 v[34:35], v8 offset:20768
    s_waitcnt lgkmcnt(10)
    v_mfma_f32_16x16x32_bf16 v[116:119], v[48:51], v[176:179], v[116:119]
    v_mfma_f32_16x16x32_bf16 v[152:155], v[48:51], v[180:183], v[152:155]
    s_add_u32 s45, s50, 90112
    buffer_load_dwordx4 v[216:219], v3, s[16:19], s45 offen
    buffer_load_dwordx4 v[220:223], v3, s[16:19], s45 offen offset:1024
    ds_read_b64_tr_b16 v[36:37], v8 offset:18496
    ds_read_b64_tr_b16 v[38:39], v8 offset:20800
    s_waitcnt lgkmcnt(10)
    v_mfma_f32_16x16x32_bf16 v[120:123], v[52:55], v[176:179], v[120:123]
    v_mfma_f32_16x16x32_bf16 v[156:159], v[52:55], v[180:183], v[156:159]
    ds_read_b64_tr_b16 v[40:41], v8 offset:18528
    ds_read_b64_tr_b16 v[42:43], v8 offset:20832
    s_waitcnt lgkmcnt(10)
    v_mfma_f32_16x16x32_bf16 v[124:127], v[56:59], v[176:179], v[124:127]
    v_mfma_f32_16x16x32_bf16 v[160:163], v[56:59], v[180:183], v[160:163]
    ds_read_b64_tr_b16 v[44:45], v8 offset:18560
    ds_read_b64_tr_b16 v[46:47], v8 offset:20864
    s_waitcnt lgkmcnt(10)
    v_mfma_f32_16x16x32_bf16 v[128:131], v[60:63], v[176:179], v[128:131]
    v_mfma_f32_16x16x32_bf16 v[164:167], v[60:63], v[180:183], v[164:167]
    s_waitcnt vmcnt(12)
    s_barrier
    ds_read_b64_tr_b16 v[48:49], v8 offset:18592
    ds_read_b64_tr_b16 v[50:51], v8 offset:20896
    s_waitcnt lgkmcnt(10)
    v_mfma_f32_16x16x32_bf16 v[96:99], v[28:31], v[184:187], v[96:99]
    v_mfma_f32_16x16x32_bf16 v[132:135], v[28:31], v[188:191], v[132:135]
    s_add_u32 m0, s53, s60
    s_add_u32 s44, s59, s54
    buffer_load_dwordx4 v20, s[20:23], s44 offen lds
    ds_read_b64_tr_b16 v[52:53], v8 offset:18624
    ds_read_b64_tr_b16 v[54:55], v8 offset:20928
    s_waitcnt lgkmcnt(10)
    v_mfma_f32_16x16x32_bf16 v[100:103], v[32:35], v[184:187], v[100:103]
    v_mfma_f32_16x16x32_bf16 v[136:139], v[32:35], v[188:191], v[136:139]
    ds_read_b64_tr_b16 v[56:57], v8 offset:18656
    ds_read_b64_tr_b16 v[58:59], v8 offset:20960
    s_waitcnt lgkmcnt(10)
    v_mfma_f32_16x16x32_bf16 v[104:107], v[36:39], v[184:187], v[104:107]
    v_mfma_f32_16x16x32_bf16 v[140:143], v[36:39], v[188:191], v[140:143]
    s_add_u32 m0, s53, s61
    s_add_u32 s44, s59, s55
    buffer_load_dwordx4 v21, s[20:23], s44 offen lds
    ds_read_b64_tr_b16 v[60:61], v8 offset:18688
    ds_read_b64_tr_b16 v[62:63], v8 offset:20992
    s_waitcnt lgkmcnt(10)
    v_mfma_f32_16x16x32_bf16 v[108:111], v[40:43], v[184:187], v[108:111]
    v_mfma_f32_16x16x32_bf16 v[144:147], v[40:43], v[188:191], v[144:147]
    ds_read_b64_tr_b16 v[28:29], v5 offset:0
    ds_read_b64_tr_b16 v[30:31], v5 offset:2304
    s_waitcnt lgkmcnt(10)
    v_mfma_f32_16x16x32_bf16 v[112:115], v[44:47], v[184:187], v[112:115]
    v_mfma_f32_16x16x32_bf16 v[148:151], v[44:47], v[188:191], v[148:151]
    s_add_u32 m0, s53, s62
    s_add_u32 s44, s59, s56
    buffer_load_dwordx4 v22, s[20:23], s44 offen lds
    ds_read_b64_tr_b16 v[32:33], v5 offset:32
    ds_read_b64_tr_b16 v[34:35], v5 offset:2336
    s_waitcnt lgkmcnt(10)
    v_mfma_f32_16x16x32_bf16 v[116:119], v[48:51], v[184:187], v[116:119]
    v_mfma_f32_16x16x32_bf16 v[152:155], v[48:51], v[188:191], v[152:155]
    ds_read_b64_tr_b16 v[36:37], v5 offset:64
    ds_read_b64_tr_b16 v[38:39], v5 offset:2368
    s_waitcnt lgkmcnt(10)
    v_mfma_f32_16x16x32_bf16 v[120:123], v[52:55], v[184:187], v[120:123]
    v_mfma_f32_16x16x32_bf16 v[156:159], v[52:55], v[188:191], v[156:159]
    s_add_u32 m0, s53, s63
    s_add_u32 s44, s59, s57
    buffer_load_dwordx4 v23, s[20:23], s44 offen lds
    ds_read_b64_tr_b16 v[40:41], v5 offset:96
    ds_read_b64_tr_b16 v[42:43], v5 offset:2400
    s_waitcnt lgkmcnt(10)
    v_mfma_f32_16x16x32_bf16 v[124:127], v[56:59], v[184:187], v[124:127]
    v_mfma_f32_16x16x32_bf16 v[160:163], v[56:59], v[188:191], v[160:163]
    ds_read_b64_tr_b16 v[44:45], v5 offset:128
    ds_read_b64_tr_b16 v[46:47], v5 offset:2432
    s_waitcnt lgkmcnt(10)
    v_mfma_f32_16x16x32_bf16 v[128:131], v[60:63], v[184:187], v[128:131]
    v_mfma_f32_16x16x32_bf16 v[164:167], v[60:63], v[188:191], v[164:167]
    s_cmp_ge_u32 s47, 4
    s_cbranch_scc1 L_no5_6
    s_add_u32 m0, s53, s64
    s_add_u32 s44, s59, s58
    buffer_load_dwordx4 v24, s[20:23], s44 offen lds
L_no5_6:
    s_add_u32 s59, s59, 147456
    s_add_u32 s53, s53, 36864
    s_cmp_eq_u32 s53, 147456
    s_cselect_b32 s53, 0, s53
    s_waitcnt vmcnt(14)
    ds_read_b64_tr_b16 v[48:49], v5 offset:160
    ds_read_b64_tr_b16 v[50:51], v5 offset:2464
    s_waitcnt lgkmcnt(10)
    v_mfma_f32_16x16x32_bf16 v[96:99], v[28:31], v[192:195], v[96:99]
    v_mfma_f32_16x16x32_bf16 v[132:135], v[28:31], v[196:199], v[132:135]
    ds_read_b64_tr_b16 v[52:53], v5 offset:192
    ds_read_b64_tr_b16 v[54:55], v5 offset:2496
    s_waitcnt lgkmcnt(10)
    v_mfma_f32_16x16x32_bf16 v[100:103], v[32:35], v[192:195], v[100:103]
    v_mfma_f32_16x16x32_bf16 v[136:139], v[32:35], v[196:199], v[136:139]
    s_add_u32 s45, s50, 98304
    buffer_load_dwordx4 v[176:179], v3, s[16:19], s45 offen
    buffer_load_dwordx4 v[180:183], v3, s[16:19], s45 offen offset:1024
    ds_read_b64_tr_b16 v[56:57], v5 offset:224
    ds_read_b64_tr_b16 v[58:59], v5 offset:2528
    s_waitcnt lgkmcnt(10)
    v_mfma_f32_16x16x32_bf16 v[104:107], v[36:39], v[192:195], v[104:107]
    v_mfma_f32_16x16x32_bf16 v[140:143], v[36:39], v[196:199], v[140:143]
    ds_read_b64_tr_b16 v[60:61], v5 offset:256
    ds_read_b64_tr_b16 v[62:63], v5 offset:2560
    s_waitcnt lgkmcnt(10)
    v_mfma_f32_16x16x32_bf16 v[108:111], v[40:43], v[192:195], v[108:111]
    v_mfma_f32_16x16x32_bf16 v[144:147], v[40:43], v[196:199], v[144:147]
    ds_read_b64_tr_b16 v[28:29], v5 offset:18432
    ds_read_b64_tr_b16 v[30:31], v5 offset:20736
    s_waitcnt lgkmcnt(10)
    v_mfma_f32_16x16x32_bf16 v[112:115], v[44:47], v[192:195], v[112:115]
    v_mfma_f32_16x16x32_bf16 v[148:151], v[44:47], v[196:199], v[148:151]
    ds_read_b64_tr_b16 v[32:33], v5 offset:18464
    ds_read_b64_tr_b16 v[34:35], v5 offset:20768
    s_waitcnt lgkmcnt(10)
    v_mfma_f32_16x16x32_bf16 v[116:119], v[48:51], v[192:195], v[116:119]
    v_mfma_f32_16x16x32_bf16 v[152:155], v[48:51], v[196:199], v[152:155]
    s_add_u32 s45, s50, 106496
    buffer_load_dwordx4 v[184:187], v3, s[16:19], s45 offen
    buffer_load_dwordx4 v[188:191], v3, s[16:19], s45 offen offset:1024
    ds_read_b64_tr_b16 v[36:37], v5 offset:18496
    ds_read_b64_tr_b16 v[38:39], v5 offset:20800
    s_waitcnt lgkmcnt(10)
    v_mfma_f32_16x16x32_bf16 v[120:123], v[52:55], v[192:195], v[120:123]
    v_mfma_f32_16x16x32_bf16 v[156:159], v[52:55], v[196:199], v[156:159]
    ds_read_b64_tr_b16 v[40:41], v5 offset:18528
    ds_read_b64_tr_b16 v[42:43], v5 offset:20832
    s_waitcnt lgkmcnt(10)
    v_mfma_f32_16x16x32_bf16 v[124:127], v[56:59], v[192:195], v[124:127]
    v_mfma_f32_16x16x32_bf16 v[160:163], v[56:59], v[196:199], v[160:163]
    ds_read_b64_tr_b16 v[44:45], v5 offset:18560
    ds_read_b64_tr_b16 v[46:47], v5 offset:20864
    s_waitcnt lgkmcnt(10)
    v_mfma_f32_16x16x32_bf16 v[128:131], v[60:63], v[192:195], v[128:131]
    v_mfma_f32_16x16x32_bf16 v[164:167], v[60:63], v[196:199], v[164:167]
    s_waitcnt vmcnt(12)
    s_barrier
    ds_read_b64_tr_b16 v[48:49], v5 offset:18592
    ds_read_b64_tr_b16 v[50:51], v5 offset:20896
    s_waitcnt lgkmcnt(10)
    v_mfma_f32_16x16x32_bf16 v[96:99], v[28:31], v[200:203], v[96:99]
    v_mfma_f32_16x16x32_bf16 v[132:135], v[28:31], v[204:207], v[132:135]
    s_add_u32 m0, s53, s60
    s_add_u32 s44, s59, s54
    buffer_load_dwordx4 v20, s[20:23], s44 offen lds
    ds_read_b64_tr_b16 v[52:53], v5 offset:18624
    ds_read_b64_tr_b16 v[54:55], v5 offset:20928
    s_waitcnt lgkmcnt(10)
    v_mfma_f32_16x16x32_bf16 v[100:103], v[32:35], v[200:203], v[100:103]
    v_mfma_f32_16x16x32_bf16 v[136:139], v[32:35], v[204:207], v[136:139]
    ds_read_b64_tr_b16 v[56:57], v5 offset:18656
    ds_read_b64_tr_b16 v[58:59], v5 offset:20960
    s_waitcnt lgkmcnt(10)
    v_mfma_f32_16x16x32_bf16 v[104:107], v[36:39], v[200:203], v[104:107]
    v_mfma_f32_16x16x32_bf16 v[140:143], v[36:39], v[204:207], v[140:143]
    s_add_u32 m0, s53, s61
    s_add_u32 s44, s59, s55
    buffer_load_dwordx4 v21, s[20:23], s44 offen lds
    ds_read_b64_tr_b16 v[60:61], v5 offset:18688
    ds_read_b64_tr_b16 v[62:63], v5 offset:20992
    s_waitcnt lgkmcnt(10)
    v_mfma_f32_16x16x32_bf16 v[108:111], v[40:43], v[200:203], v[108:111]
    v_mfma_f32_16x16x32_bf16 v[144:147], v[40:43], v[204:207], v[144:147]
    ds_read_b64_tr_b16 v[28:29], v6 offset:0
    ds_read_b64_tr_b16 v[30:31], v6 offset:2304
    s_waitcnt lgkmcnt(10)
    v_mfma_f32_16x16x32_bf16 v[112:115], v[44:47], v[200:203], v[112:115]
    v_mfma_f32_16x16x32_bf16 v[148:151], v[44:47], v[204:207], v[148:151]
    s_add_u32 m0, s53, s62
    s_add_u32 s44, s59, s56
    buffer_load_dwordx4 v22, s[20:23], s44 offen lds
    ds_read_b64_tr_b16 v[32:33], v6 offset:32
    ds_read_b64_tr_b16 v[34:35], v6 offset:2336
    s_waitcnt lgkmcnt(10)
    v_mfma_f32_16x16x32_bf16 v[116:119], v[48:51], v[200:203], v[116:119]
    v_mfma_f32_16x16x32_bf16 v[152:155], v[48:51], v[204:207], v[152:155]
    ds_read_b64_tr_b16 v[36:37], v6 offset:64
    ds_read_b64_tr_b16 v[38:39], v6 offset:2368
    s_waitcnt lgkmcnt(10)
    v_mfma_f32_16x16x32_bf16 v[120:123], v[52:55], v[200:203], v[120:123]
    v_mfma_f32_16x16x32_bf16 v[156:159], v[52:55], v[204:207], v[156:159]
    s_add_u32 m0, s53, s63
    s_add_u32 s44, s59, s57
    buffer_load_dwordx4 v23, s[20:23], s44 offen lds
    ds_read_b64_tr_b16 v[40:41], v6 offset:96
    ds_read_b64_tr_b16 v[42:43], v6 offset:2400
    s_waitcnt lgkmcnt(10)
    v_mfma_f32_16x16x32_bf16 v[124:127], v[56:59], v[200:203], v[124:127]
    v_mfma_f32_16x16x32_bf16 v[160:163], v[56:59], v[204:207], v[160:163]
    ds_read_b64_tr_b16 v[44:45], v6 offset:128
    ds_read_b64_tr_b16 v[46:47], v6 offset:2432
    s_waitcnt lgkmcnt(10)
    v_mfma_f32_16x16x32_bf16 v[128:131], v[60:63], v[200:203], v[128:131]
    v_mfma_f32_16x16x32_bf16 v[164:167], v[60:63], v[204:207], v[164:167]
    s_cmp_ge_u32 s47, 4
    s_cbranch_scc1 L_no5_7
    s_add_u32 m0, s53, s64
    s_add_u32 s44, s59, s58
    buffer_load_dwordx4 v24, s[20:23], s44 offen lds
L_no5_7:
    s_add_u32 s59, s59, 147456
    s_add_u32 s53, s53, 36864
    s_cmp_eq_u32 s53, 147456
    s_cselect_b32 s53, 0, s53
    s_waitcnt vmcnt(14)
    ds_read_b64_tr_b16 v[48:49], v6 offset:160
    ds_read_b64_tr_b16 v[50:51], v6 offset:2464
    s_waitcnt lgkmcnt(10)
    v_mfma_f32_16x16x32_bf16 v[96:99], v[28:31], v[208:211], v[96:99]
    v_mfma_f32_16x16x32_bf16 v[132:135], v[28:31], v[212:215], v[132:135]
    ds_read_b64_tr_b16 v[52:53], v6 offset:192
    ds_read_b64_tr_b16 v[54:55], v6 offset:2496
    s_waitcnt lgkmcnt(10)
    v_mfma_f32_16x16x32_bf16 v[100:103], v[32:35], v[208:211], v[100:103]
    v_mfma_f32_16x16x32_bf16 v[136:139], v[32:35], v[212:215], v[136:139]
    s_add_u32 s45, s50, 114688
    buffer_load_dwordx4 v[192:195], v3, s[16:19], s45 offen
    buffer_load_dwordx4 v[196:199], v3, s[16:19], s45 offen offset:1024
    ds_read_b64_tr_b16 v[56:57], v6 offset:224
    ds_read_b64_tr_b16 v[58:59], v6 offset:2528
    s_waitcnt lgkmcnt(10)
    v_mfma_f32_16x16x32_bf16 v[104:107], v[36:39], v[208:211], v[104:107]
    v_mfma_f32_16x16x32_bf16 v[140:143], v[36:39], v[212:215], v[140:143]
    ds_read_b64_tr_b16 v[60:61], v6 offset:256
    ds_read_b64_tr_b16 v[62:63], v6 offset:2560
    s_waitcnt lgkmcnt(10)
    v_mfma_f32_16x16x32_bf16 v[108:111], v[40:43], v[208:211], v[108:111]
    v_mfma_f32_16x16x32_bf16 v[144:147], v[40:43], v[212:215], v[144:147]
    ds_read_b64_tr_b16 v[28:29], v6 offset:18432
    ds_read_b64_tr_b16 v[30:31], v6 offset:20736
    s_waitcnt lgkmcnt(10)
    v_mfma_f32_16x16x32_bf16 v[112:115], v[44:47], v[208:211], v[112:115]
    v_mfma_f32_16x16x32_bf16 v[148:151], v[44:47], v[212:215], v[148:151]
    ds_read_b64_tr_b16 v[32:33], v6 offset:18464
    ds_read_b64_tr_b16 v[34:35], v6 offset:20768
    s_waitcnt lgkmcnt(10)
    v_mfma_f32_16x16x32_bf16 v[116:119], v[48:51], v[208:211], v[116:119]
    v_mfma_f32_16x16x32_bf16 v[152:155], v[48:51], v[212:215], v[152:155]
    s_add_u32 s45, s50, 122880
    buffer_load_dwordx4 v[200:203], v3, s[16:19], s45 offen
    buffer_load_dwordx4 v[204:207], v3, s[16:19], s45 offen offset:1024
    ds_read_b64_tr_b16 v[36:37], v6 offset:18496
    ds_read_b64_tr_b16 v[38:39], v6 offset:20800
    s_waitcnt lgkmcnt(10)
    v_mfma_f32_16x16x32_bf16 v[120:123], v[52:55], v[208:211], v[120:123]
    v_mfma_f32_16x16x32_bf16 v[156:159], v[52:55], v[212:215], v[156:159]
    ds_read_b64_tr_b16 v[40:41], v6 offset:18528
    ds_read_b64_tr_b16 v[42:43], v6 offset:20832
    s_waitcnt lgkmcnt(10)
    v_mfma_f32_16x16x32_bf16 v[124:127], v[56:59], v[208:211], v[124:127]
    v_mfma_f32_16x16x32_bf16 v[160:163], v[56:59], v[212:215], v[160:163]
    ds_read_b64_tr_b16 v[44:45], v6 offset:18560
    ds_read_b64_tr_b16 v[46:47], v6 offset:20864
    s_waitcnt lgkmcnt(10)
    v_mfma_f32_16x16x32_bf16 v[128:131], v[60:63], v[208:211], v[128:131]
    v_mfma_f32_16x16x32_bf16 v[164:167], v[60:63], v[212:215], v[164:167]
    s_waitcnt vmcnt(12)
    s_barrier
    ds_read_b64_tr_b16 v[48:49], v6 offset:18592
    ds_read_b64_tr_b16 v[50:51], v6 offset:20896
    s_waitcnt lgkmcnt(10)
    v_mfma_f32_16x16x32_bf16 v[96:99], v[28:31], v[216:219], v[96:99]
    v_mfma_f32_16x16x32_bf16 v[132:135], v[28:31], v[220:223], v[132:135]
    s_add_u32 m0, s53, s60
    s_add_u32 s44, s59, s54
    buffer_load_dwordx4 v20, s[20:23], s44 offen lds
    ds_read_b64_tr_b16 v[52:53], v6 offset:18624
    ds_read_b64_tr_b16 v[54:55], v6 offset:20928
    s_waitcnt lgkmcnt(10)
    v_mfma_f32_16x16x32_bf16 v[100:103], v[32:35], v[216:219], v[100:103]
    v_mfma_f32_16x16x32_bf16 v[136:139], v[32:35], v[220:223], v[136:139]
    ds_read_b64_tr_b16 v[56:57], v6 offset:18656
    ds_read_b64_tr_b16 v[58:59], v6 offset:20960
    s_waitcnt lgkmcnt(10)
    v_mfma_f32_16x16x32_bf16 v[104:107], v[36:39], v[216:219], v[104:107]
    v_mfma_f32_16x16x32_bf16 v[140:143], v[36:39], v[220:223], v[140:143]
    s_add_u32 m0, s53, s61
    s_add_u32 s44, s59, s55
    buffer_load_dwordx4 v21, s[20:23], s44 offen lds
    ds_read_b64_tr_b16 v[60:61], v6 offset:18688
    ds_read_b64_tr_b16 v[62:63], v6 offset:20992
    s_waitcnt lgkmcnt(10)
    v_mfma_f32_16x16x32_bf16 v[108:111], v[40:43], v[216:219], v[108:111]
    v_mfma_f32_16x16x32_bf16 v[144:147], v[40:43], v[220:223], v[144:147]
    ds_read_b64_tr_b16 v[28:29], v7 offset:0
    ds_read_b64_tr_b16 v[30:31], v7 offset:2304
    s_waitcnt lgkmcnt(10)
    v_mfma_f32_16x16x32_bf16 v[112:115], v[44:47], v[216:219], v[112:115]
    v_mfma_f32_16x16x32_bf16 v[148:151], v[44:47], v[220:223], v[148:151]
    s_add_u32 m0, s53, s62
    s_add_u32 s44, s59, s56
    buffer_load_dwordx4 v22, s[20:23], s44 offen lds
    ds_read_b64_tr_b16 v[32:33], v7 offset:32
    ds_read_b64_tr_b16 v[34:35], v7 offset:2336
    s_waitcnt lgkmcnt(10)
    v_mfma_f32_16x16x32_bf16 v[116:119], v[48:51], v[216:219], v[116:119]
    v_mfma_f32_16x16x32_bf16 v[152:155], v[48:51], v[220:223], v[152:155]
    ds_read_b64_tr_b16 v[36:37], v7 offset:64
    ds_read_b64_tr_b16 v[38:39], v7 offset:2368
    s_waitcnt lgkmcnt(10)
    v_mfma_f32_16x16x32_bf16 v[120:123], v[52:55], v[216:219], v[120:123]
    v_mfma_f32_16x16x32_bf16 v[156:159], v[52:55], v[220:223], v[156:159]
    s_add_u32 m0, s53, s63
    s_add_u32 s44, s59, s57
    buffer_load_dwordx4 v23, s[20:23], s44 offen lds
    ds_read_b64_tr_b16 v[40:41], v7 offset:96
    ds_read_b64_tr_b16 v[42:43], v7 offset:2400
    s_waitcnt lgkmcnt(10)
    v_mfma_f32_16x16x32_bf16 v[124:127], v[56:59], v[216:219], v[124:127]
    v_mfma_f32_16x16x32_bf16 v[160:163], v[56:59], v[220:223], v[160:163]
    ds_read_b64_tr_b16 v[44:45], v7 offset:128
    ds_read_b64_tr_b16 v[46:47], v7 offset:2432
    s_waitcnt lgkmcnt(10)
    v_mfma_f32_16x16x32_bf16 v[128:131], v[60:63], v[216:219], v[128:131]
    v_mfma_f32_16x16x32_bf16 v[164:167], v[60:63], v[220:223], v[164:167]
    s_cmp_ge_u32 s47, 4
    s_cbranch_scc1 L_no5_8
    s_add_u32 m0, s53, s64
    s_add_u32 s44, s59, s58
    buffer_load_dwordx4 v24, s[20:23], s44 offen lds
L_no5_8:
    s_add_u32 s59, s59, 147456
    s_add_u32 s53, s53, 36864
    s_cmp_eq_u32 s53, 147456
    s_cselect_b32 s53, 0, s53
    s_waitcnt vmcnt(14)
    ds_read_b64_tr_b16 v[48:49], v7 offset:160
    ds_read_b64_tr_b16 v[50:51], v7 offset:2464
    s_waitcnt lgkmcnt(10)
    v_mfma_f32_16x16x32_bf16 v[96:99], v[28:31], v[176:179], v[96:99]
    v_mfma_f32_16x16x32_bf16 v[132:135], v[28:31], v[180:183], v[132:135]
    ds_read_b64_tr_b16 v[52:53], v7 offset:192
    ds_read_b64_tr_b16 v[54:55], v7 offset:2496
    s_waitcnt lgkmcnt(10)
    v_mfma_f32_16x16x32_bf16 v[100:103], v[32:35], v[176:179], v[100:103]
    v_mfma_f32_16x16x32_bf16 v[136:139], v[32:35], v[180:183], v[136:139]
    s_add_u32 s45, s50, 131072
    buffer_load_dwordx4 v[208:211], v3, s[16:19], s45 offen
    buffer_load_dwordx4 v[212:215], v3, s[16:19], s45 offen offset:1024
    ds_read_b64_tr_b16 v[56:57], v7 offset:224
    ds_read_b64_tr_b16 v[58:59], v7 offset:2528
    s_waitcnt lgkmcnt(10)
    v_mfma_f32_16x16x32_bf16 v[104:107], v[36:39], v[176:179], v[104:107]
    v_mfma_f32_16x16x32_bf16 v[140:143], v[36:39], v[180:183], v[140:143]
    ds_read_b64_tr_b16 v[60:61], v7 offset:256
    ds_read_b64_tr_b16 v[62:63], v7 offset:2560
    s_waitcnt lgkmcnt(10)
    v_mfma_f32_16x16x32_bf16 v[108:111], v[40:43], v[176:179], v[108:111]
    v_mfma_f32_16x16x32_bf16 v[144:147], v[40:43], v[180:183], v[144:147]
    ds_read_b64_tr_b16 v[28:29], v7 offset:18432
    ds_read_b64_tr_b16 v[30:31], v7 offset:20736
    s_waitcnt lgkmcnt(10)
    v_mfma_f32_16x16x32_bf16 v[112:115], v[44:47], v[176:179], v[112:115]
    v_mfma_f32_16x16x32_bf16 v[148:151], v[44:47], v[180:183], v[148:151]
    ds_read_b64_tr_b16 v[32:33], v7 offset:18464
    ds_read_b64_tr_b16 v[34:35], v7 offset:20768
    s_waitcnt lgkmcnt(10)
    v_mfma_f32_16x16x32_bf16 v[116:119], v[48:51], v[176:179], v[116:119]
    v_mfma_f32_16x16x32_bf16 v[152:155], v[48:51], v[180:183], v[152:155]
    s_add_u32 s45, s50, 139264
    buffer_load_dwordx4 v[216:219], v3, s[16:19], s45 offen
    buffer_load_dwordx4 v[220:223], v3, s[16:19], s45 offen offset:1024
    ds_read_b64_tr_b16 v[36:37], v7 offset:18496
    ds_read_b64_tr_b16 v[38:39], v7 offset:20800
    s_waitcnt lgkmcnt(10)
    v_mfma_f32_16x16x32_bf16 v[120:123], v[52:55], v[176:179], v[120:123]
    v_mfma_f32_16x16x32_bf16 v[156:159], v[52:55], v[180:183], v[156:159]
    ds_read_b64_tr_b16 v[40:41], v7 offset:18528
    ds_read_b64_tr_b16 v[42:43], v7 offset:20832
    s_waitcnt lgkmcnt(10)
    v_mfma_f32_16x16x32_bf16 v[124:127], v[56:59], v[176:179], v[124:127]
    v_mfma_f32_16x16x32_bf16 v[160:163], v[56:59], v[180:183], v[160:163]
    ds_read_b64_tr_b16 v[44:45], v7 offset:18560
    ds_read_b64_tr_b16 v[46:47], v7 offset:20864
    s_waitcnt lgkmcnt(10)
    v_mfma_f32_16x16x32_bf16 v[128:131], v[60:63], v[176:179], v[128:131]
    v_mfma_f32_16x16x32_bf16 v[164:167], v[60:63], v[180:183], v[164:167]
    s_waitcnt vmcnt(12)
    s_barrier
    ds_read_b64_tr_b16 v[48:49], v7 offset:18592
    ds_read_b64_tr_b16 v[50:51], v7 offset:20896
    s_waitcnt lgkmcnt(10)
    v_mfma_f32_16x16x32_bf16 v[96:99], v[28:31], v[184:187], v[96:99]
    v_mfma_f32_16x16x32_bf16 v[132:135], v[28:31], v[188:191], v[132:135]
    ds_read_b64_tr_b16 v[52:53], v7 offset:18624
    ds_read_b64_tr_b16 v[54:55], v7 offset:20928
    s_waitcnt lgkmcnt(10)
    v_mfma_f32_16x16x32_bf16 v[100:103], v[32:35], v[184:187], v[100:103]
    v_mfma_f32_16x16x32_bf16 v[136:139], v[32:35], v[188:191], v[136:139]
    ds_read_b64_tr_b16 v[56:57], v7 offset:18656
    ds_read_b64_tr_b16 v[58:59], v7 offset:20960
    s_waitcnt lgkmcnt(10)
    v_mfma_f32_16x16x32_bf16 v[104:107], v[36:39], v[184:187], v[104:107]
    v_mfma_f32_16x16x32_bf16 v[140:143], v[36:39], v[188:191], v[140:143]
    ds_read_b64_tr_b16 v[60:61], v7 offset:18688
    ds_read_b64_tr_b16 v[62:63], v7 offset:20992
    s_waitcnt lgkmcnt(10)
    v_mfma_f32_16x16x32_bf16 v[108:111], v[40:43], v[184:187], v[108:111]
    v_mfma_f32_16x16x32_bf16 v[144:147], v[40:43], v[188:191], v[144:147]
    ds_read_b64_tr_b16 v[28:29], v8 offset:0
    ds_read_b64_tr_b16 v[30:31], v8 offset:2304
    s_waitcnt lgkmcnt(10)
    v_mfma_f32_16x16x32_bf16 v[112:115], v[44:47], v[184:187], v[112:115]
    v_mfma_f32_16x16x32_bf16 v[148:151], v[44:47], v[188:191], v[148:151]
    ds_read_b64_tr_b16 v[32:33], v8 offset:32
    ds_read_b64_tr_b16 v[34:35], v8 offset:2336
    s_waitcnt lgkmcnt(10)
    v_mfma_f32_16x16x32_bf16 v[116:119], v[48:51], v[184:187], v[116:119]
    v_mfma_f32_16x16x32_bf16 v[152:155], v[48:51], v[188:191], v[152:155]
    ds_read_b64_tr_b16 v[36:37], v8 offset:64
    ds_read_b64_tr_b16 v[38:39], v8 offset:2368
    s_waitcnt lgkmcnt(10)
    v_mfma_f32_16x16x32_bf16 v[120:123], v[52:55], v[184:187], v[120:123]
    v_mfma_f32_16x16x32_bf16 v[156:159], v[52:55], v[188:191], v[156:159]
    ds_read_b64_tr_b16 v[40:41], v8 offset:96
    ds_read_b64_tr_b16 v[42:43], v8 offset:2400
    s_waitcnt lgkmcnt(10)
    v_mfma_f32_16x16x32_bf16 v[124:127], v[56:59], v[184:187], v[124:127]
    v_mfma_f32_16x16x32_bf16 v[160:163], v[56:59], v[188:191], v[160:163]
    ds_read_b64_tr_b16 v[44:45], v8 offset:128
    ds_read_b64_tr_b16 v[46:47], v8 offset:2432
    s_waitcnt lgkmcnt(10)
    v_mfma_f32_16x16x32_bf16 v[128:131], v[60:63], v[184:187], v[128:131]
    v_mfma_f32_16x16x32_bf16 v[164:167], v[60:63], v[188:191], v[164:167]
    s_waitcnt vmcnt(10)
    ds_read_b64_tr_b16 v[48:49], v8 offset:160
    ds_read_b64_tr_b16 v[50:51], v8 offset:2464
    s_waitcnt lgkmcnt(10)
    v_mfma_f32_16x16x32_bf16 v[96:99], v[28:31], v[192:195], v[96:99]
    v_mfma_f32_16x16x32_bf16 v[132:135], v[28:31], v[196:199], v[132:135]
    ds_read_b64_tr_b16 v[52:53], v8 offset:192
    ds_read_b64_tr_b16 v[54:55], v8 offset:2496
    s_waitcnt lgkmcnt(10)
    v_mfma_f32_16x16x32_bf16 v[100:103], v[32:35], v[192:195], v[100:103]
    v_mfma_f32_16x16x32_bf16 v[136:139], v[32:35], v[196:199], v[136:139]
    ds_read_b64_tr_b16 v[56:57], v8 offset:224
    ds_read_b64_tr_b16 v[58:59], v8 offset:2528
    s_waitcnt lgkmcnt(10)
    v_mfma_f32_16x16x32_bf16 v[104:107], v[36:39], v[192:195], v[104:107]
    v_mfma_f32_16x16x32_bf16 v[140:143], v[36:39], v[196:199], v[140:143]
    ds_read_b64_tr_b16 v[60:61], v8 offset:256
    ds_read_b64_tr_b16 v[62:63], v8 offset:2560
    s_waitcnt lgkmcnt(10)
    v_mfma_f32_16x16x32_bf16 v[108:111], v[40:43], v[192:195], v[108:111]
    v_mfma_f32_16x16x32_bf16 v[144:147], v[40:43], v[196:199], v[144:147]
    ds_read_b64_tr_b16 v[28:29], v8 offset:18432
    ds_read_b64_tr_b16 v[30:31], v8 offset:20736
    s_waitcnt lgkmcnt(10)
    v_mfma_f32_16x16x32_bf16 v[112:115], v[44:47], v[192:195], v[112:115]
    v_mfma_f32_16x16x32_bf16 v[148:151], v[44:47], v[196:199], v[148:151]
    ds_read_b64_tr_b16 v[32:33], v8 offset:18464
    ds_read_b64_tr_b16 v[34:35], v8 offset:20768
    s_waitcnt lgkmcnt(10)
    v_mfma_f32_16x16x32_bf16 v[116:119], v[48:51], v[192:195], v[116:119]
    v_mfma_f32_16x16x32_bf16 v[152:155], v[48:51], v[196:199], v[152:155]
    ds_read_b64_tr_b16 v[36:37], v8 offset:18496
    ds_read_b64_tr_b16 v[38:39], v8 offset:20800
    s_waitcnt lgkmcnt(10)
    v_mfma_f32_16x16x32_bf16 v[120:123], v[52:55], v[192:195], v[120:123]
    v_mfma_f32_16x16x32_bf16 v[156:159], v[52:55], v[196:199], v[156:159]
    ds_read_b64_tr_b16 v[40:41], v8 offset:18528
    ds_read_b64_tr_b16 v[42:43], v8 offset:20832
    s_waitcnt lgkmcnt(10)
    v_mfma_f32_16x16x32_bf16 v[124:127], v[56:59], v[192:195], v[124:127]
    v_mfma_f32_16x16x32_bf16 v[160:163], v[56:59], v[196:199], v[160:163]
    ds_read_b64_tr_b16 v[44:45], v8 offset:18560
    ds_read_b64_tr_b16 v[46:47], v8 offset:20864
    s_waitcnt lgkmcnt(10)
    v_mfma_f32_16x16x32_bf16 v[128:131], v[60:63], v[192:195], v[128:131]
    v_mfma_f32_16x16x32_bf16 v[164:167], v[60:63], v[196:199], v[164:167]
    s_waitcnt vmcnt(4)
    s_barrier
    ds_read_b64_tr_b16 v[48:49], v8 offset:18592
    ds_read_b64_tr_b16 v[50:51], v8 offset:20896
    s_waitcnt lgkmcnt(10)
    v_mfma_f32_16x16x32_bf16 v[96:99], v[28:31], v[200:203], v[96:99]
    v_mfma_f32_16x16x32_bf16 v[132:135], v[28:31], v[204:207], v[132:135]
    ds_read_b64_tr_b16 v[52:53], v8 offset:18624
    ds_read_b64_tr_b16 v[54:55], v8 offset:20928
    s_waitcnt lgkmcnt(10)
    v_mfma_f32_16x16x32_bf16 v[100:103], v[32:35], v[200:203], v[100:103]
    v_mfma_f32_16x16x32_bf16 v[136:139], v[32:35], v[204:207], v[136:139]
    ds_read_b64_tr_b16 v[56:57], v8 offset:18656
    ds_read_b64_tr_b16 v[58:59], v8 offset:20960
    s_waitcnt lgkmcnt(10)
    v_mfma_f32_16x16x32_bf16 v[104:107], v[36:39], v[200:203], v[104:107]
    v_mfma_f32_16x16x32_bf16 v[140:143], v[36:39], v[204:207], v[140:143]
    ds_read_b64_tr_b16 v[60:61], v8 offset:18688
    ds_read_b64_tr_b16 v[62:63], v8 offset:20992
    s_waitcnt lgkmcnt(10)
    v_mfma_f32_16x16x32_bf16 v[108:111], v[40:43], v[200:203], v[108:111]
    v_mfma_f32_16x16x32_bf16 v[144:147], v[40:43], v[204:207], v[144:147]
    ds_read_b64_tr_b16 v[28:29], v5 offset:0
    ds_read_b64_tr_b16 v[30:31], v5 offset:2304
    s_waitcnt lgkmcnt(10)
    v_mfma_f32_16x16x32_bf16 v[112:115], v[44:47], v[200:203], v[112:115]
    v_mfma_f32_16x16x32_bf16 v[148:151], v[44:47], v[204:207], v[148:151]
    ds_read_b64_tr_b16 v[32:33], v5 offset:32
    ds_read_b64_tr_b16 v[34:35], v5 offset:2336
    s_waitcnt lgkmcnt(10)
    v_mfma_f32_16x16x32_bf16 v[116:119], v[48:51], v[200:203], v[116:119]
    v_mfma_f32_16x16x32_bf16 v[152:155], v[48:51], v[204:207], v[152:155]
    ds_read_b64_tr_b16 v[36:37], v5 offset:64
    ds_read_b64_tr_b16 v[38:39], v5 offset:2368
    s_waitcnt lgkmcnt(10)
    v_mfma_f32_16x16x32_bf16 v[120:123], v[52:55], v[200:203], v[120:123]
    v_mfma_f32_16x16x32_bf16 v[156:159], v[52:55], v[204:207], v[156:159]
    ds_read_b64_tr_b16 v[40:41], v5 offset:96
    ds_read_b64_tr_b16 v[42:43], v5 offset:2400
    s_waitcnt lgkmcnt(10)
    v_mfma_f32_16x16x32_bf16 v[124:127], v[56:59], v[200:203], v[124:127]
    v_mfma_f32_16x16x32_bf16 v[160:163], v[56:59], v[204:207], v[160:163]
    ds_read_b64_tr_b16 v[44:45], v5 offset:128
    ds_read_b64_tr_b16 v[46:47], v5 offset:2432
    s_waitcnt lgkmcnt(10)
    v_mfma_f32_16x16x32_bf16 v[128:131], v[60:63], v[200:203], v[128:131]
    v_mfma_f32_16x16x32_bf16 v[164:167], v[60:63], v[204:207], v[164:167]
    s_waitcnt vmcnt(2)
    ds_read_b64_tr_b16 v[48:49], v5 offset:160
    ds_read_b64_tr_b16 v[50:51], v5 offset:2464
    s_waitcnt lgkmcnt(10)
    v_mfma_f32_16x16x32_bf16 v[96:99], v[28:31], v[208:211], v[96:99]
    v_mfma_f32_16x16x32_bf16 v[132:135], v[28:31], v[212:215], v[132:135]
    ds_read_b64_tr_b16 v[52:53], v5 offset:192
    ds_read_b64_tr_b16 v[54:55], v5 offset:2496
    s_waitcnt lgkmcnt(10)
    v_mfma_f32_16x16x32_bf16 v[100:103], v[32:35], v[208:211], v[100:103]
    v_mfma_f32_16x16x32_bf16 v[136:139], v[32:35], v[212:215], v[136:139]
    ds_read_b64_tr_b16 v[56:57], v5 offset:224
    ds_read_b64_tr_b16 v[58:59], v5 offset:2528
    s_waitcnt lgkmcnt(10)
    v_mfma_f32_16x16x32_bf16 v[104:107], v[36:39], v[208:211], v[104:107]
    v_mfma_f32_16x16x32_bf16 v[140:143], v[36:39], v[212:215], v[140:143]
    ds_read_b64_tr_b16 v[60:61], v5 offset:256
    ds_read_b64_tr_b16 v[62:63], v5 offset:2560
    s_waitcnt lgkmcnt(10)
    v_mfma_f32_16x16x32_bf16 v[108:111], v[40:43], v[208:211], v[108:111]
    v_mfma_f32_16x16x32_bf16 v[144:147], v[40:43], v[212:215], v[144:147]
    ds_read_b64_tr_b16 v[28:29], v5 offset:18432
    ds_read_b64_tr_b16 v[30:31], v5 offset:20736
    s_waitcnt lgkmcnt(10)
    v_mfma_f32_16x16x32_bf16 v[112:115], v[44:47], v[208:211], v[112:115]
    v_mfma_f32_16x16x32_bf16 v[148:151], v[44:47], v[212:215], v[148:151]
    ds_read_b64_tr_b16 v[32:33], v5 offset:18464
    ds_read_b64_tr_b16 v[34:35], v5 offset:20768
    s_waitcnt lgkmcnt(10)
    v_mfma_f32_16x16x32_bf16 v[116:119], v[48:51], v[208:211], v[116:119]
    v_mfma_f32_16x16x32_bf16 v[152:155], v[48:51], v[212:215], v[152:155]
    ds_read_b64_tr_b16 v[36:37], v5 offset:18496
    ds_read_b64_tr_b16 v[38:39], v5 offset:20800
    s_waitcnt lgkmcnt(10)
    v_mfma_f32_16x16x32_bf16 v[120:123], v[52:55], v[208:211], v[120:123]
    v_mfma_f32_16x16x32_bf16 v[156:159], v[52:55], v[212:215], v[156:159]
    ds_read_b64_tr_b16 v[40:41], v5 offset:18528
    ds_read_b64_tr_b16 v[42:43], v5 offset:20832
    s_waitcnt lgkmcnt(10)
    v_mfma_f32_16x16x32_bf16 v[124:127], v[56:59], v[208:211], v[124:127]
    v_mfma_f32_16x16x32_bf16 v[160:163], v[56:59], v[212:215], v[160:163]
    ds_read_b64_tr_b16 v[44:45], v5 offset:18560
    ds_read_b64_tr_b16 v[46:47], v5 offset:20864
    s_waitcnt lgkmcnt(10)
    v_mfma_f32_16x16x32_bf16 v[128:131], v[60:63], v[208:211], v[128:131]
    v_mfma_f32_16x16x32_bf16 v[164:167], v[60:63], v[212:215], v[164:167]
    s_waitcnt vmcnt(0)
    ds_read_b64_tr_b16 v[48:49], v5 offset:18592
    ds_read_b64_tr_b16 v[50:51], v5 offset:20896
    s_waitcnt lgkmcnt(10)
    v_mfma_f32_16x16x32_bf16 v[96:99], v[28:31], v[216:219], v[96:99]
    v_mfma_f32_16x16x32_bf16 v[132:135], v[28:31], v[220:223], v[132:135]
    ds_read_b64_tr_b16 v[52:53], v5 offset:18624
    ds_read_b64_tr_b16 v[54:55], v5 offset:20928
    s_waitcnt lgkmcnt(10)
    v_mfma_f32_16x16x32_bf16 v[100:103], v[32:35], v[216:219], v[100:103]
    v_mfma_f32_16x16x32_bf16 v[136:139], v[32:35], v[220:223], v[136:139]
    ds_read_b64_tr_b16 v[56:57], v5 offset:18656
    ds_read_b64_tr_b16 v[58:59], v5 offset:20960
    s_waitcnt lgkmcnt(10)
    v_mfma_f32_16x16x32_bf16 v[104:107], v[36:39], v[216:219], v[104:107]
    v_mfma_f32_16x16x32_bf16 v[140:143], v[36:39], v[220:223], v[140:143]
    ds_read_b64_tr_b16 v[60:61], v5 offset:18688
    ds_read_b64_tr_b16 v[62:63], v5 offset:20992
    s_waitcnt lgkmcnt(10)
    v_mfma_f32_16x16x32_bf16 v[108:111], v[40:43], v[216:219], v[108:111]
    v_mfma_f32_16x16x32_bf16 v[144:147], v[40:43], v[220:223], v[144:147]
    s_waitcnt lgkmcnt(8)
    v_mfma_f32_16x16x32_bf16 v[112:115], v[44:47], v[216:219], v[112:115]
    v_mfma_f32_16x16x32_bf16 v[148:151], v[44:47], v[220:223], v[148:151]
    s_waitcnt lgkmcnt(6)
    v_mfma_f32_16x16x32_bf16 v[116:119], v[48:51], v[216:219], v[116:119]
    v_mfma_f32_16x16x32_bf16 v[152:155], v[48:51], v[220:223], v[152:155]
    s_waitcnt lgkmcnt(4)
    v_mfma_f32_16x16x32_bf16 v[120:123], v[52:55], v[216:219], v[120:123]
    v_mfma_f32_16x16x32_bf16 v[156:159], v[52:55], v[220:223], v[156:159]
    s_waitcnt lgkmcnt(2)
    v_mfma_f32_16x16x32_bf16 v[124:127], v[56:59], v[216:219], v[124:127]
    v_mfma_f32_16x16x32_bf16 v[160:163], v[56:59], v[220:223], v[160:163]
    s_waitcnt lgkmcnt(0)
    v_mfma_f32_16x16x32_bf16 v[128:131], v[60:63], v[216:219], v[128:131]
    v_mfma_f32_16x16x32_bf16 v[164:167], v[60:63], v[220:223], v[164:167]
    s_mul_i32 s44, s47, 9216
    s_add_u32 s44, s44, 36864
    v_add_u32 v15, s44, v3
    s_xor_b32 s45, s47, 4
    s_mul_i32 s45, s45, 9216
    s_add_u32 s45, s45, 36864
    v_add_u32 v16, s45, v3
    s_lshl_b32 s67, s15, 2
    s_add_u32 s67, s67, s46
    s_cmp_eq_u32 s49, 0
    s_cbranch_scc0 L_k5_kp1
    ds_write_b128 v15, v[132:135] offset:0
    ds_write_b128 v15, v[136:139] offset:1024
    ds_write_b128 v15, v[140:143] offset:2048
    ds_write_b128 v15, v[144:147] offset:3072
    ds_write_b128 v15, v[148:151] offset:4096
    ds_write_b128 v15, v[152:155] offset:5120
    ds_write_b128 v15, v[156:159] offset:6144
    ds_write_b128 v15, v[160:163] offset:7168
    ds_write_b128 v15, v[164:167] offset:8192
    s_waitcnt lgkmcnt(0)
    s_barrier
    ds_read_b128 v[28:31], v16 offset:0
    ds_read_b128 v[32:35], v16 offset:1024
    ds_read_b128 v[36:39], v16 offset:2048
    ds_read_b128 v[40:43], v16 offset:3072
    ds_read_b128 v[44:47], v16 offset:4096
    ds_read_b128 v[48:51], v16 offset:5120
    ds_read_b128 v[52:55], v16 offset:6144
    ds_read_b128 v[56:59], v16 offset:7168
    ds_read_b128 v[60:63], v16 offset:8192
    s_waitcnt lgkmcnt(8)
    v_add_f32 v96, v96, v28
    v_add_f32 v97, v97, v29
    v_add_f32 v98, v98, v30
    v_add_f32 v99, v99, v31
    s_waitcnt lgkmcnt(7)
    v_add_f32 v100, v100, v32
    v_add_f32 v101, v101, v33
    v_add_f32 v102, v102, v34
    v_add_f32 v103, v103, v35
    s_waitcnt lgkmcnt(6)
    v_add_f32 v104, v104, v36
    v_add_f32 v105, v105, v37
    v_add_f32 v106, v106, v38
    v_add_f32 v107, v107, v39
    s_waitcnt lgkmcnt(5)
    v_add_f32 v108, v108, v40
    v_add_f32 v109, v109, v41
    v_add_f32 v110, v110, v42
    v_add_f32 v111, v111, v43
    s_waitcnt lgkmcnt(4)
    v_add_f32 v112, v112, v44
    v_add_f32 v113, v113, v45
    v_add_f32 v114, v114, v46
    v_add_f32 v115, v115, v47
    s_waitcnt lgkmcnt(3)
    v_add_f32 v116, v116, v48
    v_add_f32 v117, v117, v49
    v_add_f32 v118, v118, v50
    v_add_f32 v119, v119, v51
    s_waitcnt lgkmcnt(2)
    v_add_f32 v120, v120, v52
    v_add_f32 v121, v121, v53
    v_add_f32 v122, v122, v54
    v_add_f32 v123, v123, v55
    s_waitcnt lgkmcnt(1)
    v_add_f32 v124, v124, v56
    v_add_f32 v125, v125, v57
    v_add_f32 v126, v126, v58
    v_add_f32 v127, v127, v59
    s_waitcnt lgkmcnt(0)
    v_add_f32 v128, v128, v60
    v_add_f32 v129, v129, v61
    v_add_f32 v130, v130, v62
    v_add_f32 v131, v131, v63
    s_cmp_eq_u32 s48, s14
    s_cbranch_scc1 L_k5_keep0
    v_cvt_pk_bf16_f32 v28, v96, v97
    v_cvt_pk_bf16_f32 v29, v98, v99
    v_cvt_pk_bf16_f32 v30, v100, v101
    v_cvt_pk_bf16_f32 v31, v102, v103
    v_cvt_pk_bf16_f32 v32, v104, v105
    v_cvt_pk_bf16_f32 v33, v106, v107
    v_cvt_pk_bf16_f32 v34, v108, v109
    v_cvt_pk_bf16_f32 v35, v110, v111
    v_cvt_pk_bf16_f32 v36, v112, v113
    v_cvt_pk_bf16_f32 v37, v114, v115
    v_cvt_pk_bf16_f32 v38, v116, v117
    v_cvt_pk_bf16_f32 v39, v118, v119
    v_cvt_pk_bf16_f32 v40, v120, v121
    v_cvt_pk_bf16_f32 v41, v122, v123
    v_cvt_pk_bf16_f32 v42, v124, v125
    v_cvt_pk_bf16_f32 v43, v126, v127
    v_cvt_pk_bf16_f32 v44, v128, v129
    v_cvt_pk_bf16_f32 v45, v130, v131
    s_lshl_b32 s44, s67, 2
    s_add_u32 s44, s44, s48
    s_lshl_b32 s44, s44, 2
    s_add_u32 s44, s44, s14
    s_lshl_b32 s44, s44, 1
    s_add_u32 s44, s44, 0
    s_mul_i32 s44, s44, 5120
    buffer_store_dwordx4 v[28:31], v3, s[32:35], s44 offen offset:0 sc1
    buffer_store_dwordx4 v[32:35], v3, s[32:35], s44 offen offset:1024 sc1
    buffer_store_dwordx4 v[36:39], v3, s[32:35], s44 offen offset:2048 sc1
    buffer_store_dwordx4 v[40:43], v3, s[32:35], s44 offen offset:3072 sc1
    v_lshrrev_b32 v17, 1, v3
    s_add_u32 s44, s44, 4096
    buffer_store_dwordx2 v[44:45], v17, s[32:35], s44 offen sc1
    s_branch L_k5_sent0
L_k5_keep0:
    s_mov_b32 s44, 110592
    v_add_u32 v15, s44, v3
    ds_write_b128 v15, v[96:99] offset:0
    ds_write_b128 v15, v[100:103] offset:1024
    ds_write_b128 v15, v[104:107] offset:2048
    ds_write_b128 v15, v[108:111] offset:3072
    ds_write_b128 v15, v[112:115] offset:4096
    ds_write_b128 v15, v[116:119] offset:5120
    ds_write_b128 v15, v[120:123] offset:6144
    ds_write_b128 v15, v[124:127] offset:7168
    ds_write_b128 v15, v[128:131] offset:8192
L_k5_sent0:
    s_branch L_k5_kpj
L_k5_kp1:
    ds_write_b128 v15, v[96:99] offset:0
    ds_write_b128 v15, v[100:103] offset:1024
    ds_write_b128 v15, v[104:107] offset:2048
    ds_write_b128 v15, v[108:111] offset:3072
    ds_write_b128 v15, v[112:115] offset:4096
    ds_write_b128 v15, v[116:119] offset:5120
    ds_write_b128 v15, v[120:123] offset:6144
    ds_write_b128 v15, v[124:127] offset:7168
    ds_write_b128 v15, v[128:131] offset:8192
    s_waitcnt lgkmcnt(0)
    s_barrier
    ds_read_b128 v[28:31], v16 offset:0
    ds_read_b128 v[32:35], v16 offset:1024
    ds_read_b128 v[36:39], v16 offset:2048
    ds_read_b128 v[40:43], v16 offset:3072
    ds_read_b128 v[44:47], v16 offset:4096
    ds_read_b128 v[48:51], v16 offset:5120
    ds_read_b128 v[52:55], v16 offset:6144
    ds_read_b128 v[56:59], v16 offset:7168
    ds_read_b128 v[60:63], v16 offset:8192
    s_waitcnt lgkmcnt(8)
    v_add_f32 v132, v132, v28
    v_add_f32 v133, v133, v29
    v_add_f32 v134, v134, v30
    v_add_f32 v135, v135, v31
    s_waitcnt lgkmcnt(7)
    v_add_f32 v136, v136, v32
    v_add_f32 v137, v137, v33
    v_add_f32 v138, v138, v34
    v_add_f32 v139, v139, v35
    s_waitcnt lgkmcnt(6)
    v_add_f32 v140, v140, v36
    v_add_f32 v141, v141, v37
    v_add_f32 v142, v142, v38
    v_add_f32 v143, v143, v39
    s_waitcnt lgkmcnt(5)
    v_add_f32 v144, v144, v40
    v_add_f32 v145, v145, v41
    v_add_f32 v146, v146, v42
    v_add_f32 v147, v147, v43
    s_waitcnt lgkmcnt(4)
    v_add_f32 v148, v148, v44
    v_add_f32 v149, v149, v45
    v_add_f32 v150, v150, v46
    v_add_f32 v151, v151, v47
    s_waitcnt lgkmcnt(3)
    v_add_f32 v152, v152, v48
    v_add_f32 v153, v153, v49
    v_add_f32 v154, v154, v50
    v_add_f32 v155, v155, v51
    s_waitcnt lgkmcnt(2)
    v_add_f32 v156, v156, v52
    v_add_f32 v157, v157, v53
    v_add_f32 v158, v158, v54
    v_add_f32 v159, v159, v55
    s_waitcnt lgkmcnt(1)
    v_add_f32 v160, v160, v56
    v_add_f32 v161, v161, v57
    v_add_f32 v162, v162, v58
    v_add_f32 v163, v163, v59
    s_waitcnt lgkmcnt(0)
    v_add_f32 v164, v164, v60
    v_add_f32 v165, v165, v61
    v_add_f32 v166, v166, v62
    v_add_f32 v167, v167, v63
    s_cmp_eq_u32 s48, s14
    s_cbranch_scc1 L_k5_keep1
    v_cvt_pk_bf16_f32 v28, v132, v133
    v_cvt_pk_bf16_f32 v29, v134, v135
    v_cvt_pk_bf16_f32 v30, v136, v137
    v_cvt_pk_bf16_f32 v31, v138, v139
    v_cvt_pk_bf16_f32 v32, v140, v141
    v_cvt_pk_bf16_f32 v33, v142, v143
    v_cvt_pk_bf16_f32 v34, v144, v145
    v_cvt_pk_bf16_f32 v35, v146, v147
    v_cvt_pk_bf16_f32 v36, v148, v149
    v_cvt_pk_bf16_f32 v37, v150, v151
    v_cvt_pk_bf16_f32 v38, v152, v153
    v_cvt_pk_bf16_f32 v39, v154, v155
    v_cvt_pk_bf16_f32 v40, v156, v157
    v_cvt_pk_bf16_f32 v41, v158, v159
    v_cvt_pk_bf16_f32 v42, v160, v161
    v_cvt_pk_bf16_f32 v43, v162, v163
    v_cvt_pk_bf16_f32 v44, v164, v165
    v_cvt_pk_bf16_f32 v45, v166, v167
    s_lshl_b32 s44, s67, 2
    s_add_u32 s44, s44, s48
    s_lshl_b32 s44, s44, 2
    s_add_u32 s44, s44, s14
    s_lshl_b32 s44, s44, 1
    s_add_u32 s44, s44, 1
    s_mul_i32 s44, s44, 5120
    buffer_store_dwordx4 v[28:31], v3, s[32:35], s44 offen offset:0 sc1
    buffer_store_dwordx4 v[32:35], v3, s[32:35], s44 offen offset:1024 sc1
    buffer_store_dwordx4 v[36:39], v3, s[32:35], s44 offen offset:2048 sc1
    buffer_store_dwordx4 v[40:43], v3, s[32:35], s44 offen offset:3072 sc1
    v_lshrrev_b32 v17, 1, v3
    s_add_u32 s44, s44, 4096
    buffer_store_dwordx2 v[44:45], v17, s[32:35], s44 offen sc1
    s_branch L_k5_sent1
L_k5_keep1:
    s_mov_b32 s44, 119808
    v_add_u32 v15, s44, v3
    ds_write_b128 v15, v[132:135] offset:0
    ds_write_b128 v15, v[136:139] offset:1024
    ds_write_b128 v15, v[140:143] offset:2048
    ds_write_b128 v15, v[144:147] offset:3072
    ds_write_b128 v15, v[148:151] offset:4096
    ds_write_b128 v15, v[152:155] offset:5120
    ds_write_b128 v15, v[156:159] offset:6144
    ds_write_b128 v15, v[160:163] offset:7168
    ds_write_b128 v15, v[164:167] offset:8192
L_k5_sent1:
L_k5_kpj:
    s_waitcnt vmcnt(0) lgkmcnt(0)
    s_barrier
    s_cmp_eq_u32 s47, 0
    s_cbranch_scc0 L_k5_nosig
    s_add_u32 s80, s42, 65581056
    s_addc_u32 s81, s43, 0
    s_lshl_b32 s44, s67, 6
    s_lshl_b32 s45, s14, 2
    s_add_u32 s45, s45, s44
    v_lshlrev_b32 v20, 4, v1
    v_add_u32 v20, s45, v20
    v_mov_b32 v21, 1
    s_lshl_b32 s45, 1, s14
    s_xor_b32 s45, s45, 15
    s_mov_b64 s[82:83], exec
    s_mov_b32 exec_lo, s45
    s_mov_b32 exec_hi, 0
    global_store_dword v20, v21, s[80:81] sc1
    s_mov_b64 exec, 1
    s_lshl_b32 s45, s14, 4
    s_add_u32 s45, s45, s44
    v_mov_b32 v20, s45
    s_mov_b32 s68, 0
L_k5_poll:
    global_load_dwordx4 v[24:27], v20, s[80:81] sc1
    s_waitcnt vmcnt(0)
    v_add_u32 v24, v24, v25
    v_add_u32 v26, v26, v27
    v_add_u32 v24, v24, v26
    s_nop 0
    v_readfirstlane_b32 s69, v24
    s_nop 3
    s_cmp_ge_u32 s69, 3
    s_cbranch_scc1 L_k5_pollok
    s_add_u32 s68, s68, 1
    s_cmp_ge_u32 s68, 200000
    s_cbranch_scc0 L_k5_poll
L_k5_pollok:
    s_mov_b64 exec, s[82:83]
L_k5_nosig:
    s_barrier
    s_cmp_ge_u32 s47, 6
    s_cbranch_scc1 L_k5_done
    s_lshl_b32 s44, s67, 2
    s_add_u32 s44, s44, s14
    s_lshl_b32 s44, s44, 3
    s_mul_i32 s44, s44, 5120
    v_lshrrev_b32 v17, 1, v3
    s_and_b32 s45, s73, 1
    s_lshl_b32 s45, s45, 3
    v_add_u32 v18, s45, v3
    s_cmp_eq_u32 s73, 8
    s_cselect_b64 s[80:81], -1, 0
    v_cndmask_b32 v19, v18, v17, s[80:81]
    s_lshr_b32 s45, s73, 1
    s_lshl_b32 s45, s45, 10
    s_mul_i32 s68, s70, 5120
    s_add_u32 s45, s45, s68
    s_add_u32 s45, s45, s44
    s_add_u32 s68, s14, 1
    s_and_b32 s68, s68, 3
    s_mul_i32 s68, s68, 10240
    s_add_u32 s68, s68, s45
    buffer_load_dwordx2 v[98:99], v19, s[32:35], s68 offen sc1
    s_add_u32 s68, s14, 2
    s_and_b32 s68, s68, 3
    s_mul_i32 s68, s68, 10240
    s_add_u32 s68, s68, s45
    buffer_load_dwordx2 v[100:101], v19, s[32:35], s68 offen sc1
    s_add_u32 s68, s14, 3
    s_and_b32 s68, s68, 3
    s_mul_i32 s68, s68, 10240
    s_add_u32 s68, s68, s45
    buffer_load_dwordx2 v[102:103], v19, s[32:35], s68 offen sc1
    s_mul_i32 s45, s70, 9216
    s_lshl_b32 s68, s73, 10
    s_add_u32 s45, s45, s68
    s_add_u32 s45, s45, 110592
    v_add_u32 v15, s45, v3
    ds_read_b128 v[104:107], v15
    s_and_b32 s45, s74, 1
    s_lshl_b32 s45, s45, 3
    v_add_u32 v18, s45, v3
    s_cmp_eq_u32 s74, 8
    s_cselect_b64 s[80:81], -1, 0
    v_cndmask_b32 v20, v18, v17, s[80:81]
    s_lshr_b32 s45, s74, 1
    s_lshl_b32 s45, s45, 10
    s_mul_i32 s68, s71, 5120
    s_add_u32 s45, s45, s68
    s_add_u32 s45, s45, s44
    s_add_u32 s68, s14, 1
    s_and_b32 s68, s68, 3
    s_mul_i32 s68, s68, 10240
    s_add_u32 s68, s68, s45
    buffer_load_dwordx2 v[114:115], v20, s[32:35], s68 offen sc1
    s_add_u32 s68, s14, 2
    s_and_b32 s68, s68, 3
    s_mul_i32 s68, s68, 10240
    s_add_u32 s68, s68, s45
    buffer_load_dwordx2 v[116:117], v20, s[32:35], s68 offen sc1
    s_add_u32 s68, s14, 3
    s_and_b32 s68, s68, 3
    s_mul_i32 s68, s68, 10240
    s_add_u32 s68, s68, s45
    buffer_load_dwordx2 v[118:119], v20, s[32:35], s68 offen sc1
    s_mul_i32 s45, s71, 9216
    s_lshl_b32 s68, s74, 10
    s_add_u32 s45, s45, s68
    s_add_u32 s45, s45, 110592
    v_add_u32 v15, s45, v3
    ds_read_b128 v[120:123], v15
    s_and_b32 s45, s75, 1
    s_lshl_b32 s45, s45, 3
    v_add_u32 v18, s45, v3
    s_cmp_eq_u32 s75, 8
    s_cselect_b64 s[80:81], -1, 0
    v_cndmask_b32 v21, v18, v17, s[80:81]
    s_lshr_b32 s45, s75, 1
    s_lshl_b32 s45, s45, 10
    s_mul_i32 s68, s72, 5120
    s_add_u32 s45, s45, s68
    s_add_u32 s45, s45, s44
    s_add_u32 s68, s14, 1
    s_and_b32 s68, s68, 3
    s_mul_i32 s68, s68, 10240
    s_add_u32 s68, s68, s45
    buffer_load_dwordx2 v[130:131], v21, s[32:35], s68 offen sc1
    s_add_u32 s68, s14, 2
    s_and_b32 s68, s68, 3
    s_mul_i32 s68, s68, 10240
    s_add_u32 s68, s68, s45
    buffer_load_dwordx2 v[132:133], v21, s[32:35], s68 offen sc1
    s_add_u32 s68, s14, 3
    s_and_b32 s68, s68, 3
    s_mul_i32 s68, s68, 10240
    s_add_u32 s68, s68, s45
    buffer_load_dwordx2 v[134:135], v21, s[32:35], s68 offen sc1
    s_mul_i32 s45, s72, 9216
    s_lshl_b32 s68, s75, 10
    s_add_u32 s45, s45, s68
    s_add_u32 s45, s45, 110592
    v_add_u32 v15, s45, v3
    ds_read_b128 v[136:139], v15
    s_waitcnt vmcnt(0) lgkmcnt(0)
    v_lshlrev_b32 v96, 16, v98
    v_and_b32 v97, 0xffff0000, v98
    v_add_f32 v104, v104, v96
    v_add_f32 v105, v105, v97
    v_lshlrev_b32 v96, 16, v99
    v_and_b32 v97, 0xffff0000, v99
    v_add_f32 v106, v106, v96
    v_add_f32 v107, v107, v97
    v_lshlrev_b32 v96, 16, v100
    v_and_b32 v97, 0xffff0000, v100
    v_add_f32 v104, v104, v96
    v_add_f32 v105, v105, v97
    v_lshlrev_b32 v96, 16, v101
    v_and_b32 v97, 0xffff0000, v101
    v_add_f32 v106, v106, v96
    v_add_f32 v107, v107, v97
    v_lshlrev_b32 v96, 16, v102
    v_and_b32 v97, 0xffff0000, v102
    v_add_f32 v104, v104, v96
    v_add_f32 v105, v105, v97
    v_lshlrev_b32 v96, 16, v103
    v_and_b32 v97, 0xffff0000, v103
    v_add_f32 v106, v106, v96
    v_add_f32 v107, v107, v97
    v_cvt_pk_bf16_f32 v108, v104, v105
    v_cvt_pk_bf16_f32 v109, v106, v107
    v_lshlrev_b32 v104, 16, v108
    v_and_b32 v105, 0xffff0000, v108
    v_lshlrev_b32 v106, 16, v109
    v_and_b32 v107, 0xffff0000, v109
    v_lshlrev_b32 v224, 16, v224
    v_add_f32 v104, v104, v224
    v_lshlrev_b32 v225, 16, v225
    v_add_f32 v105, v105, v225
    v_lshlrev_b32 v226, 16, v226
    v_add_f32 v106, v106, v226
    v_lshlrev_b32 v227, 16, v227
    v_add_f32 v107, v107, v227
    v_cvt_pk_bf16_f32 v108, v104, v105
    v_cvt_pk_bf16_f32 v109, v106, v107
    buffer_store_dwordx2 v[108:109], v13, s[28:31], s76 offen
    v_lshlrev_b32 v112, 16, v114
    v_and_b32 v113, 0xffff0000, v114
    v_add_f32 v120, v120, v112
    v_add_f32 v121, v121, v113
    v_lshlrev_b32 v112, 16, v115
    v_and_b32 v113, 0xffff0000, v115
    v_add_f32 v122, v122, v112
    v_add_f32 v123, v123, v113
    v_lshlrev_b32 v112, 16, v116
    v_and_b32 v113, 0xffff0000, v116
    v_add_f32 v120, v120, v112
    v_add_f32 v121, v121, v113
    v_lshlrev_b32 v112, 16, v117
    v_and_b32 v113, 0xffff0000, v117
    v_add_f32 v122, v122, v112
    v_add_f32 v123, v123, v113
    v_lshlrev_b32 v112, 16, v118
    v_and_b32 v113, 0xffff0000, v118
    v_add_f32 v120, v120, v112
    v_add_f32 v121, v121, v113
    v_lshlrev_b32 v112, 16, v119
    v_and_b32 v113, 0xffff0000, v119
    v_add_f32 v122, v122, v112
    v_add_f32 v123, v123, v113
    v_cvt_pk_bf16_f32 v124, v120, v121
    v_cvt_pk_bf16_f32 v125, v122, v123
    v_lshlrev_b32 v120, 16, v124
    v_and_b32 v121, 0xffff0000, v124
    v_lshlrev_b32 v122, 16, v125
    v_and_b32 v123, 0xffff0000, v125
    v_lshlrev_b32 v228, 16, v228
    v_add_f32 v120, v120, v228
    v_lshlrev_b32 v229, 16, v229
    v_add_f32 v121, v121, v229
    v_lshlrev_b32 v230, 16, v230
    v_add_f32 v122, v122, v230
    v_lshlrev_b32 v231, 16, v231
    v_add_f32 v123, v123, v231
    v_cvt_pk_bf16_f32 v124, v120, v121
    v_cvt_pk_bf16_f32 v125, v122, v123
    buffer_store_dwordx2 v[124:125], v13, s[28:31], s77 offen
    v_lshlrev_b32 v128, 16, v130
    v_and_b32 v129, 0xffff0000, v130
    v_add_f32 v136, v136, v128
    v_add_f32 v137, v137, v129
    v_lshlrev_b32 v128, 16, v131
    v_and_b32 v129, 0xffff0000, v131
    v_add_f32 v138, v138, v128
    v_add_f32 v139, v139, v129
    v_lshlrev_b32 v128, 16, v132
    v_and_b32 v129, 0xffff0000, v132
    v_add_f32 v136, v136, v128
    v_add_f32 v137, v137, v129
    v_lshlrev_b32 v128, 16, v133
    v_and_b32 v129, 0xffff0000, v133
    v_add_f32 v138, v138, v128
    v_add_f32 v139, v139, v129
    v_lshlrev_b32 v128, 16, v134
    v_and_b32 v129, 0xffff0000, v134
    v_add_f32 v136, v136, v128
    v_add_f32 v137, v137, v129
    v_lshlrev_b32 v128, 16, v135
    v_and_b32 v129, 0xffff0000, v135
    v_add_f32 v138, v138, v128
    v_add_f32 v139, v139, v129
    v_cvt_pk_bf16_f32 v140, v136, v137
    v_cvt_pk_bf16_f32 v141, v138, v139
    v_lshlrev_b32 v136, 16, v140
    v_and_b32 v137, 0xffff0000, v140
    v_lshlrev_b32 v138, 16, v141
    v_and_b32 v139, 0xffff0000, v141
    v_lshlrev_b32 v232, 16, v232
    v_add_f32 v136, v136, v232
    v_lshlrev_b32 v233, 16, v233
    v_add_f32 v137, v137, v233
    v_lshlrev_b32 v234, 16, v234
    v_add_f32 v138, v138, v234
    v_lshlrev_b32 v235, 16, v235
    v_add_f32 v139, v139, v235
    v_cvt_pk_bf16_f32 v140, v136, v137
    v_cvt_pk_bf16_f32 v141, v138, v139
    buffer_store_dwordx2 v[140:141], v13, s[28:31], s78 offen
L_k5_done:
    s_endpgm
.section .rodata,"a"
.p2align 6
.amdhsa_kernel k5_kernel
  .amdhsa_next_free_vgpr 256
  .amdhsa_next_free_sgpr 102
  .amdhsa_accum_offset 256
  .amdhsa_group_segment_fixed_size 0
  .amdhsa_kernarg_size 112
  .amdhsa_user_sgpr_count 2
  .amdhsa_user_sgpr_kernarg_segment_ptr 1
  .amdhsa_system_sgpr_workgroup_id_x 1
.end_amdhsa_kernel
```
